```python
import torch

def _softmax(x, axis=-1):
    return torch.softmax(x, dim=axis)
def _gelu(x):
    return torch.nn.functional.gelu(x, approximate="tanh")
def _silu(x):
    return torch.nn.functional.silu(x)
def _sigmoid(x):
    return torch.sigmoid(x)
def _layernorm(x, axis=-1, eps=1e-5):
    m = x.mean(dim=axis, keepdim=True)
    v = x.var(dim=axis, keepdim=True, unbiased=False)
    return (x - m) / torch.sqrt(v + eps)
def _scatter_add(tgt, idx, src, axis=0):
    return tgt.clone().index_add_(axis, idx, src)
def _segment_sum(src, seg, n):
    out = torch.zeros((n,) + src.shape[1:], dtype=src.dtype)
    return out.index_add_(0, seg, src)
def _pad(x, pw):
    flat = tuple(v for pair in reversed(pw) for v in pair)
    return torch.nn.functional.pad(x, flat)

kernel_name = 'parallel_sum__mha_block__glu_gated_glu__prompt'

def setup_inputs():

    _w = (lambda a: (lambda t: t.to(torch.bfloat16) if t.is_floating_point() else t)(torch.as_tensor(a)))
    def _A_setup():
        B, S, D, H = 1, 2048, 1024, 32
        return {
            "x": _w((lambda *s: torch.randn(*s, dtype=torch.bfloat16) * 0.05)(B, S, D)),
            "wqkv": _w((lambda *s: torch.randn(*s, dtype=torch.bfloat16) * 0.05)(D, 3 * D)),
            "wo": _w((lambda *s: torch.randn(*s, dtype=torch.bfloat16) * 0.05)(D, D)),
        }
    _A_in = _A_setup()

    def _B_setup():
        B, S, D, F = 1, 2048, 1024, 3584
        return {
            "x": _w((lambda *s: torch.randn(*s, dtype=torch.bfloat16) * 0.05)(B, S, D)),
            "w_gate": _w((lambda *s: torch.randn(*s, dtype=torch.bfloat16) * 0.05)(D, F)),
            "w_up": _w((lambda *s: torch.randn(*s, dtype=torch.bfloat16) * 0.05)(D, F)),
            "w_down": _w((lambda *s: torch.randn(*s, dtype=torch.bfloat16) * 0.05)(F, D)),
        }
    _B_in = _B_setup()

    return {
        "A_x": _A_in["x"],
        "A_wqkv": _A_in["wqkv"],
        "A_wo": _A_in["wo"],
        "B_x": _B_in["x"],
        "B_w_gate": _B_in["w_gate"],
        "B_w_up": _B_in["w_up"],
        "B_w_down": _B_in["w_down"],
    }

def reference(A_x, A_wqkv, A_wo, B_x, B_w_gate, B_w_up, B_w_down):
    def _A_ref(x, wqkv, wo):
        B, S, D = x.shape
        H = 32
        Dh = D // H
        qkv = (lambda x, *d: x.permute(*d))((x @ wqkv).reshape(B, S, 3, H, Dh), 2, 0, 3, 1, 4)
        q, k, v = qkv[0], qkv[1], qkv[2]
        scores = torch.einsum("bhqd,bhkd->bhqk", q, k) * (Dh ** -0.5)
        p = _softmax(scores, axis=-1)
        o = torch.einsum("bhqk,bhkd->bhqd", p, v)
        return (lambda x, *d: x.permute(*d))(o, 0, 2, 1, 3).reshape(B, S, D) @ wo

    def _B_ref(x, w_gate, w_up, w_down):
        g = torch.einsum("bsd,df->bsf", x, w_gate)
        u = torch.einsum("bsd,df->bsf", x, w_up)
        h = _sigmoid(g) * u
        return torch.einsum("bsf,fd->bsd", h, w_down)

    x = A_x
    xn = _layernorm(x, axis=-1)
    return x + _A_ref(xn, A_wqkv, A_wo) + _B_ref(xn, B_w_gate, B_w_up, B_w_down)
```

```asm
; @launch kernel=mega_kernel grid=(256,1,1) block=(512,1,1) lds=163840
.amdgcn_target "amdgcn-amd-amdhsa--gfx950"
.text
.globl mega_kernel
.p2align 8
.type mega_kernel,@function
mega_kernel:
    s_cmp_ge_u32 s2, 256
    s_cbranch_scc1 L_end
    s_load_dwordx16 s[4:19], s[0:1], 0
    s_load_dwordx4 s[20:23], s[0:1], 64
    s_memrealtime s[32:33]
    v_lshrrev_b32 v3, 6, v0
    v_and_b32 v1, 63, v0
    v_readfirstlane_b32 s28, v3
    s_and_b32 s34, s2, 7
    s_lshr_b32 s35, s2, 3
    s_lshr_b32 s29, s35, 2
    s_and_b32 s36, s35, 3
    s_lshl_b32 s30, s34, 2
    s_add_u32 s30, s30, s36
    v_lshlrev_b32 v2, 4, v1
    v_mov_b32 v28, 0
    s_cmp_ge_u32 s28, 4
    s_cbranch_scc1 L_p0_h1
    v_and_b32 v4, 7, v1
    v_lshrrev_b32 v5, 3, v1
    s_lshl_b32 s34, s29, 5
    s_add_u32 s34, s34, s30
    v_lshlrev_b32 v6, 11, v4
    v_lshl_add_u32 v6, v3, 9, v6
    v_lshl_add_u32 v6, v5, 4, v6
    s_lshl_b32 s35, s34, 14
    s_mov_b32 s58, 4194304
    s_mov_b32 s59, 0x00020000
    s_waitcnt lgkmcnt(0)
    s_mov_b32 s56, s4
    s_and_b32 s57, s5, 0xffff
    buffer_load_dwordx4 v[32:35], v6, s[56:59], s35 offen offset:0
    buffer_load_dwordx4 v[36:39], v6, s[56:59], s35 offen offset:128
    buffer_load_dwordx4 v[40:43], v6, s[56:59], s35 offen offset:256
    buffer_load_dwordx4 v[44:47], v6, s[56:59], s35 offen offset:384
    s_mov_b32 s24, s22
    s_and_b32 s25, s23, 0xffff
    s_mov_b32 s26, 83886080
    s_mov_b32 s27, 0x00020000
    s_mov_b32 s44, s20
    s_and_b32 s45, s21, 0xffff
    s_mov_b32 s46, 256
    s_mov_b32 s47, 0x00020000
    s_or_b32 s32, s32, 1
    s_or_b32 s35, s2, s28
    s_cmp_lg_u32 s35, 0
    s_cbranch_scc1 L_nononce
    v_mov_b32 v10, s32
    v_mov_b32 v11, s33
    s_mov_b64 exec, 1
    buffer_store_dwordx2 v[10:11], v28, s[44:47], 0 offen sc1
    s_mov_b64 exec, -1
L_nononce:
    s_barrier
    s_lshr_b32 s35, s34, 3
    s_lshl_b32 s35, s35, 17
    s_lshr_b32 s36, s30, 1
    s_and_b32 s36, s36, 3
    s_lshl_b32 s36, s36, 10
    s_add_u32 s35, s35, s36
    s_and_b32 s36, s30, 1
    s_lshl_b32 s36, s36, 7
    s_add_u32 s35, s35, s36
    s_lshl_b32 s36, s28, 15
    s_add_u32 s35, s35, s36
    v_lshrrev_b32 v12, 2, v5
    v_lshlrev_b32 v29, 12, v12
    v_and_b32 v12, 3, v5
    v_lshl_add_u32 v29, v12, 8, v29
    v_lshl_add_u32 v29, v4, 4, v29
    v_add_u32 v29, s35, v29
    v_lshlrev_b32 v31, 5, v4
    v_add_u32 v31, 155648, v31
    v_lshl_add_u32 v30, v3, 3, v31
    s_mov_b32 s60, 0xffff0000
    s_movk_i32 s61, 0x2000
    s_movk_i32 s62, 0x4000
    s_movk_i32 s63, 0x6000
    s_lshl_b32 s38, s28, 1
    s_lshl_b32 s39, s34, 6
    v_lshlrev_b32 v27, 3, v4
    v_add_u32 v27, s39, v27
    v_lshrrev_b32 v14, 4, v1
    v_bfe_u32 v15, v1, 3, 1
    v_bfe_u32 v16, v1, 1, 2
    v_lshl_add_u32 v15, v15, 3, v16
    v_and_b32 v16, 1, v1
    v_lshlrev_b32 v16, 4, v16
    s_lshl_b32 s73, s38, 10
    s_add_u32 s72, s73, 61440
    s_add_u32 s74, s73, 102400
    s_mul_i32 s37, s30, 224
    s_lshl_b32 s39, s30, 6
    s_add_u32 s34, s38, 0
    s_cmp_lt_u32 s34, 6
    s_cbranch_scc1 L_mega_kernel_dq_1
    s_cmp_lt_u32 s34, 13
    s_cselect_b32 s48, s12, s14
    s_cselect_b32 s49, s13, s15
    s_cselect_b32 s35, 6, 13
    s_sub_u32 s34, s34, s35
    s_lshl_b32 s34, s34, 2
    v_add_u32 v17, s34, v14
    v_mul_u32_u24 v18, 37, v17
    v_lshrrev_b32 v18, 8, v18
    v_mul_u32_u24 v19, 7, v18
    v_sub_u32 v17, v17, v19
    s_mov_b32 s50, 7340032
    s_movk_i32 s36, 7168
    v_lshlrev_b32 v17, 5, v17
    v_add_u32 v17, s37, v17
    s_branch L_mega_kernel_dd_2
L_mega_kernel_dq_1:
    s_mov_b32 s48, s6
    s_mov_b32 s49, s7
    s_mov_b32 s50, 6291456
    s_movk_i32 s36, 6144
    s_lshl_b32 s34, s34, 2
    v_add_u32 v17, s34, v14
    v_mul_u32_u24 v18, 43, v17
    v_lshrrev_b32 v18, 8, v18
    v_mul_u32_u24 v19, 6, v18
    v_sub_u32 v17, v17, v19
    v_lshrrev_b32 v19, 1, v17
    v_and_b32 v17, 1, v17
    v_lshlrev_b32 v17, 5, v17
    v_lshl_add_u32 v17, v19, 11, v17
    v_add_u32 v17, s39, v17
L_mega_kernel_dd_2:
    s_and_b32 s49, s49, 0xffff
    s_mov_b32 s51, 0x00020000
    v_and_b32 v19, 1, v18
    v_lshrrev_b32 v18, 1, v18
    v_lshl_add_u32 v19, v19, 2, v15
    v_lshl_add_u32 v19, v18, 4, v19
    v_mul_lo_u32 v19, v19, s36
    v_add3_u32 v3, v19, v17, v16
    s_lshl_b32 s68, s36, 5
    s_mov_b32 s64, 0
    s_add_u32 s34, s38, 1
    s_cmp_lt_u32 s34, 6
    s_cbranch_scc1 L_mega_kernel_dq_3
    s_cmp_lt_u32 s34, 13
    s_cselect_b32 s52, s12, s14
    s_cselect_b32 s53, s13, s15
    s_cselect_b32 s35, 6, 13
    s_sub_u32 s34, s34, s35
    s_lshl_b32 s34, s34, 2
    v_add_u32 v17, s34, v14
    v_mul_u32_u24 v18, 37, v17
    v_lshrrev_b32 v18, 8, v18
    v_mul_u32_u24 v19, 7, v18
    v_sub_u32 v17, v17, v19
    s_mov_b32 s54, 7340032
    s_movk_i32 s36, 7168
    v_lshlrev_b32 v17, 5, v17
    v_add_u32 v17, s37, v17
    s_branch L_mega_kernel_dd_4
L_mega_kernel_dq_3:
    s_mov_b32 s52, s6
    s_mov_b32 s53, s7
    s_mov_b32 s54, 6291456
    s_movk_i32 s36, 6144
    s_lshl_b32 s34, s34, 2
    v_add_u32 v17, s34, v14
    v_mul_u32_u24 v18, 43, v17
    v_lshrrev_b32 v18, 8, v18
    v_mul_u32_u24 v19, 6, v18
    v_sub_u32 v17, v17, v19
    v_lshrrev_b32 v19, 1, v17
    v_and_b32 v17, 1, v17
    v_lshlrev_b32 v17, 5, v17
    v_lshl_add_u32 v17, v19, 11, v17
    v_add_u32 v17, s39, v17
L_mega_kernel_dd_4:
    s_and_b32 s53, s53, 0xffff
    s_mov_b32 s55, 0x00020000
    v_and_b32 v19, 1, v18
    v_lshrrev_b32 v18, 1, v18
    v_lshl_add_u32 v19, v19, 2, v15
    v_lshl_add_u32 v19, v18, 4, v19
    v_mul_lo_u32 v19, v19, s36
    v_add3_u32 v4, v19, v17, v16
    s_lshl_b32 s69, s36, 5
    s_mov_b32 s65, 0
    s_add_u32 m0, s72, 0
    s_nop 0
    buffer_load_dwordx4 v3, s[48:51], s64 offen lds
    s_add_u32 s64, s64, s68
    s_add_u32 m0, s72, 1024
    s_nop 0
    buffer_load_dwordx4 v4, s[52:55], s65 offen lds
    s_add_u32 s65, s65, s69
    s_add_u32 s72, s72, 20480
    s_cmp_ge_u32 s72, s74
    s_cselect_b32 s72, s73, s72
    s_add_u32 m0, s72, 0
    s_nop 0
    buffer_load_dwordx4 v3, s[48:51], s64 offen lds
    s_add_u32 s64, s64, s68
    s_add_u32 m0, s72, 1024
    s_nop 0
    buffer_load_dwordx4 v4, s[52:55], s65 offen lds
    s_add_u32 s65, s65, s69
    s_add_u32 s72, s72, 20480
    s_cmp_ge_u32 s72, s74
    s_cselect_b32 s72, s73, s72
    s_add_u32 m0, s72, 0
    s_nop 0
    buffer_load_dwordx4 v3, s[48:51], s64 offen lds
    s_add_u32 s64, s64, s68
    s_add_u32 m0, s72, 1024
    s_nop 0
    buffer_load_dwordx4 v4, s[52:55], s65 offen lds
    s_add_u32 s65, s65, s69
    s_add_u32 s72, s72, 20480
    s_cmp_ge_u32 s72, s74
    s_cselect_b32 s72, s73, s72
    s_and_b32 s34, s28, 3
    s_lshl_b32 s35, s29, 2
    s_add_u32 s35, s34, s35
    s_lshl_b32 s35, s35, 17
    s_add_u32 s40, s22, s35
    s_addc_u32 s41, s23, 0
    s_and_b32 s41, s41, 0xffff
    s_mov_b32 s42, 131072
    s_mov_b32 s43, 0x00020000
    s_mov_b32 s77, 0
    s_mov_b32 s75, 61440
    s_lshl_b32 s34, s34, 12
    s_add_u32 s34, s34, 102400
    s_mov_b32 s79, 0
    s_mov_b32 s3, s34
    s_mov_b32 s80, 0
    s_mov_b32 s82, 20480
    s_mov_b32 s83, 16384
    v_add_u32 v9, s34, v2
    v_lshrrev_b32 v12, 5, v1
    v_and_b32 v13, 31, v1
    v_lshlrev_b32 v13, 3, v13
    v_add_u32 v13, 61440, v13
    v_mul_u32_u24 v7, 3072, v12
    v_mul_u32_u24 v8, 3584, v12
    v_add_u32 v7, v7, v13
    v_add_u32 v8, v8, v13
    v_accvgpr_write_b32 a64, 0
    v_accvgpr_write_b32 a65, 0
    v_accvgpr_write_b32 a66, 0
    v_accvgpr_write_b32 a67, 0
    v_accvgpr_write_b32 a68, 0
    v_accvgpr_write_b32 a69, 0
    v_accvgpr_write_b32 a70, 0
    v_accvgpr_write_b32 a71, 0
    v_accvgpr_write_b32 a72, 0
    v_accvgpr_write_b32 a73, 0
    v_accvgpr_write_b32 a74, 0
    v_accvgpr_write_b32 a75, 0
    v_accvgpr_write_b32 a76, 0
    v_accvgpr_write_b32 a77, 0
    v_accvgpr_write_b32 a78, 0
    v_accvgpr_write_b32 a79, 0
    v_accvgpr_write_b32 a80, 0
    v_accvgpr_write_b32 a81, 0
    v_accvgpr_write_b32 a82, 0
    v_accvgpr_write_b32 a83, 0
    v_accvgpr_write_b32 a84, 0
    v_accvgpr_write_b32 a85, 0
    v_accvgpr_write_b32 a86, 0
    v_accvgpr_write_b32 a87, 0
    v_accvgpr_write_b32 a88, 0
    v_accvgpr_write_b32 a89, 0
    v_accvgpr_write_b32 a90, 0
    v_accvgpr_write_b32 a91, 0
    v_accvgpr_write_b32 a92, 0
    v_accvgpr_write_b32 a93, 0
    v_accvgpr_write_b32 a94, 0
    v_accvgpr_write_b32 a95, 0
    v_accvgpr_write_b32 a96, 0
    v_accvgpr_write_b32 a97, 0
    v_accvgpr_write_b32 a98, 0
    v_accvgpr_write_b32 a99, 0
    v_accvgpr_write_b32 a100, 0
    v_accvgpr_write_b32 a101, 0
    v_accvgpr_write_b32 a102, 0
    v_accvgpr_write_b32 a103, 0
    v_accvgpr_write_b32 a104, 0
    v_accvgpr_write_b32 a105, 0
    v_accvgpr_write_b32 a106, 0
    v_accvgpr_write_b32 a107, 0
    v_accvgpr_write_b32 a108, 0
    v_accvgpr_write_b32 a109, 0
    v_accvgpr_write_b32 a110, 0
    v_accvgpr_write_b32 a111, 0
    v_accvgpr_write_b32 a112, 0
    v_accvgpr_write_b32 a113, 0
    v_accvgpr_write_b32 a114, 0
    v_accvgpr_write_b32 a115, 0
    v_accvgpr_write_b32 a116, 0
    v_accvgpr_write_b32 a117, 0
    v_accvgpr_write_b32 a118, 0
    v_accvgpr_write_b32 a119, 0
    v_accvgpr_write_b32 a120, 0
    v_accvgpr_write_b32 a121, 0
    v_accvgpr_write_b32 a122, 0
    v_accvgpr_write_b32 a123, 0
    v_accvgpr_write_b32 a124, 0
    v_accvgpr_write_b32 a125, 0
    v_accvgpr_write_b32 a126, 0
    v_accvgpr_write_b32 a127, 0
    v_mov_b32 v100, 0
    v_mov_b32 v101, 0
    v_mov_b32 v102, 0
    v_mov_b32 v103, 0
    v_mov_b32 v104, 0
    v_mov_b32 v105, 0
    v_mov_b32 v106, 0
    v_mov_b32 v107, 0
    v_mov_b32 v108, 0
    v_mov_b32 v109, 0
    v_mov_b32 v110, 0
    v_mov_b32 v111, 0
    v_mov_b32 v112, 0
    v_mov_b32 v113, 0
    v_mov_b32 v114, 0
    v_mov_b32 v115, 0
    v_mov_b32 v116, 0
    v_mov_b32 v117, 0
    v_mov_b32 v118, 0
    v_mov_b32 v119, 0
    v_mov_b32 v120, 0
    v_mov_b32 v121, 0
    v_mov_b32 v122, 0
    v_mov_b32 v123, 0
    v_mov_b32 v124, 0
    v_mov_b32 v125, 0
    v_mov_b32 v126, 0
    v_mov_b32 v127, 0
    v_mov_b32 v90, 156692
    v_mov_b32 v91, 1
    s_waitcnt vmcnt(6)
    ds_write_b32 v90, v91
    s_load_dwordx2 s[32:33], s[20:21], 0
    v_lshlrev_b32 v48, 16, v32
    v_and_b32 v49, s60, v32
    v_lshlrev_b32 v50, 16, v33
    v_and_b32 v51, s60, v33
    v_lshlrev_b32 v52, 16, v34
    v_and_b32 v53, s60, v34
    v_lshlrev_b32 v54, 16, v35
    v_and_b32 v55, s60, v35
    v_lshlrev_b32 v56, 16, v36
    v_and_b32 v57, s60, v36
    v_lshlrev_b32 v58, 16, v37
    v_and_b32 v59, s60, v37
    v_lshlrev_b32 v60, 16, v38
    v_and_b32 v61, s60, v38
    v_lshlrev_b32 v62, 16, v39
    v_and_b32 v63, s60, v39
    v_lshlrev_b32 v64, 16, v40
    v_and_b32 v65, s60, v40
    v_lshlrev_b32 v66, 16, v41
    v_and_b32 v67, s60, v41
    v_lshlrev_b32 v68, 16, v42
    v_and_b32 v69, s60, v42
    v_lshlrev_b32 v70, 16, v43
    v_and_b32 v71, s60, v43
    v_lshlrev_b32 v72, 16, v44
    v_and_b32 v73, s60, v44
    v_lshlrev_b32 v74, 16, v45
    v_and_b32 v75, s60, v45
    v_lshlrev_b32 v76, 16, v46
    v_and_b32 v77, s60, v46
    v_lshlrev_b32 v78, 16, v47
    v_and_b32 v79, s60, v47
    v_add_f32 v80, v48, v49
    v_add_f32 v81, v50, v51
    v_add_f32 v80, v80, v52
    v_add_f32 v81, v81, v53
    v_add_f32 v80, v80, v54
    v_add_f32 v81, v81, v55
    v_add_f32 v80, v80, v56
    v_add_f32 v81, v81, v57
    v_add_f32 v80, v80, v58
    v_add_f32 v81, v81, v59
    v_add_f32 v80, v80, v60
    v_add_f32 v81, v81, v61
    v_add_f32 v80, v80, v62
    v_add_f32 v81, v81, v63
    v_add_f32 v80, v80, v64
    v_add_f32 v81, v81, v65
    v_add_f32 v80, v80, v66
    v_add_f32 v81, v81, v67
    v_add_f32 v80, v80, v68
    v_add_f32 v81, v81, v69
    v_add_f32 v80, v80, v70
    v_add_f32 v81, v81, v71
    v_add_f32 v80, v80, v72
    v_add_f32 v81, v81, v73
    v_add_f32 v80, v80, v74
    v_add_f32 v81, v81, v75
    v_add_f32 v80, v80, v76
    v_add_f32 v81, v81, v77
    v_add_f32 v80, v80, v78
    v_add_f32 v81, v81, v79
    v_add_f32 v80, v80, v81
    s_nop 1
    v_add_f32_dpp v80, v80, v80 row_ror:8 row_mask:0xf bank_mask:0xf
    v_mov_b32 v88, v80
    s_nop 1
    v_permlane16_swap_b32 v80, v88
    v_add_f32 v80, v80, v88
    v_mov_b32 v88, v80
    s_nop 1
    v_permlane32_swap_b32 v80, v88
    v_add_f32 v80, v80, v88
    v_mul_f32 v80, 0x3b800000, v80
    v_mov_b32 v81, 0
    v_mov_b32 v83, 0
    v_sub_f32 v82, v48, v80
    v_sub_f32 v84, v49, v80
    v_fmac_f32 v81, v82, v82
    v_fmac_f32 v83, v84, v84
    v_sub_f32 v82, v50, v80
    v_sub_f32 v84, v51, v80
    v_fmac_f32 v81, v82, v82
    v_fmac_f32 v83, v84, v84
    v_sub_f32 v82, v52, v80
    v_sub_f32 v84, v53, v80
    v_fmac_f32 v81, v82, v82
    v_fmac_f32 v83, v84, v84
    v_sub_f32 v82, v54, v80
    v_sub_f32 v84, v55, v80
    v_fmac_f32 v81, v82, v82
    v_fmac_f32 v83, v84, v84
    v_sub_f32 v82, v56, v80
    v_sub_f32 v84, v57, v80
    v_fmac_f32 v81, v82, v82
    v_fmac_f32 v83, v84, v84
    v_sub_f32 v82, v58, v80
    v_sub_f32 v84, v59, v80
    v_fmac_f32 v81, v82, v82
    v_fmac_f32 v83, v84, v84
    v_sub_f32 v82, v60, v80
    v_sub_f32 v84, v61, v80
    v_fmac_f32 v81, v82, v82
    v_fmac_f32 v83, v84, v84
    v_sub_f32 v82, v62, v80
    v_sub_f32 v84, v63, v80
    v_fmac_f32 v81, v82, v82
    v_fmac_f32 v83, v84, v84
    v_sub_f32 v82, v64, v80
    v_sub_f32 v84, v65, v80
    v_fmac_f32 v81, v82, v82
    v_fmac_f32 v83, v84, v84
    v_sub_f32 v82, v66, v80
    v_sub_f32 v84, v67, v80
    v_fmac_f32 v81, v82, v82
    v_fmac_f32 v83, v84, v84
    v_sub_f32 v82, v68, v80
    v_sub_f32 v84, v69, v80
    v_fmac_f32 v81, v82, v82
    v_fmac_f32 v83, v84, v84
    v_sub_f32 v82, v70, v80
    v_sub_f32 v84, v71, v80
    v_fmac_f32 v81, v82, v82
    v_fmac_f32 v83, v84, v84
    v_sub_f32 v82, v72, v80
    v_sub_f32 v84, v73, v80
    v_fmac_f32 v81, v82, v82
    v_fmac_f32 v83, v84, v84
    v_sub_f32 v82, v74, v80
    v_sub_f32 v84, v75, v80
    v_fmac_f32 v81, v82, v82
    v_fmac_f32 v83, v84, v84
    v_sub_f32 v82, v76, v80
    v_sub_f32 v84, v77, v80
    v_fmac_f32 v81, v82, v82
    v_fmac_f32 v83, v84, v84
    v_sub_f32 v82, v78, v80
    v_sub_f32 v84, v79, v80
    v_fmac_f32 v81, v82, v82
    v_fmac_f32 v83, v84, v84
    v_add_f32 v81, v81, v83
    s_nop 1
    v_add_f32_dpp v81, v81, v81 row_ror:8 row_mask:0xf bank_mask:0xf
    v_mov_b32 v88, v81
    s_nop 1
    v_permlane16_swap_b32 v81, v88
    v_add_f32 v81, v81, v88
    v_mov_b32 v88, v81
    s_nop 1
    v_permlane32_swap_b32 v81, v88
    v_add_f32 v81, v81, v88
    ds_write_b64 v30, v[80:81]
    v_mov_b32 v90, 156688
    v_mov_b32 v91, 1
    s_mov_b64 exec, 1
    ds_add_u32 v90, v91
    s_mov_b64 exec, -1
    s_mov_b32 s31, 1048576
    L_lnsync:
    ds_read_b32 v91, v90
    s_waitcnt lgkmcnt(0)
    v_cmp_gt_u32 vcc, 4, v91
    s_sub_u32 s31, s31, 1
    s_cbranch_scc1 L_lnsyncd
    s_cbranch_vccnz L_lnsync
    L_lnsyncd:
    ds_read_b128 v[92:95], v31
    ds_read_b128 v[96:99], v31 offset:16
    s_waitcnt lgkmcnt(0)
    v_add_f32 v80, v92, v94
    v_add_f32 v81, v96, v98
    v_add_f32 v80, v80, v81
    v_mul_f32 v80, 0.5, v80
    v_mul_f32 v80, 0.5, v80
    v_add_f32 v82, v93, v95
    v_add_f32 v83, v97, v99
    v_add_f32 v82, v82, v83
    v_sub_f32 v92, v92, v80
    v_sub_f32 v94, v94, v80
    v_sub_f32 v96, v96, v80
    v_sub_f32 v98, v98, v80
    v_mul_f32 v83, v92, v92
    v_fmac_f32 v83, v94, v94
    v_fmac_f32 v83, v96, v96
    v_fmac_f32 v83, v98, v98
    v_mul_f32 v83, 0x43800000, v83
    v_add_f32 v82, v82, v83
    v_mul_f32 v82, 0x3a800000, v82
    v_cvt_pk_bf16_f32 v80, v80, v82
    v_and_b32 v82, s60, v80
    v_lshlrev_b32 v80, 16, v80
    v_add_f32 v82, 0x3727c5ac, v82
    v_cvt_pk_bf16_f32 v82, v82, v82
    v_and_b32 v82, s60, v82
    v_sqrt_f32 v82, v82
    s_nop 0
    v_cvt_pk_bf16_f32 v82, v82, v82
    v_and_b32 v82, s60, v82
    v_lshrrev_b32 v84, 16, v80
    v_or_b32 v84, v84, v82
    v_rcp_f32 v82, v82
    s_waitcnt lgkmcnt(0)
    s_mov_b32 s31, 131072
L_mega_kernel_nl_5:
    s_cmp_lg_u32 s32, 0
    s_cbranch_scc1 L_mega_kernel_nok_6
    buffer_load_dwordx2 v[10:11], v28, s[44:47], 0 offen sc1
    s_waitcnt vmcnt(0)
    v_readfirstlane_b32 s32, v10
    v_readfirstlane_b32 s33, v11
    s_sub_u32 s31, s31, 1
    s_cbranch_scc0 L_mega_kernel_nl_5
L_mega_kernel_nok_6:
    s_cmp_lg_u32 s28, 0
    s_cbranch_scc1 L_nost
    v_mov_b32 v85, s32
    s_mov_b32 s34, 42074112
    s_mov_b64 exec, 0xff
    buffer_store_dwordx2 v[84:85], v27, s[24:27], s34 offen sc1
    s_mov_b64 exec, -1
    L_nost:
    v_sub_f32 v48, v48, v80
    v_sub_f32 v49, v49, v80
    v_cvt_pk_bf16_f32 v32, v48, v49
    v_sub_f32 v50, v50, v80
    v_sub_f32 v51, v51, v80
    v_cvt_pk_bf16_f32 v33, v50, v51
    v_sub_f32 v52, v52, v80
    v_sub_f32 v53, v53, v80
    v_cvt_pk_bf16_f32 v34, v52, v53
    v_sub_f32 v54, v54, v80
    v_sub_f32 v55, v55, v80
    v_cvt_pk_bf16_f32 v35, v54, v55
    v_lshlrev_b32 v48, 16, v32
    v_and_b32 v49, s60, v32
    v_mul_f32 v48, v48, v82
    v_mul_f32 v49, v49, v82
    v_cvt_pk_bf16_f32 v32, v48, v49
    v_lshlrev_b32 v50, 16, v33
    v_and_b32 v51, s60, v33
    v_mul_f32 v50, v50, v82
    v_mul_f32 v51, v51, v82
    v_cvt_pk_bf16_f32 v33, v50, v51
    v_lshlrev_b32 v52, 16, v34
    v_and_b32 v53, s60, v34
    v_mul_f32 v52, v52, v82
    v_mul_f32 v53, v53, v82
    v_cvt_pk_bf16_f32 v34, v52, v53
    v_lshlrev_b32 v54, 16, v35
    v_and_b32 v55, s60, v35
    v_mul_f32 v54, v54, v82
    v_mul_f32 v55, v55, v82
    v_cvt_pk_bf16_f32 v35, v54, v55
    buffer_store_dwordx4 v[32:35], v29, s[24:27], 0 offen sc1
    v_sub_f32 v56, v56, v80
    v_sub_f32 v57, v57, v80
    v_cvt_pk_bf16_f32 v36, v56, v57
    v_sub_f32 v58, v58, v80
    v_sub_f32 v59, v59, v80
    v_cvt_pk_bf16_f32 v37, v58, v59
    v_sub_f32 v60, v60, v80
    v_sub_f32 v61, v61, v80
    v_cvt_pk_bf16_f32 v38, v60, v61
    v_sub_f32 v62, v62, v80
    v_sub_f32 v63, v63, v80
    v_cvt_pk_bf16_f32 v39, v62, v63
    v_lshlrev_b32 v56, 16, v36
    v_and_b32 v57, s60, v36
    v_mul_f32 v56, v56, v82
    v_mul_f32 v57, v57, v82
    v_cvt_pk_bf16_f32 v36, v56, v57
    v_lshlrev_b32 v58, 16, v37
    v_and_b32 v59, s60, v37
    v_mul_f32 v58, v58, v82
    v_mul_f32 v59, v59, v82
    v_cvt_pk_bf16_f32 v37, v58, v59
    v_lshlrev_b32 v60, 16, v38
    v_and_b32 v61, s60, v38
    v_mul_f32 v60, v60, v82
    v_mul_f32 v61, v61, v82
    v_cvt_pk_bf16_f32 v38, v60, v61
    v_lshlrev_b32 v62, 16, v39
    v_and_b32 v63, s60, v39
    v_mul_f32 v62, v62, v82
    v_mul_f32 v63, v63, v82
    v_cvt_pk_bf16_f32 v39, v62, v63
    buffer_store_dwordx4 v[36:39], v29, s[24:27], s61 offen sc1
    v_sub_f32 v64, v64, v80
    v_sub_f32 v65, v65, v80
    v_cvt_pk_bf16_f32 v40, v64, v65
    v_sub_f32 v66, v66, v80
    v_sub_f32 v67, v67, v80
    v_cvt_pk_bf16_f32 v41, v66, v67
    v_sub_f32 v68, v68, v80
    v_sub_f32 v69, v69, v80
    v_cvt_pk_bf16_f32 v42, v68, v69
    v_sub_f32 v70, v70, v80
    v_sub_f32 v71, v71, v80
    v_cvt_pk_bf16_f32 v43, v70, v71
    v_lshlrev_b32 v64, 16, v40
    v_and_b32 v65, s60, v40
    v_mul_f32 v64, v64, v82
    v_mul_f32 v65, v65, v82
    v_cvt_pk_bf16_f32 v40, v64, v65
    v_lshlrev_b32 v66, 16, v41
    v_and_b32 v67, s60, v41
    v_mul_f32 v66, v66, v82
    v_mul_f32 v67, v67, v82
    v_cvt_pk_bf16_f32 v41, v66, v67
    v_lshlrev_b32 v68, 16, v42
    v_and_b32 v69, s60, v42
    v_mul_f32 v68, v68, v82
    v_mul_f32 v69, v69, v82
    v_cvt_pk_bf16_f32 v42, v68, v69
    v_lshlrev_b32 v70, 16, v43
    v_and_b32 v71, s60, v43
    v_mul_f32 v70, v70, v82
    v_mul_f32 v71, v71, v82
    v_cvt_pk_bf16_f32 v43, v70, v71
    buffer_store_dwordx4 v[40:43], v29, s[24:27], s62 offen sc1
    v_sub_f32 v72, v72, v80
    v_sub_f32 v73, v73, v80
    v_cvt_pk_bf16_f32 v44, v72, v73
    v_sub_f32 v74, v74, v80
    v_sub_f32 v75, v75, v80
    v_cvt_pk_bf16_f32 v45, v74, v75
    v_sub_f32 v76, v76, v80
    v_sub_f32 v77, v77, v80
    v_cvt_pk_bf16_f32 v46, v76, v77
    v_sub_f32 v78, v78, v80
    v_sub_f32 v79, v79, v80
    v_cvt_pk_bf16_f32 v47, v78, v79
    v_lshlrev_b32 v72, 16, v44
    v_and_b32 v73, s60, v44
    v_mul_f32 v72, v72, v82
    v_mul_f32 v73, v73, v82
    v_cvt_pk_bf16_f32 v44, v72, v73
    v_lshlrev_b32 v74, 16, v45
    v_and_b32 v75, s60, v45
    v_mul_f32 v74, v74, v82
    v_mul_f32 v75, v75, v82
    v_cvt_pk_bf16_f32 v45, v74, v75
    v_lshlrev_b32 v76, 16, v46
    v_and_b32 v77, s60, v46
    v_mul_f32 v76, v76, v82
    v_mul_f32 v77, v77, v82
    v_cvt_pk_bf16_f32 v46, v76, v77
    v_lshlrev_b32 v78, 16, v47
    v_and_b32 v79, s60, v47
    v_mul_f32 v78, v78, v82
    v_mul_f32 v79, v79, v82
    v_cvt_pk_bf16_f32 v47, v78, v79
    buffer_store_dwordx4 v[44:47], v29, s[24:27], s63 offen sc1
    v_mov_b32 v48, 0
    v_mov_b32 v49, 0
    v_mov_b32 v50, 0
    v_mov_b32 v51, 0
    v_mov_b32 v52, 0
    v_mov_b32 v53, 0
    v_mov_b32 v54, 0
    v_mov_b32 v55, 0
    v_mov_b32 v56, 0
    v_mov_b32 v57, 0
    v_mov_b32 v58, 0
    v_mov_b32 v59, 0
    v_mov_b32 v60, 0
    v_mov_b32 v61, 0
    v_mov_b32 v62, 0
    v_mov_b32 v63, 0
    v_mov_b32 v64, 0
    v_mov_b32 v65, 0
    v_mov_b32 v66, 0
    v_mov_b32 v67, 0
    v_mov_b32 v68, 0
    v_mov_b32 v69, 0
    v_mov_b32 v70, 0
    v_mov_b32 v71, 0
    v_mov_b32 v72, 0
    v_mov_b32 v73, 0
    v_mov_b32 v74, 0
    v_mov_b32 v75, 0
    v_mov_b32 v76, 0
    v_mov_b32 v77, 0
    v_mov_b32 v78, 0
    v_mov_b32 v79, 0
    v_mov_b32 v80, 0
    v_mov_b32 v81, 0
    v_mov_b32 v82, 0
    v_mov_b32 v83, 0
    v_mov_b32 v84, 0
    v_mov_b32 v85, 0
    v_mov_b32 v86, 0
    v_mov_b32 v87, 0
    v_mov_b32 v88, 0
    v_mov_b32 v89, 0
    v_mov_b32 v90, 0
    v_mov_b32 v91, 0
    v_mov_b32 v92, 0
    v_mov_b32 v93, 0
    v_mov_b32 v94, 0
    v_mov_b32 v95, 0
    v_mov_b32 v96, 0
    v_mov_b32 v97, 0
    v_mov_b32 v98, 0
    v_mov_b32 v99, 0
    v_mov_b32 v32, 0
    v_mov_b32 v33, 0
    v_mov_b32 v34, 0
    v_mov_b32 v35, 0
    v_mov_b32 v36, 0
    v_mov_b32 v37, 0
    v_mov_b32 v38, 0
    v_mov_b32 v39, 0
    v_mov_b32 v40, 0
    v_mov_b32 v41, 0
    v_mov_b32 v42, 0
    v_mov_b32 v43, 0
    v_mov_b32 v44, 0
    v_mov_b32 v45, 0
    v_mov_b32 v46, 0
    v_mov_b32 v47, 0
    v_and_b32 v15, 7, v1
    v_lshlrev_b32 v15, 3, v15
    s_lshl_b32 s37, s29, 2
    s_add_u32 s37, s37, s28
    s_lshl_b32 s37, s37, 6
    s_add_u32 s37, s37, 41943040
    s_waitcnt vmcnt(4)
    s_waitcnt vmcnt(0)
    v_mov_b32 v12, 156672
    v_mov_b32 v13, 1
    s_mov_b64 exec, 1
    ds_add_rtn_u32 v14, v12, v13
    s_mov_b64 exec, -1
    s_lshl_b32 s34, s29, 5
    s_add_u32 s34, s34, s30
    s_lshl_b32 s34, s34, 3
    s_add_u32 s34, s34, 41943040
    s_waitcnt lgkmcnt(0)
    v_readfirstlane_b32 s35, v14
    s_cmp_lg_u32 s35, 3
    s_cbranch_scc1 L_mega_kernel_na_7
    v_mov_b32 v12, s32
    v_mov_b32 v13, s33
    v_mov_b32 v14, 0
    s_mov_b64 exec, 1
    buffer_store_dwordx2 v[12:13], v14, s[24:27], s34 offen sc1
    s_mov_b64 exec, -1
L_mega_kernel_na_7:
    s_mov_b32 s77, 12288
    s_mov_b32 s58, 0
    s_barrier
    s_branch L_g1_H0
L_p0_h1:
    v_mov_b32 v25, 156672
    v_mov_b32 v12, 0
    v_mov_b32 v13, 0
    v_mov_b32 v14, 0
    v_mov_b32 v15, 0
    ds_write_b128 v25, v[12:15]
    ds_write_b128 v25, v[12:15] offset:16
    ds_write_b128 v25, v[12:15] offset:32
    ds_write_b128 v25, v[12:15] offset:48
    s_waitcnt lgkmcnt(0)
    s_barrier
    s_cmp_eq_u32 s28, 7
    s_cbranch_scc1 L_p0_pf
    s_mov_b32 s24, s22
    s_and_b32 s25, s23, 0xffff
    s_mov_b32 s26, 83886080
    s_mov_b32 s27, 0x00020000
    s_mov_b32 s44, s20
    s_and_b32 s45, s21, 0xffff
    s_mov_b32 s46, 256
    s_mov_b32 s47, 0x00020000
    s_lshl_b32 s38, s28, 2
    s_sub_u32 s38, s38, 8
    v_lshrrev_b32 v14, 4, v1
    v_bfe_u32 v15, v1, 3, 1
    v_bfe_u32 v16, v1, 1, 2
    v_lshl_add_u32 v15, v15, 3, v16
    v_and_b32 v16, 1, v1
    v_lshlrev_b32 v16, 4, v16
    s_lshl_b32 s73, s38, 10
    s_add_u32 s72, s73, 61440
    s_add_u32 s74, s73, 102400
    s_mul_i32 s37, s30, 224
    s_lshl_b32 s39, s30, 6
    s_add_u32 s34, s38, 0
    s_cmp_lt_u32 s34, 6
    s_cbranch_scc1 L_mega_kernel_dq_8
    s_cmp_lt_u32 s34, 13
    s_cselect_b32 s48, s12, s14
    s_cselect_b32 s49, s13, s15
    s_cselect_b32 s35, 6, 13
    s_sub_u32 s34, s34, s35
    s_lshl_b32 s34, s34, 2
    v_add_u32 v17, s34, v14
    v_mul_u32_u24 v18, 37, v17
    v_lshrrev_b32 v18, 8, v18
    v_mul_u32_u24 v19, 7, v18
    v_sub_u32 v17, v17, v19
    s_mov_b32 s50, 7340032
    s_movk_i32 s36, 7168
    v_lshlrev_b32 v17, 5, v17
    v_add_u32 v17, s37, v17
    s_branch L_mega_kernel_dd_9
L_mega_kernel_dq_8:
    s_mov_b32 s48, s6
    s_mov_b32 s49, s7
    s_mov_b32 s50, 6291456
    s_movk_i32 s36, 6144
    s_lshl_b32 s34, s34, 2
    v_add_u32 v17, s34, v14
    v_mul_u32_u24 v18, 43, v17
    v_lshrrev_b32 v18, 8, v18
    v_mul_u32_u24 v19, 6, v18
    v_sub_u32 v17, v17, v19
    v_lshrrev_b32 v19, 1, v17
    v_and_b32 v17, 1, v17
    v_lshlrev_b32 v17, 5, v17
    v_lshl_add_u32 v17, v19, 11, v17
    v_add_u32 v17, s39, v17
L_mega_kernel_dd_9:
    s_and_b32 s49, s49, 0xffff
    s_mov_b32 s51, 0x00020000
    v_and_b32 v19, 1, v18
    v_lshrrev_b32 v18, 1, v18
    v_lshl_add_u32 v19, v19, 2, v15
    v_lshl_add_u32 v19, v18, 4, v19
    v_mul_lo_u32 v19, v19, s36
    v_add3_u32 v3, v19, v17, v16
    s_lshl_b32 s68, s36, 5
    s_mov_b32 s64, 0
    s_add_u32 s34, s38, 1
    s_cmp_lt_u32 s34, 6
    s_cbranch_scc1 L_mega_kernel_dq_10
    s_cmp_lt_u32 s34, 13
    s_cselect_b32 s52, s12, s14
    s_cselect_b32 s53, s13, s15
    s_cselect_b32 s35, 6, 13
    s_sub_u32 s34, s34, s35
    s_lshl_b32 s34, s34, 2
    v_add_u32 v17, s34, v14
    v_mul_u32_u24 v18, 37, v17
    v_lshrrev_b32 v18, 8, v18
    v_mul_u32_u24 v19, 7, v18
    v_sub_u32 v17, v17, v19
    s_mov_b32 s54, 7340032
    s_movk_i32 s36, 7168
    v_lshlrev_b32 v17, 5, v17
    v_add_u32 v17, s37, v17
    s_branch L_mega_kernel_dd_11
L_mega_kernel_dq_10:
    s_mov_b32 s52, s6
    s_mov_b32 s53, s7
    s_mov_b32 s54, 6291456
    s_movk_i32 s36, 6144
    s_lshl_b32 s34, s34, 2
    v_add_u32 v17, s34, v14
    v_mul_u32_u24 v18, 43, v17
    v_lshrrev_b32 v18, 8, v18
    v_mul_u32_u24 v19, 6, v18
    v_sub_u32 v17, v17, v19
    v_lshrrev_b32 v19, 1, v17
    v_and_b32 v17, 1, v17
    v_lshlrev_b32 v17, 5, v17
    v_lshl_add_u32 v17, v19, 11, v17
    v_add_u32 v17, s39, v17
L_mega_kernel_dd_11:
    s_and_b32 s53, s53, 0xffff
    s_mov_b32 s55, 0x00020000
    v_and_b32 v19, 1, v18
    v_lshrrev_b32 v18, 1, v18
    v_lshl_add_u32 v19, v19, 2, v15
    v_lshl_add_u32 v19, v18, 4, v19
    v_mul_lo_u32 v19, v19, s36
    v_add3_u32 v4, v19, v17, v16
    s_lshl_b32 s69, s36, 5
    s_mov_b32 s65, 0
    s_add_u32 s34, s38, 2
    s_cmp_lt_u32 s34, 6
    s_cbranch_scc1 L_mega_kernel_dq_12
    s_cmp_lt_u32 s34, 13
    s_cselect_b32 s56, s12, s14
    s_cselect_b32 s57, s13, s15
    s_cselect_b32 s35, 6, 13
    s_sub_u32 s34, s34, s35
    s_lshl_b32 s34, s34, 2
    v_add_u32 v17, s34, v14
    v_mul_u32_u24 v18, 37, v17
    v_lshrrev_b32 v18, 8, v18
    v_mul_u32_u24 v19, 7, v18
    v_sub_u32 v17, v17, v19
    s_mov_b32 s58, 7340032
    s_movk_i32 s36, 7168
    v_lshlrev_b32 v17, 5, v17
    v_add_u32 v17, s37, v17
    s_branch L_mega_kernel_dd_13
L_mega_kernel_dq_12:
    s_mov_b32 s56, s6
    s_mov_b32 s57, s7
    s_mov_b32 s58, 6291456
    s_movk_i32 s36, 6144
    s_lshl_b32 s34, s34, 2
    v_add_u32 v17, s34, v14
    v_mul_u32_u24 v18, 43, v17
    v_lshrrev_b32 v18, 8, v18
    v_mul_u32_u24 v19, 6, v18
    v_sub_u32 v17, v17, v19
    v_lshrrev_b32 v19, 1, v17
    v_and_b32 v17, 1, v17
    v_lshlrev_b32 v17, 5, v17
    v_lshl_add_u32 v17, v19, 11, v17
    v_add_u32 v17, s39, v17
L_mega_kernel_dd_13:
    s_and_b32 s57, s57, 0xffff
    s_mov_b32 s59, 0x00020000
    v_and_b32 v19, 1, v18
    v_lshrrev_b32 v18, 1, v18
    v_lshl_add_u32 v19, v19, 2, v15
    v_lshl_add_u32 v19, v18, 4, v19
    v_mul_lo_u32 v19, v19, s36
    v_add3_u32 v5, v19, v17, v16
    s_lshl_b32 s70, s36, 5
    s_mov_b32 s66, 0
    s_add_u32 s34, s38, 3
    s_cmp_lt_u32 s34, 6
    s_cbranch_scc1 L_mega_kernel_dq_14
    s_cmp_lt_u32 s34, 13
    s_cselect_b32 s60, s12, s14
    s_cselect_b32 s61, s13, s15
    s_cselect_b32 s35, 6, 13
    s_sub_u32 s34, s34, s35
    s_lshl_b32 s34, s34, 2
    v_add_u32 v17, s34, v14
    v_mul_u32_u24 v18, 37, v17
    v_lshrrev_b32 v18, 8, v18
    v_mul_u32_u24 v19, 7, v18
    v_sub_u32 v17, v17, v19
    s_mov_b32 s62, 7340032
    s_movk_i32 s36, 7168
    v_lshlrev_b32 v17, 5, v17
    v_add_u32 v17, s37, v17
    s_branch L_mega_kernel_dd_15
L_mega_kernel_dq_14:
    s_mov_b32 s60, s6
    s_mov_b32 s61, s7
    s_mov_b32 s62, 6291456
    s_movk_i32 s36, 6144
    s_lshl_b32 s34, s34, 2
    v_add_u32 v17, s34, v14
    v_mul_u32_u24 v18, 43, v17
    v_lshrrev_b32 v18, 8, v18
    v_mul_u32_u24 v19, 6, v18
    v_sub_u32 v17, v17, v19
    v_lshrrev_b32 v19, 1, v17
    v_and_b32 v17, 1, v17
    v_lshlrev_b32 v17, 5, v17
    v_lshl_add_u32 v17, v19, 11, v17
    v_add_u32 v17, s39, v17
L_mega_kernel_dd_15:
    s_and_b32 s61, s61, 0xffff
    s_mov_b32 s63, 0x00020000
    v_and_b32 v19, 1, v18
    v_lshrrev_b32 v18, 1, v18
    v_lshl_add_u32 v19, v19, 2, v15
    v_lshl_add_u32 v19, v18, 4, v19
    v_mul_lo_u32 v19, v19, s36
    v_add3_u32 v6, v19, v17, v16
    s_lshl_b32 s71, s36, 5
    s_mov_b32 s67, 0
    s_add_u32 m0, s72, 0
    s_nop 0
    buffer_load_dwordx4 v3, s[48:51], s64 offen lds
    s_add_u32 s64, s64, s68
    s_add_u32 m0, s72, 1024
    s_nop 0
    buffer_load_dwordx4 v4, s[52:55], s65 offen lds
    s_add_u32 s65, s65, s69
    s_add_u32 m0, s72, 2048
    s_nop 0
    buffer_load_dwordx4 v5, s[56:59], s66 offen lds
    s_add_u32 s66, s66, s70
    s_add_u32 m0, s72, 3072
    s_nop 0
    buffer_load_dwordx4 v6, s[60:63], s67 offen lds
    s_add_u32 s67, s67, s71
    s_add_u32 s72, s72, 20480
    s_cmp_ge_u32 s72, s74
    s_cselect_b32 s72, s73, s72
    v_mov_b32 v29, 156692
    s_mov_b32 s31, 1048576
    L_mega_kernel_rw_16:
    ds_read_b32 v30, v29
    s_waitcnt lgkmcnt(0)
    v_cmp_eq_u32 vcc, 0, v30
    s_sub_u32 s31, s31, 1
    s_cbranch_scc1 L_mega_kernel_rwd_17
    s_cbranch_vccnz L_mega_kernel_rw_16
    L_mega_kernel_rwd_17:
    s_mov_b32 s40, s4
    s_and_b32 s41, s5, 0xffff
    s_mov_b32 s42, 4194304
    s_mov_b32 s43, 0x00020000
    v_lshrrev_b32 v29, 2, v1
    v_and_b32 v30, 3, v1
    v_lshlrev_b32 v31, 11, v29
    v_lshl_add_u32 v31, v30, 4, v31
    s_lshl_b32 s34, s29, 2
    s_and_b32 s35, s28, 3
    s_add_u32 s34, s34, s35
    s_lshl_b32 s39, s34, 9
    s_lshl_b32 s34, s34, 17
    buffer_load_dwordx4 v[32:35], v31, s[40:43], s34 offen offset:0
    buffer_load_dwordx4 v[48:51], v31, s[40:43], s34 offen offset:64
    buffer_load_dwordx4 v[64:67], v31, s[40:43], s34 offen offset:128
    buffer_load_dwordx4 v[80:83], v31, s[40:43], s34 offen offset:192
    s_add_u32 s34, s34, 32768
    buffer_load_dwordx4 v[36:39], v31, s[40:43], s34 offen offset:0
    buffer_load_dwordx4 v[52:55], v31, s[40:43], s34 offen offset:64
    buffer_load_dwordx4 v[68:71], v31, s[40:43], s34 offen offset:128
    buffer_load_dwordx4 v[84:87], v31, s[40:43], s34 offen offset:192
    s_add_u32 s34, s34, 32768
    buffer_load_dwordx4 v[40:43], v31, s[40:43], s34 offen offset:0
    buffer_load_dwordx4 v[56:59], v31, s[40:43], s34 offen offset:64
    buffer_load_dwordx4 v[72:75], v31, s[40:43], s34 offen offset:128
    buffer_load_dwordx4 v[88:91], v31, s[40:43], s34 offen offset:192
    s_add_u32 s34, s34, 32768
    buffer_load_dwordx4 v[44:47], v31, s[40:43], s34 offen offset:0
    buffer_load_dwordx4 v[60:63], v31, s[40:43], s34 offen offset:64
    buffer_load_dwordx4 v[76:79], v31, s[40:43], s34 offen offset:128
    buffer_load_dwordx4 v[92:95], v31, s[40:43], s34 offen offset:192
    s_add_u32 s78, s39, 42074112
    s_and_b32 s34, s28, 3
    s_lshl_b32 s35, s29, 2
    s_add_u32 s35, s34, s35
    s_lshl_b32 s35, s35, 17
    s_add_u32 s40, s22, s35
    s_addc_u32 s41, s23, 0
    s_and_b32 s41, s41, 0xffff
    s_mov_b32 s42, 131072
    s_mov_b32 s43, 0x00020000
    s_mov_b32 s77, 0
    s_mov_b32 s75, 61440
    s_lshl_b32 s34, s34, 12
    s_add_u32 s34, s34, 102400
    s_mov_b32 s79, 0
    s_mov_b32 s3, s34
    s_mov_b32 s80, 0
    s_mov_b32 s82, 20480
    s_mov_b32 s83, 16384
    v_add_u32 v9, s34, v2
    v_lshrrev_b32 v12, 5, v1
    v_and_b32 v13, 31, v1
    v_lshlrev_b32 v13, 3, v13
    v_add_u32 v13, 61440, v13
    v_mul_u32_u24 v7, 3072, v12
    v_mul_u32_u24 v8, 3584, v12
    v_add_u32 v7, v7, v13
    v_add_u32 v8, v8, v13
    v_accvgpr_write_b32 a64, 0
    v_accvgpr_write_b32 a65, 0
    v_accvgpr_write_b32 a66, 0
    v_accvgpr_write_b32 a67, 0
    v_accvgpr_write_b32 a68, 0
    v_accvgpr_write_b32 a69, 0
    v_accvgpr_write_b32 a70, 0
    v_accvgpr_write_b32 a71, 0
    v_accvgpr_write_b32 a72, 0
    v_accvgpr_write_b32 a73, 0
    v_accvgpr_write_b32 a74, 0
    v_accvgpr_write_b32 a75, 0
    v_accvgpr_write_b32 a76, 0
    v_accvgpr_write_b32 a77, 0
    v_accvgpr_write_b32 a78, 0
    v_accvgpr_write_b32 a79, 0
    v_accvgpr_write_b32 a80, 0
    v_accvgpr_write_b32 a81, 0
    v_accvgpr_write_b32 a82, 0
    v_accvgpr_write_b32 a83, 0
    v_accvgpr_write_b32 a84, 0
    v_accvgpr_write_b32 a85, 0
    v_accvgpr_write_b32 a86, 0
    v_accvgpr_write_b32 a87, 0
    v_accvgpr_write_b32 a88, 0
    v_accvgpr_write_b32 a89, 0
    v_accvgpr_write_b32 a90, 0
    v_accvgpr_write_b32 a91, 0
    v_accvgpr_write_b32 a92, 0
    v_accvgpr_write_b32 a93, 0
    v_accvgpr_write_b32 a94, 0
    v_accvgpr_write_b32 a95, 0
    v_accvgpr_write_b32 a96, 0
    v_accvgpr_write_b32 a97, 0
    v_accvgpr_write_b32 a98, 0
    v_accvgpr_write_b32 a99, 0
    v_accvgpr_write_b32 a100, 0
    v_accvgpr_write_b32 a101, 0
    v_accvgpr_write_b32 a102, 0
    v_accvgpr_write_b32 a103, 0
    v_accvgpr_write_b32 a104, 0
    v_accvgpr_write_b32 a105, 0
    v_accvgpr_write_b32 a106, 0
    v_accvgpr_write_b32 a107, 0
    v_accvgpr_write_b32 a108, 0
    v_accvgpr_write_b32 a109, 0
    v_accvgpr_write_b32 a110, 0
    v_accvgpr_write_b32 a111, 0
    v_accvgpr_write_b32 a112, 0
    v_accvgpr_write_b32 a113, 0
    v_accvgpr_write_b32 a114, 0
    v_accvgpr_write_b32 a115, 0
    v_accvgpr_write_b32 a116, 0
    v_accvgpr_write_b32 a117, 0
    v_accvgpr_write_b32 a118, 0
    v_accvgpr_write_b32 a119, 0
    v_accvgpr_write_b32 a120, 0
    v_accvgpr_write_b32 a121, 0
    v_accvgpr_write_b32 a122, 0
    v_accvgpr_write_b32 a123, 0
    v_accvgpr_write_b32 a124, 0
    v_accvgpr_write_b32 a125, 0
    v_accvgpr_write_b32 a126, 0
    v_accvgpr_write_b32 a127, 0
    v_mov_b32 v96, 0
    v_mov_b32 v97, 0
    v_mov_b32 v98, 0
    v_mov_b32 v99, 0
    v_mov_b32 v100, 0
    v_mov_b32 v101, 0
    v_mov_b32 v102, 0
    v_mov_b32 v103, 0
    v_mov_b32 v104, 0
    v_mov_b32 v105, 0
    v_mov_b32 v106, 0
    v_mov_b32 v107, 0
    v_mov_b32 v108, 0
    v_mov_b32 v109, 0
    v_mov_b32 v110, 0
    v_mov_b32 v111, 0
    s_load_dwordx2 s[32:33], s[20:21], 0
    s_waitcnt lgkmcnt(0)
    s_mov_b32 s31, 131072
L_mega_kernel_nl_20:
    s_cmp_lg_u32 s32, 0
    s_cbranch_scc1 L_mega_kernel_nok_21
    buffer_load_dwordx2 v[10:11], v28, s[44:47], 0 offen sc1
    s_waitcnt vmcnt(0)
    v_readfirstlane_b32 s32, v10
    v_readfirstlane_b32 s33, v11
    s_sub_u32 s31, s31, 1
    s_cbranch_scc0 L_mega_kernel_nl_20
L_mega_kernel_nok_21:
    v_lshlrev_b32 v31, 3, v29
    v_lshlrev_b32 v28, 8, v30
    v_lshl_add_u32 v28, v29, 4, v28
    v_add_u32 v28, s3, v28
    s_mov_b32 s39, 0xffff0000
    s_mov_b32 s31, 131072
L_mega_kernel_stp_18:
    buffer_load_dwordx2 v[112:113], v31, s[24:27], s78 offen offset:0 sc1
    buffer_load_dwordx2 v[116:117], v31, s[24:27], s78 offen offset:128 sc1
    buffer_load_dwordx2 v[120:121], v31, s[24:27], s78 offen offset:256 sc1
    buffer_load_dwordx2 v[124:125], v31, s[24:27], s78 offen offset:384 sc1
    s_waitcnt vmcnt(0)
    v_xor_b32 v12, s32, v113
    v_xor_b32 v13, s32, v117
    v_xor_b32 v14, s32, v121
    v_xor_b32 v15, s32, v125
    v_or3_b32 v12, v12, v13, v14
    v_or_b32 v12, v12, v15
    v_cmp_ne_u32 vcc, 0, v12
    s_sub_u32 s31, s31, 1
    s_cbranch_scc1 L_mega_kernel_std_19
    s_cbranch_vccnz L_mega_kernel_stp_18
L_mega_kernel_std_19:
    s_add_u32 m0, s72, 0
    s_nop 0
    buffer_load_dwordx4 v3, s[48:51], s64 offen lds
    s_add_u32 s64, s64, s68
    s_add_u32 m0, s72, 1024
    s_nop 0
    buffer_load_dwordx4 v4, s[52:55], s65 offen lds
    s_add_u32 s65, s65, s69
    s_add_u32 m0, s72, 2048
    s_nop 0
    buffer_load_dwordx4 v5, s[56:59], s66 offen lds
    s_add_u32 s66, s66, s70
    s_add_u32 m0, s72, 3072
    s_nop 0
    buffer_load_dwordx4 v6, s[60:63], s67 offen lds
    s_add_u32 s67, s67, s71
    s_add_u32 s72, s72, 20480
    s_cmp_ge_u32 s72, s74
    s_cselect_b32 s72, s73, s72
    s_add_u32 m0, s72, 0
    s_nop 0
    buffer_load_dwordx4 v3, s[48:51], s64 offen lds
    s_add_u32 s64, s64, s68
    s_add_u32 m0, s72, 1024
    s_nop 0
    buffer_load_dwordx4 v4, s[52:55], s65 offen lds
    s_add_u32 s65, s65, s69
    s_add_u32 m0, s72, 2048
    s_nop 0
    buffer_load_dwordx4 v5, s[56:59], s66 offen lds
    s_add_u32 s66, s66, s70
    s_add_u32 m0, s72, 3072
    s_nop 0
    buffer_load_dwordx4 v6, s[60:63], s67 offen lds
    s_add_u32 s67, s67, s71
    s_add_u32 s72, s72, 20480
    s_cmp_ge_u32 s72, s74
    s_cselect_b32 s72, s73, s72
    v_lshlrev_b32 v114, 16, v112
    v_and_b32 v112, s39, v112
    v_rcp_f32 v112, v112
    v_lshlrev_b32 v118, 16, v116
    v_and_b32 v116, s39, v116
    v_rcp_f32 v116, v116
    v_lshlrev_b32 v122, 16, v120
    v_and_b32 v120, s39, v120
    v_rcp_f32 v120, v120
    v_lshlrev_b32 v126, 16, v124
    v_and_b32 v124, s39, v124
    v_rcp_f32 v124, v124
    v_mul_f32 v114, v114, v112
    v_mov_b32 v113, v112
    v_sub_f32 v114, 0, v114
    v_mov_b32 v115, v114
    v_mul_f32 v118, v118, v116
    v_mov_b32 v117, v116
    v_sub_f32 v118, 0, v118
    v_mov_b32 v119, v118
    v_mul_f32 v122, v122, v120
    v_mov_b32 v121, v120
    v_sub_f32 v122, 0, v122
    v_mov_b32 v123, v122
    v_mul_f32 v126, v126, v124
    v_mov_b32 v125, v124
    v_sub_f32 v126, 0, v126
    v_mov_b32 v127, v126
    v_lshlrev_b32 v12, 16, v32
    v_and_b32 v13, s39, v32
    v_lshlrev_b32 v14, 16, v33
    v_and_b32 v15, s39, v33
    v_lshlrev_b32 v16, 16, v34
    v_and_b32 v17, s39, v34
    v_lshlrev_b32 v18, 16, v35
    v_and_b32 v19, s39, v35
    v_pk_fma_f32 v[12:13], v[12:13], v[112:113], v[114:115]
    v_pk_fma_f32 v[14:15], v[14:15], v[112:113], v[114:115]
    v_pk_fma_f32 v[16:17], v[16:17], v[112:113], v[114:115]
    v_pk_fma_f32 v[18:19], v[18:19], v[112:113], v[114:115]
    v_cvt_pk_bf16_f32 v32, v12, v13
    v_cvt_pk_bf16_f32 v33, v14, v15
    v_cvt_pk_bf16_f32 v34, v16, v17
    v_cvt_pk_bf16_f32 v35, v18, v19
    ds_write_b128 v28, v[32:35] offset:0
    v_lshlrev_b32 v20, 16, v36
    v_and_b32 v21, s39, v36
    v_lshlrev_b32 v22, 16, v37
    v_and_b32 v23, s39, v37
    v_lshlrev_b32 v24, 16, v38
    v_and_b32 v25, s39, v38
    v_lshlrev_b32 v26, 16, v39
    v_and_b32 v27, s39, v39
    v_pk_fma_f32 v[20:21], v[20:21], v[116:117], v[118:119]
    v_pk_fma_f32 v[22:23], v[22:23], v[116:117], v[118:119]
    v_pk_fma_f32 v[24:25], v[24:25], v[116:117], v[118:119]
    v_pk_fma_f32 v[26:27], v[26:27], v[116:117], v[118:119]
    v_cvt_pk_bf16_f32 v36, v20, v21
    v_cvt_pk_bf16_f32 v37, v22, v23
    v_cvt_pk_bf16_f32 v38, v24, v25
    v_cvt_pk_bf16_f32 v39, v26, v27
    ds_write_b128 v28, v[36:39] offset:1024
    v_lshlrev_b32 v12, 16, v40
    v_and_b32 v13, s39, v40
    v_lshlrev_b32 v14, 16, v41
    v_and_b32 v15, s39, v41
    v_lshlrev_b32 v16, 16, v42
    v_and_b32 v17, s39, v42
    v_lshlrev_b32 v18, 16, v43
    v_and_b32 v19, s39, v43
    v_pk_fma_f32 v[12:13], v[12:13], v[120:121], v[122:123]
    v_pk_fma_f32 v[14:15], v[14:15], v[120:121], v[122:123]
    v_pk_fma_f32 v[16:17], v[16:17], v[120:121], v[122:123]
    v_pk_fma_f32 v[18:19], v[18:19], v[120:121], v[122:123]
    v_cvt_pk_bf16_f32 v40, v12, v13
    v_cvt_pk_bf16_f32 v41, v14, v15
    v_cvt_pk_bf16_f32 v42, v16, v17
    v_cvt_pk_bf16_f32 v43, v18, v19
    ds_write_b128 v28, v[40:43] offset:2048
    v_lshlrev_b32 v20, 16, v44
    v_and_b32 v21, s39, v44
    v_lshlrev_b32 v22, 16, v45
    v_and_b32 v23, s39, v45
    v_lshlrev_b32 v24, 16, v46
    v_and_b32 v25, s39, v46
    v_lshlrev_b32 v26, 16, v47
    v_and_b32 v27, s39, v47
    v_pk_fma_f32 v[20:21], v[20:21], v[124:125], v[126:127]
    v_pk_fma_f32 v[22:23], v[22:23], v[124:125], v[126:127]
    v_pk_fma_f32 v[24:25], v[24:25], v[124:125], v[126:127]
    v_pk_fma_f32 v[26:27], v[26:27], v[124:125], v[126:127]
    v_cvt_pk_bf16_f32 v44, v20, v21
    v_cvt_pk_bf16_f32 v45, v22, v23
    v_cvt_pk_bf16_f32 v46, v24, v25
    v_cvt_pk_bf16_f32 v47, v26, v27
    ds_write_b128 v28, v[44:47] offset:3072
    v_lshlrev_b32 v12, 16, v48
    v_and_b32 v13, s39, v48
    v_lshlrev_b32 v14, 16, v49
    v_and_b32 v15, s39, v49
    v_lshlrev_b32 v16, 16, v50
    v_and_b32 v17, s39, v50
    v_lshlrev_b32 v18, 16, v51
    v_and_b32 v19, s39, v51
    v_pk_fma_f32 v[12:13], v[12:13], v[112:113], v[114:115]
    v_pk_fma_f32 v[14:15], v[14:15], v[112:113], v[114:115]
    v_pk_fma_f32 v[16:17], v[16:17], v[112:113], v[114:115]
    v_pk_fma_f32 v[18:19], v[18:19], v[112:113], v[114:115]
    v_cvt_pk_bf16_f32 v48, v12, v13
    v_cvt_pk_bf16_f32 v49, v14, v15
    v_cvt_pk_bf16_f32 v50, v16, v17
    v_cvt_pk_bf16_f32 v51, v18, v19
    ds_write_b128 v28, v[48:51] offset:16384
    v_lshlrev_b32 v20, 16, v52
    v_and_b32 v21, s39, v52
    v_lshlrev_b32 v22, 16, v53
    v_and_b32 v23, s39, v53
    v_lshlrev_b32 v24, 16, v54
    v_and_b32 v25, s39, v54
    v_lshlrev_b32 v26, 16, v55
    v_and_b32 v27, s39, v55
    v_pk_fma_f32 v[20:21], v[20:21], v[116:117], v[118:119]
    v_pk_fma_f32 v[22:23], v[22:23], v[116:117], v[118:119]
    v_pk_fma_f32 v[24:25], v[24:25], v[116:117], v[118:119]
    v_pk_fma_f32 v[26:27], v[26:27], v[116:117], v[118:119]
    v_cvt_pk_bf16_f32 v52, v20, v21
    v_cvt_pk_bf16_f32 v53, v22, v23
    v_cvt_pk_bf16_f32 v54, v24, v25
    v_cvt_pk_bf16_f32 v55, v26, v27
    ds_write_b128 v28, v[52:55] offset:17408
    v_lshlrev_b32 v12, 16, v56
    v_and_b32 v13, s39, v56
    v_lshlrev_b32 v14, 16, v57
    v_and_b32 v15, s39, v57
    v_lshlrev_b32 v16, 16, v58
    v_and_b32 v17, s39, v58
    v_lshlrev_b32 v18, 16, v59
    v_and_b32 v19, s39, v59
    v_pk_fma_f32 v[12:13], v[12:13], v[120:121], v[122:123]
    v_pk_fma_f32 v[14:15], v[14:15], v[120:121], v[122:123]
    v_pk_fma_f32 v[16:17], v[16:17], v[120:121], v[122:123]
    v_pk_fma_f32 v[18:19], v[18:19], v[120:121], v[122:123]
    v_cvt_pk_bf16_f32 v56, v12, v13
    v_cvt_pk_bf16_f32 v57, v14, v15
    v_cvt_pk_bf16_f32 v58, v16, v17
    v_cvt_pk_bf16_f32 v59, v18, v19
    ds_write_b128 v28, v[56:59] offset:18432
    v_lshlrev_b32 v20, 16, v60
    v_and_b32 v21, s39, v60
    v_lshlrev_b32 v22, 16, v61
    v_and_b32 v23, s39, v61
    v_lshlrev_b32 v24, 16, v62
    v_and_b32 v25, s39, v62
    v_lshlrev_b32 v26, 16, v63
    v_and_b32 v27, s39, v63
    v_pk_fma_f32 v[20:21], v[20:21], v[124:125], v[126:127]
    v_pk_fma_f32 v[22:23], v[22:23], v[124:125], v[126:127]
    v_pk_fma_f32 v[24:25], v[24:25], v[124:125], v[126:127]
    v_pk_fma_f32 v[26:27], v[26:27], v[124:125], v[126:127]
    v_cvt_pk_bf16_f32 v60, v20, v21
    v_cvt_pk_bf16_f32 v61, v22, v23
    v_cvt_pk_bf16_f32 v62, v24, v25
    v_cvt_pk_bf16_f32 v63, v26, v27
    ds_write_b128 v28, v[60:63] offset:19456
    v_lshlrev_b32 v12, 16, v64
    v_and_b32 v13, s39, v64
    v_lshlrev_b32 v14, 16, v65
    v_and_b32 v15, s39, v65
    v_lshlrev_b32 v16, 16, v66
    v_and_b32 v17, s39, v66
    v_lshlrev_b32 v18, 16, v67
    v_and_b32 v19, s39, v67
    v_pk_fma_f32 v[12:13], v[12:13], v[112:113], v[114:115]
    v_pk_fma_f32 v[14:15], v[14:15], v[112:113], v[114:115]
    v_pk_fma_f32 v[16:17], v[16:17], v[112:113], v[114:115]
    v_pk_fma_f32 v[18:19], v[18:19], v[112:113], v[114:115]
    v_cvt_pk_bf16_f32 v64, v12, v13
    v_cvt_pk_bf16_f32 v65, v14, v15
    v_cvt_pk_bf16_f32 v66, v16, v17
    v_cvt_pk_bf16_f32 v67, v18, v19
    ds_write_b128 v28, v[64:67] offset:32768
    v_lshlrev_b32 v20, 16, v68
    v_and_b32 v21, s39, v68
    v_lshlrev_b32 v22, 16, v69
    v_and_b32 v23, s39, v69
    v_lshlrev_b32 v24, 16, v70
    v_and_b32 v25, s39, v70
    v_lshlrev_b32 v26, 16, v71
    v_and_b32 v27, s39, v71
    v_pk_fma_f32 v[20:21], v[20:21], v[116:117], v[118:119]
    v_pk_fma_f32 v[22:23], v[22:23], v[116:117], v[118:119]
    v_pk_fma_f32 v[24:25], v[24:25], v[116:117], v[118:119]
    v_pk_fma_f32 v[26:27], v[26:27], v[116:117], v[118:119]
    v_cvt_pk_bf16_f32 v68, v20, v21
    v_cvt_pk_bf16_f32 v69, v22, v23
    v_cvt_pk_bf16_f32 v70, v24, v25
    v_cvt_pk_bf16_f32 v71, v26, v27
    ds_write_b128 v28, v[68:71] offset:33792
    v_lshlrev_b32 v12, 16, v72
    v_and_b32 v13, s39, v72
    v_lshlrev_b32 v14, 16, v73
    v_and_b32 v15, s39, v73
    v_lshlrev_b32 v16, 16, v74
    v_and_b32 v17, s39, v74
    v_lshlrev_b32 v18, 16, v75
    v_and_b32 v19, s39, v75
    v_pk_fma_f32 v[12:13], v[12:13], v[120:121], v[122:123]
    v_pk_fma_f32 v[14:15], v[14:15], v[120:121], v[122:123]
    v_pk_fma_f32 v[16:17], v[16:17], v[120:121], v[122:123]
    v_pk_fma_f32 v[18:19], v[18:19], v[120:121], v[122:123]
    v_cvt_pk_bf16_f32 v72, v12, v13
    v_cvt_pk_bf16_f32 v73, v14, v15
    v_cvt_pk_bf16_f32 v74, v16, v17
    v_cvt_pk_bf16_f32 v75, v18, v19
    ds_write_b128 v28, v[72:75] offset:34816
    v_lshlrev_b32 v20, 16, v76
    v_and_b32 v21, s39, v76
    v_lshlrev_b32 v22, 16, v77
    v_and_b32 v23, s39, v77
    v_lshlrev_b32 v24, 16, v78
    v_and_b32 v25, s39, v78
    v_lshlrev_b32 v26, 16, v79
    v_and_b32 v27, s39, v79
    v_pk_fma_f32 v[20:21], v[20:21], v[124:125], v[126:127]
    v_pk_fma_f32 v[22:23], v[22:23], v[124:125], v[126:127]
    v_pk_fma_f32 v[24:25], v[24:25], v[124:125], v[126:127]
    v_pk_fma_f32 v[26:27], v[26:27], v[124:125], v[126:127]
    v_cvt_pk_bf16_f32 v76, v20, v21
    v_cvt_pk_bf16_f32 v77, v22, v23
    v_cvt_pk_bf16_f32 v78, v24, v25
    v_cvt_pk_bf16_f32 v79, v26, v27
    ds_write_b128 v28, v[76:79] offset:35840
    v_lshlrev_b32 v12, 16, v80
    v_and_b32 v13, s39, v80
    v_lshlrev_b32 v14, 16, v81
    v_and_b32 v15, s39, v81
    v_lshlrev_b32 v16, 16, v82
    v_and_b32 v17, s39, v82
    v_lshlrev_b32 v18, 16, v83
    v_and_b32 v19, s39, v83
    v_pk_fma_f32 v[12:13], v[12:13], v[112:113], v[114:115]
    v_pk_fma_f32 v[14:15], v[14:15], v[112:113], v[114:115]
    v_pk_fma_f32 v[16:17], v[16:17], v[112:113], v[114:115]
    v_pk_fma_f32 v[18:19], v[18:19], v[112:113], v[114:115]
    v_cvt_pk_bf16_f32 v80, v12, v13
    v_cvt_pk_bf16_f32 v81, v14, v15
    v_cvt_pk_bf16_f32 v82, v16, v17
    v_cvt_pk_bf16_f32 v83, v18, v19
    v_accvgpr_write_b32 a32, v80
    v_accvgpr_write_b32 a33, v81
    v_accvgpr_write_b32 a34, v82
    v_accvgpr_write_b32 a35, v83
    v_lshlrev_b32 v20, 16, v84
    v_and_b32 v21, s39, v84
    v_lshlrev_b32 v22, 16, v85
    v_and_b32 v23, s39, v85
    v_lshlrev_b32 v24, 16, v86
    v_and_b32 v25, s39, v86
    v_lshlrev_b32 v26, 16, v87
    v_and_b32 v27, s39, v87
    v_pk_fma_f32 v[20:21], v[20:21], v[116:117], v[118:119]
    v_pk_fma_f32 v[22:23], v[22:23], v[116:117], v[118:119]
    v_pk_fma_f32 v[24:25], v[24:25], v[116:117], v[118:119]
    v_pk_fma_f32 v[26:27], v[26:27], v[116:117], v[118:119]
    v_cvt_pk_bf16_f32 v84, v20, v21
    v_cvt_pk_bf16_f32 v85, v22, v23
    v_cvt_pk_bf16_f32 v86, v24, v25
    v_cvt_pk_bf16_f32 v87, v26, v27
    v_accvgpr_write_b32 a36, v84
    v_accvgpr_write_b32 a37, v85
    v_accvgpr_write_b32 a38, v86
    v_accvgpr_write_b32 a39, v87
    v_lshlrev_b32 v12, 16, v88
    v_and_b32 v13, s39, v88
    v_lshlrev_b32 v14, 16, v89
    v_and_b32 v15, s39, v89
    v_lshlrev_b32 v16, 16, v90
    v_and_b32 v17, s39, v90
    v_lshlrev_b32 v18, 16, v91
    v_and_b32 v19, s39, v91
    v_pk_fma_f32 v[12:13], v[12:13], v[120:121], v[122:123]
    v_pk_fma_f32 v[14:15], v[14:15], v[120:121], v[122:123]
    v_pk_fma_f32 v[16:17], v[16:17], v[120:121], v[122:123]
    v_pk_fma_f32 v[18:19], v[18:19], v[120:121], v[122:123]
    v_cvt_pk_bf16_f32 v88, v12, v13
    v_cvt_pk_bf16_f32 v89, v14, v15
    v_cvt_pk_bf16_f32 v90, v16, v17
    v_cvt_pk_bf16_f32 v91, v18, v19
    v_accvgpr_write_b32 a40, v88
    v_accvgpr_write_b32 a41, v89
    v_accvgpr_write_b32 a42, v90
    v_accvgpr_write_b32 a43, v91
    v_lshlrev_b32 v20, 16, v92
    v_and_b32 v21, s39, v92
    v_lshlrev_b32 v22, 16, v93
    v_and_b32 v23, s39, v93
    v_lshlrev_b32 v24, 16, v94
    v_and_b32 v25, s39, v94
    v_lshlrev_b32 v26, 16, v95
    v_and_b32 v27, s39, v95
    v_pk_fma_f32 v[20:21], v[20:21], v[124:125], v[126:127]
    v_pk_fma_f32 v[22:23], v[22:23], v[124:125], v[126:127]
    v_pk_fma_f32 v[24:25], v[24:25], v[124:125], v[126:127]
    v_pk_fma_f32 v[26:27], v[26:27], v[124:125], v[126:127]
    v_cvt_pk_bf16_f32 v92, v20, v21
    v_cvt_pk_bf16_f32 v93, v22, v23
    v_cvt_pk_bf16_f32 v94, v24, v25
    v_cvt_pk_bf16_f32 v95, v26, v27
    v_accvgpr_write_b32 a44, v92
    v_accvgpr_write_b32 a45, v93
    v_accvgpr_write_b32 a46, v94
    v_accvgpr_write_b32 a47, v95
    s_waitcnt lgkmcnt(0)
    v_mov_b32 v32, 0
    v_mov_b32 v33, 0
    v_mov_b32 v34, 0
    v_mov_b32 v35, 0
    v_mov_b32 v36, 0
    v_mov_b32 v37, 0
    v_mov_b32 v38, 0
    v_mov_b32 v39, 0
    v_mov_b32 v40, 0
    v_mov_b32 v41, 0
    v_mov_b32 v42, 0
    v_mov_b32 v43, 0
    v_mov_b32 v44, 0
    v_mov_b32 v45, 0
    v_mov_b32 v46, 0
    v_mov_b32 v47, 0
    v_mov_b32 v48, 0
    v_mov_b32 v49, 0
    v_mov_b32 v50, 0
    v_mov_b32 v51, 0
    v_mov_b32 v52, 0
    v_mov_b32 v53, 0
    v_mov_b32 v54, 0
    v_mov_b32 v55, 0
    v_mov_b32 v56, 0
    v_mov_b32 v57, 0
    v_mov_b32 v58, 0
    v_mov_b32 v59, 0
    v_mov_b32 v60, 0
    v_mov_b32 v61, 0
    v_mov_b32 v62, 0
    v_mov_b32 v63, 0
    v_mov_b32 v64, 0
    v_mov_b32 v65, 0
    v_mov_b32 v66, 0
    v_mov_b32 v67, 0
    v_mov_b32 v68, 0
    v_mov_b32 v69, 0
    v_mov_b32 v70, 0
    v_mov_b32 v71, 0
    v_mov_b32 v72, 0
    v_mov_b32 v73, 0
    v_mov_b32 v74, 0
    v_mov_b32 v75, 0
    v_mov_b32 v76, 0
    v_mov_b32 v77, 0
    v_mov_b32 v78, 0
    v_mov_b32 v79, 0
    v_mov_b32 v80, 0
    v_mov_b32 v81, 0
    v_mov_b32 v82, 0
    v_mov_b32 v83, 0
    v_mov_b32 v84, 0
    v_mov_b32 v85, 0
    v_mov_b32 v86, 0
    v_mov_b32 v87, 0
    v_mov_b32 v88, 0
    v_mov_b32 v89, 0
    v_mov_b32 v90, 0
    v_mov_b32 v91, 0
    v_mov_b32 v92, 0
    v_mov_b32 v93, 0
    v_mov_b32 v94, 0
    v_mov_b32 v95, 0
    v_mov_b32 v112, 0
    v_mov_b32 v113, 0
    v_mov_b32 v114, 0
    v_mov_b32 v115, 0
    v_mov_b32 v116, 0
    v_mov_b32 v117, 0
    v_mov_b32 v118, 0
    v_mov_b32 v119, 0
    v_mov_b32 v120, 0
    v_mov_b32 v121, 0
    v_mov_b32 v122, 0
    v_mov_b32 v123, 0
    v_mov_b32 v124, 0
    v_mov_b32 v125, 0
    v_mov_b32 v126, 0
    v_mov_b32 v127, 0
    s_barrier
    s_branch L_g1_H1
L_p0_pf:
    v_lshlrev_b32 v11, 7, v1
    s_getpc_b64 s[56:57]
    L_pc:
    s_sub_u32 s56, s56, L_pc - mega_kernel
    s_subb_u32 s57, s57, 0
    s_lshr_b32 s36, s2, 3
    s_cmp_ge_u32 s36, 20
    s_cselect_b32 s37, 20, 0
    s_sub_u32 s36, s36, s37
    s_cmp_ge_u32 s36, 10
    s_cselect_b32 s37, 10, 0
    s_sub_u32 s36, s36, s37
    s_lshl_b32 s36, s36, 13
    v_add_u32 v5, s36, v11
    v_min_u32 v5, L_code_end - mega_kernel - 4, v5
    global_load_dword v10, v5, s[56:57]
    s_mov_b32 s48, s6
    s_and_b32 s49, s7, 0xffff
    s_mov_b32 s50, 6291456
    s_mov_b32 s68, 786432
    s_add_u32 s36, s2, 0
    s_cmp_lt_u32 s2, 96
    s_cbranch_scc1 L_mega_kernel_pfd_22
    s_mov_b32 s48, s12
    s_and_b32 s49, s13, 0xffff
    s_mov_b32 s50, 7340032
    s_mov_b32 s68, 917504
    s_add_u32 s36, s2, 4294967200
    s_cmp_lt_u32 s2, 208
    s_cbranch_scc1 L_mega_kernel_pfd_22
    s_mov_b32 s48, s14
    s_and_b32 s49, s15, 0xffff
    s_mov_b32 s50, 7340032
    s_mov_b32 s68, 917504
    s_add_u32 s36, s2, 4294967088
L_mega_kernel_pfd_22:
    s_mov_b32 s51, 0x00020000
    s_lshl_b32 s36, s36, 13
    v_add_u32 v3, s36, v11
    s_mov_b32 s64, 0
    s_mov_b32 s52, s14
    s_and_b32 s53, s15, 0xffff
    s_mov_b32 s54, 7340032
    s_mov_b32 s69, 917504
    s_add_u32 s36, s2, 48
    s_cmp_lt_u32 s2, 64
    s_cbranch_scc1 L_mega_kernel_pfd_23
    s_mov_b32 s52, s16
    s_and_b32 s53, s17, 0xffff
    s_mov_b32 s54, 7340032
    s_mov_b32 s69, 1228800
    s_add_u32 s36, s2, 4294967232
    s_cmp_lt_u32 s2, 214
    s_cbranch_scc1 L_mega_kernel_pfd_23
    s_mov_b32 s52, s8
    s_and_b32 s53, s9, 0xffff
    s_mov_b32 s54, 2064384
    s_mov_b32 s69, 344064
    s_add_u32 s36, s2, 4294967082
L_mega_kernel_pfd_23:
    s_mov_b32 s55, 0x00020000
    s_lshl_b32 s36, s36, 13
    v_add_u32 v4, s36, v11
    s_mov_b32 s65, 0
    buffer_load_dword v10, v3, s[48:51], s64 offen
    s_add_u32 s64, s64, s68
    s_cmp_ge_u32 s2, 64
    s_cbranch_scc1 L_mega_kernel_pfs_24
    buffer_load_dword v10, v4, s[52:55], s65 offen
    s_add_u32 s65, s65, s69
L_mega_kernel_pfs_24:
    s_mov_b32 s24, s22
    s_and_b32 s25, s23, 0xffff
    s_mov_b32 s26, 83886080
    s_mov_b32 s27, 0x00020000
    s_mov_b32 s44, s20
    s_and_b32 s45, s21, 0xffff
    s_mov_b32 s46, 256
    s_mov_b32 s47, 0x00020000
    v_mov_b32 v29, 156692
    s_mov_b32 s31, 1048576
    L_mega_kernel_rw_25:
    ds_read_b32 v30, v29
    s_waitcnt lgkmcnt(0)
    v_cmp_eq_u32 vcc, 0, v30
    s_sub_u32 s31, s31, 1
    s_cbranch_scc1 L_mega_kernel_rwd_26
    s_cbranch_vccnz L_mega_kernel_rw_25
    L_mega_kernel_rwd_26:
    s_mov_b32 s40, s4
    s_and_b32 s41, s5, 0xffff
    s_mov_b32 s42, 4194304
    s_mov_b32 s43, 0x00020000
    v_lshrrev_b32 v29, 2, v1
    v_and_b32 v30, 3, v1
    v_lshlrev_b32 v31, 11, v29
    v_lshl_add_u32 v31, v30, 4, v31
    s_lshl_b32 s34, s29, 2
    s_and_b32 s35, s28, 3
    s_add_u32 s34, s34, s35
    s_lshl_b32 s39, s34, 9
    s_lshl_b32 s34, s34, 17
    buffer_load_dwordx4 v[32:35], v31, s[40:43], s34 offen offset:0
    buffer_load_dwordx4 v[48:51], v31, s[40:43], s34 offen offset:64
    buffer_load_dwordx4 v[64:67], v31, s[40:43], s34 offen offset:128
    buffer_load_dwordx4 v[80:83], v31, s[40:43], s34 offen offset:192
    s_add_u32 s34, s34, 32768
    buffer_load_dwordx4 v[36:39], v31, s[40:43], s34 offen offset:0
    buffer_load_dwordx4 v[52:55], v31, s[40:43], s34 offen offset:64
    buffer_load_dwordx4 v[68:71], v31, s[40:43], s34 offen offset:128
    buffer_load_dwordx4 v[84:87], v31, s[40:43], s34 offen offset:192
    s_add_u32 s34, s34, 32768
    buffer_load_dwordx4 v[40:43], v31, s[40:43], s34 offen offset:0
    buffer_load_dwordx4 v[56:59], v31, s[40:43], s34 offen offset:64
    buffer_load_dwordx4 v[72:75], v31, s[40:43], s34 offen offset:128
    buffer_load_dwordx4 v[88:91], v31, s[40:43], s34 offen offset:192
    s_add_u32 s34, s34, 32768
    buffer_load_dwordx4 v[44:47], v31, s[40:43], s34 offen offset:0
    buffer_load_dwordx4 v[60:63], v31, s[40:43], s34 offen offset:64
    buffer_load_dwordx4 v[76:79], v31, s[40:43], s34 offen offset:128
    buffer_load_dwordx4 v[92:95], v31, s[40:43], s34 offen offset:192
    s_add_u32 s78, s39, 42074112
    s_and_b32 s34, s28, 3
    s_lshl_b32 s35, s29, 2
    s_add_u32 s35, s34, s35
    s_lshl_b32 s35, s35, 17
    s_add_u32 s40, s22, s35
    s_addc_u32 s41, s23, 0
    s_and_b32 s41, s41, 0xffff
    s_mov_b32 s42, 131072
    s_mov_b32 s43, 0x00020000
    s_mov_b32 s77, 0
    s_mov_b32 s75, 61440
    s_lshl_b32 s34, s34, 12
    s_add_u32 s34, s34, 102400
    s_mov_b32 s79, 0
    s_mov_b32 s3, s34
    s_mov_b32 s80, 0
    s_mov_b32 s82, 20480
    s_mov_b32 s83, 16384
    v_add_u32 v9, s34, v2
    v_lshrrev_b32 v12, 5, v1
    v_and_b32 v13, 31, v1
    v_lshlrev_b32 v13, 3, v13
    v_add_u32 v13, 61440, v13
    v_mul_u32_u24 v7, 3072, v12
    v_mul_u32_u24 v8, 3584, v12
    v_add_u32 v7, v7, v13
    v_add_u32 v8, v8, v13
    v_accvgpr_write_b32 a64, 0
    v_accvgpr_write_b32 a65, 0
    v_accvgpr_write_b32 a66, 0
    v_accvgpr_write_b32 a67, 0
    v_accvgpr_write_b32 a68, 0
    v_accvgpr_write_b32 a69, 0
    v_accvgpr_write_b32 a70, 0
    v_accvgpr_write_b32 a71, 0
    v_accvgpr_write_b32 a72, 0
    v_accvgpr_write_b32 a73, 0
    v_accvgpr_write_b32 a74, 0
    v_accvgpr_write_b32 a75, 0
    v_accvgpr_write_b32 a76, 0
    v_accvgpr_write_b32 a77, 0
    v_accvgpr_write_b32 a78, 0
    v_accvgpr_write_b32 a79, 0
    v_accvgpr_write_b32 a80, 0
    v_accvgpr_write_b32 a81, 0
    v_accvgpr_write_b32 a82, 0
    v_accvgpr_write_b32 a83, 0
    v_accvgpr_write_b32 a84, 0
    v_accvgpr_write_b32 a85, 0
    v_accvgpr_write_b32 a86, 0
    v_accvgpr_write_b32 a87, 0
    v_accvgpr_write_b32 a88, 0
    v_accvgpr_write_b32 a89, 0
    v_accvgpr_write_b32 a90, 0
    v_accvgpr_write_b32 a91, 0
    v_accvgpr_write_b32 a92, 0
    v_accvgpr_write_b32 a93, 0
    v_accvgpr_write_b32 a94, 0
    v_accvgpr_write_b32 a95, 0
    v_accvgpr_write_b32 a96, 0
    v_accvgpr_write_b32 a97, 0
    v_accvgpr_write_b32 a98, 0
    v_accvgpr_write_b32 a99, 0
    v_accvgpr_write_b32 a100, 0
    v_accvgpr_write_b32 a101, 0
    v_accvgpr_write_b32 a102, 0
    v_accvgpr_write_b32 a103, 0
    v_accvgpr_write_b32 a104, 0
    v_accvgpr_write_b32 a105, 0
    v_accvgpr_write_b32 a106, 0
    v_accvgpr_write_b32 a107, 0
    v_accvgpr_write_b32 a108, 0
    v_accvgpr_write_b32 a109, 0
    v_accvgpr_write_b32 a110, 0
    v_accvgpr_write_b32 a111, 0
    v_accvgpr_write_b32 a112, 0
    v_accvgpr_write_b32 a113, 0
    v_accvgpr_write_b32 a114, 0
    v_accvgpr_write_b32 a115, 0
    v_accvgpr_write_b32 a116, 0
    v_accvgpr_write_b32 a117, 0
    v_accvgpr_write_b32 a118, 0
    v_accvgpr_write_b32 a119, 0
    v_accvgpr_write_b32 a120, 0
    v_accvgpr_write_b32 a121, 0
    v_accvgpr_write_b32 a122, 0
    v_accvgpr_write_b32 a123, 0
    v_accvgpr_write_b32 a124, 0
    v_accvgpr_write_b32 a125, 0
    v_accvgpr_write_b32 a126, 0
    v_accvgpr_write_b32 a127, 0
    v_mov_b32 v96, 0
    v_mov_b32 v97, 0
    v_mov_b32 v98, 0
    v_mov_b32 v99, 0
    v_mov_b32 v100, 0
    v_mov_b32 v101, 0
    v_mov_b32 v102, 0
    v_mov_b32 v103, 0
    v_mov_b32 v104, 0
    v_mov_b32 v105, 0
    v_mov_b32 v106, 0
    v_mov_b32 v107, 0
    v_mov_b32 v108, 0
    v_mov_b32 v109, 0
    v_mov_b32 v110, 0
    v_mov_b32 v111, 0
    s_load_dwordx2 s[32:33], s[20:21], 0
    s_waitcnt lgkmcnt(0)
    s_mov_b32 s31, 131072
L_mega_kernel_nl_29:
    s_cmp_lg_u32 s32, 0
    s_cbranch_scc1 L_mega_kernel_nok_30
    buffer_load_dwordx2 v[10:11], v28, s[44:47], 0 offen sc1
    s_waitcnt vmcnt(0)
    v_readfirstlane_b32 s32, v10
    v_readfirstlane_b32 s33, v11
    s_sub_u32 s31, s31, 1
    s_cbranch_scc0 L_mega_kernel_nl_29
L_mega_kernel_nok_30:
    v_lshlrev_b32 v31, 3, v29
    v_lshlrev_b32 v28, 8, v30
    v_lshl_add_u32 v28, v29, 4, v28
    v_add_u32 v28, s3, v28
    s_mov_b32 s39, 0xffff0000
    s_mov_b32 s31, 131072
L_mega_kernel_stp_27:
    buffer_load_dwordx2 v[112:113], v31, s[24:27], s78 offen offset:0 sc1
    buffer_load_dwordx2 v[116:117], v31, s[24:27], s78 offen offset:128 sc1
    buffer_load_dwordx2 v[120:121], v31, s[24:27], s78 offen offset:256 sc1
    buffer_load_dwordx2 v[124:125], v31, s[24:27], s78 offen offset:384 sc1
    s_waitcnt vmcnt(0)
    v_xor_b32 v12, s32, v113
    v_xor_b32 v13, s32, v117
    v_xor_b32 v14, s32, v121
    v_xor_b32 v15, s32, v125
    v_or3_b32 v12, v12, v13, v14
    v_or_b32 v12, v12, v15
    v_cmp_ne_u32 vcc, 0, v12
    s_sub_u32 s31, s31, 1
    s_cbranch_scc1 L_mega_kernel_std_28
    s_cbranch_vccnz L_mega_kernel_stp_27
L_mega_kernel_std_28:
    buffer_load_dword v10, v3, s[48:51], s64 offen
    s_add_u32 s64, s64, s68
    s_cmp_ge_u32 s2, 64
    s_cbranch_scc1 L_mega_kernel_pfs_31
    buffer_load_dword v10, v4, s[52:55], s65 offen
    s_add_u32 s65, s65, s69
L_mega_kernel_pfs_31:
    v_lshlrev_b32 v114, 16, v112
    v_and_b32 v112, s39, v112
    v_rcp_f32 v112, v112
    v_lshlrev_b32 v118, 16, v116
    v_and_b32 v116, s39, v116
    v_rcp_f32 v116, v116
    v_lshlrev_b32 v122, 16, v120
    v_and_b32 v120, s39, v120
    v_rcp_f32 v120, v120
    v_lshlrev_b32 v126, 16, v124
    v_and_b32 v124, s39, v124
    v_rcp_f32 v124, v124
    v_mul_f32 v114, v114, v112
    v_mov_b32 v113, v112
    v_sub_f32 v114, 0, v114
    v_mov_b32 v115, v114
    v_mul_f32 v118, v118, v116
    v_mov_b32 v117, v116
    v_sub_f32 v118, 0, v118
    v_mov_b32 v119, v118
    v_mul_f32 v122, v122, v120
    v_mov_b32 v121, v120
    v_sub_f32 v122, 0, v122
    v_mov_b32 v123, v122
    v_mul_f32 v126, v126, v124
    v_mov_b32 v125, v124
    v_sub_f32 v126, 0, v126
    v_mov_b32 v127, v126
    v_lshlrev_b32 v12, 16, v32
    v_and_b32 v13, s39, v32
    v_lshlrev_b32 v14, 16, v33
    v_and_b32 v15, s39, v33
    v_lshlrev_b32 v16, 16, v34
    v_and_b32 v17, s39, v34
    v_lshlrev_b32 v18, 16, v35
    v_and_b32 v19, s39, v35
    v_pk_fma_f32 v[12:13], v[12:13], v[112:113], v[114:115]
    v_pk_fma_f32 v[14:15], v[14:15], v[112:113], v[114:115]
    v_pk_fma_f32 v[16:17], v[16:17], v[112:113], v[114:115]
    v_pk_fma_f32 v[18:19], v[18:19], v[112:113], v[114:115]
    v_cvt_pk_bf16_f32 v32, v12, v13
    v_cvt_pk_bf16_f32 v33, v14, v15
    v_cvt_pk_bf16_f32 v34, v16, v17
    v_cvt_pk_bf16_f32 v35, v18, v19
    ds_write_b128 v28, v[32:35] offset:0
    v_lshlrev_b32 v20, 16, v36
    v_and_b32 v21, s39, v36
    v_lshlrev_b32 v22, 16, v37
    v_and_b32 v23, s39, v37
    v_lshlrev_b32 v24, 16, v38
    v_and_b32 v25, s39, v38
    v_lshlrev_b32 v26, 16, v39
    v_and_b32 v27, s39, v39
    v_pk_fma_f32 v[20:21], v[20:21], v[116:117], v[118:119]
    v_pk_fma_f32 v[22:23], v[22:23], v[116:117], v[118:119]
    v_pk_fma_f32 v[24:25], v[24:25], v[116:117], v[118:119]
    v_pk_fma_f32 v[26:27], v[26:27], v[116:117], v[118:119]
    v_cvt_pk_bf16_f32 v36, v20, v21
    v_cvt_pk_bf16_f32 v37, v22, v23
    v_cvt_pk_bf16_f32 v38, v24, v25
    v_cvt_pk_bf16_f32 v39, v26, v27
    ds_write_b128 v28, v[36:39] offset:1024
    v_lshlrev_b32 v12, 16, v40
    v_and_b32 v13, s39, v40
    v_lshlrev_b32 v14, 16, v41
    v_and_b32 v15, s39, v41
    v_lshlrev_b32 v16, 16, v42
    v_and_b32 v17, s39, v42
    v_lshlrev_b32 v18, 16, v43
    v_and_b32 v19, s39, v43
    v_pk_fma_f32 v[12:13], v[12:13], v[120:121], v[122:123]
    v_pk_fma_f32 v[14:15], v[14:15], v[120:121], v[122:123]
    v_pk_fma_f32 v[16:17], v[16:17], v[120:121], v[122:123]
    v_pk_fma_f32 v[18:19], v[18:19], v[120:121], v[122:123]
    v_cvt_pk_bf16_f32 v40, v12, v13
    v_cvt_pk_bf16_f32 v41, v14, v15
    v_cvt_pk_bf16_f32 v42, v16, v17
    v_cvt_pk_bf16_f32 v43, v18, v19
    ds_write_b128 v28, v[40:43] offset:2048
    v_lshlrev_b32 v20, 16, v44
    v_and_b32 v21, s39, v44
    v_lshlrev_b32 v22, 16, v45
    v_and_b32 v23, s39, v45
    v_lshlrev_b32 v24, 16, v46
    v_and_b32 v25, s39, v46
    v_lshlrev_b32 v26, 16, v47
    v_and_b32 v27, s39, v47
    v_pk_fma_f32 v[20:21], v[20:21], v[124:125], v[126:127]
    v_pk_fma_f32 v[22:23], v[22:23], v[124:125], v[126:127]
    v_pk_fma_f32 v[24:25], v[24:25], v[124:125], v[126:127]
    v_pk_fma_f32 v[26:27], v[26:27], v[124:125], v[126:127]
    v_cvt_pk_bf16_f32 v44, v20, v21
    v_cvt_pk_bf16_f32 v45, v22, v23
    v_cvt_pk_bf16_f32 v46, v24, v25
    v_cvt_pk_bf16_f32 v47, v26, v27
    ds_write_b128 v28, v[44:47] offset:3072
    v_lshlrev_b32 v12, 16, v48
    v_and_b32 v13, s39, v48
    v_lshlrev_b32 v14, 16, v49
    v_and_b32 v15, s39, v49
    v_lshlrev_b32 v16, 16, v50
    v_and_b32 v17, s39, v50
    v_lshlrev_b32 v18, 16, v51
    v_and_b32 v19, s39, v51
    v_pk_fma_f32 v[12:13], v[12:13], v[112:113], v[114:115]
    v_pk_fma_f32 v[14:15], v[14:15], v[112:113], v[114:115]
    v_pk_fma_f32 v[16:17], v[16:17], v[112:113], v[114:115]
    v_pk_fma_f32 v[18:19], v[18:19], v[112:113], v[114:115]
    v_cvt_pk_bf16_f32 v48, v12, v13
    v_cvt_pk_bf16_f32 v49, v14, v15
    v_cvt_pk_bf16_f32 v50, v16, v17
    v_cvt_pk_bf16_f32 v51, v18, v19
    ds_write_b128 v28, v[48:51] offset:16384
    v_lshlrev_b32 v20, 16, v52
    v_and_b32 v21, s39, v52
    v_lshlrev_b32 v22, 16, v53
    v_and_b32 v23, s39, v53
    v_lshlrev_b32 v24, 16, v54
    v_and_b32 v25, s39, v54
    v_lshlrev_b32 v26, 16, v55
    v_and_b32 v27, s39, v55
    v_pk_fma_f32 v[20:21], v[20:21], v[116:117], v[118:119]
    v_pk_fma_f32 v[22:23], v[22:23], v[116:117], v[118:119]
    v_pk_fma_f32 v[24:25], v[24:25], v[116:117], v[118:119]
    v_pk_fma_f32 v[26:27], v[26:27], v[116:117], v[118:119]
    v_cvt_pk_bf16_f32 v52, v20, v21
    v_cvt_pk_bf16_f32 v53, v22, v23
    v_cvt_pk_bf16_f32 v54, v24, v25
    v_cvt_pk_bf16_f32 v55, v26, v27
    ds_write_b128 v28, v[52:55] offset:17408
    v_lshlrev_b32 v12, 16, v56
    v_and_b32 v13, s39, v56
    v_lshlrev_b32 v14, 16, v57
    v_and_b32 v15, s39, v57
    v_lshlrev_b32 v16, 16, v58
    v_and_b32 v17, s39, v58
    v_lshlrev_b32 v18, 16, v59
    v_and_b32 v19, s39, v59
    v_pk_fma_f32 v[12:13], v[12:13], v[120:121], v[122:123]
    v_pk_fma_f32 v[14:15], v[14:15], v[120:121], v[122:123]
    v_pk_fma_f32 v[16:17], v[16:17], v[120:121], v[122:123]
    v_pk_fma_f32 v[18:19], v[18:19], v[120:121], v[122:123]
    v_cvt_pk_bf16_f32 v56, v12, v13
    v_cvt_pk_bf16_f32 v57, v14, v15
    v_cvt_pk_bf16_f32 v58, v16, v17
    v_cvt_pk_bf16_f32 v59, v18, v19
    ds_write_b128 v28, v[56:59] offset:18432
    v_lshlrev_b32 v20, 16, v60
    v_and_b32 v21, s39, v60
    v_lshlrev_b32 v22, 16, v61
    v_and_b32 v23, s39, v61
    v_lshlrev_b32 v24, 16, v62
    v_and_b32 v25, s39, v62
    v_lshlrev_b32 v26, 16, v63
    v_and_b32 v27, s39, v63
    v_pk_fma_f32 v[20:21], v[20:21], v[124:125], v[126:127]
    v_pk_fma_f32 v[22:23], v[22:23], v[124:125], v[126:127]
    v_pk_fma_f32 v[24:25], v[24:25], v[124:125], v[126:127]
    v_pk_fma_f32 v[26:27], v[26:27], v[124:125], v[126:127]
    v_cvt_pk_bf16_f32 v60, v20, v21
    v_cvt_pk_bf16_f32 v61, v22, v23
    v_cvt_pk_bf16_f32 v62, v24, v25
    v_cvt_pk_bf16_f32 v63, v26, v27
    ds_write_b128 v28, v[60:63] offset:19456
    v_lshlrev_b32 v12, 16, v64
    v_and_b32 v13, s39, v64
    v_lshlrev_b32 v14, 16, v65
    v_and_b32 v15, s39, v65
    v_lshlrev_b32 v16, 16, v66
    v_and_b32 v17, s39, v66
    v_lshlrev_b32 v18, 16, v67
    v_and_b32 v19, s39, v67
    v_pk_fma_f32 v[12:13], v[12:13], v[112:113], v[114:115]
    v_pk_fma_f32 v[14:15], v[14:15], v[112:113], v[114:115]
    v_pk_fma_f32 v[16:17], v[16:17], v[112:113], v[114:115]
    v_pk_fma_f32 v[18:19], v[18:19], v[112:113], v[114:115]
    v_cvt_pk_bf16_f32 v64, v12, v13
    v_cvt_pk_bf16_f32 v65, v14, v15
    v_cvt_pk_bf16_f32 v66, v16, v17
    v_cvt_pk_bf16_f32 v67, v18, v19
    ds_write_b128 v28, v[64:67] offset:32768
    v_lshlrev_b32 v20, 16, v68
    v_and_b32 v21, s39, v68
    v_lshlrev_b32 v22, 16, v69
    v_and_b32 v23, s39, v69
    v_lshlrev_b32 v24, 16, v70
    v_and_b32 v25, s39, v70
    v_lshlrev_b32 v26, 16, v71
    v_and_b32 v27, s39, v71
    v_pk_fma_f32 v[20:21], v[20:21], v[116:117], v[118:119]
    v_pk_fma_f32 v[22:23], v[22:23], v[116:117], v[118:119]
    v_pk_fma_f32 v[24:25], v[24:25], v[116:117], v[118:119]
    v_pk_fma_f32 v[26:27], v[26:27], v[116:117], v[118:119]
    v_cvt_pk_bf16_f32 v68, v20, v21
    v_cvt_pk_bf16_f32 v69, v22, v23
    v_cvt_pk_bf16_f32 v70, v24, v25
    v_cvt_pk_bf16_f32 v71, v26, v27
    ds_write_b128 v28, v[68:71] offset:33792
    v_lshlrev_b32 v12, 16, v72
    v_and_b32 v13, s39, v72
    v_lshlrev_b32 v14, 16, v73
    v_and_b32 v15, s39, v73
    v_lshlrev_b32 v16, 16, v74
    v_and_b32 v17, s39, v74
    v_lshlrev_b32 v18, 16, v75
    v_and_b32 v19, s39, v75
    v_pk_fma_f32 v[12:13], v[12:13], v[120:121], v[122:123]
    v_pk_fma_f32 v[14:15], v[14:15], v[120:121], v[122:123]
    v_pk_fma_f32 v[16:17], v[16:17], v[120:121], v[122:123]
    v_pk_fma_f32 v[18:19], v[18:19], v[120:121], v[122:123]
    v_cvt_pk_bf16_f32 v72, v12, v13
    v_cvt_pk_bf16_f32 v73, v14, v15
    v_cvt_pk_bf16_f32 v74, v16, v17
    v_cvt_pk_bf16_f32 v75, v18, v19
    ds_write_b128 v28, v[72:75] offset:34816
    v_lshlrev_b32 v20, 16, v76
    v_and_b32 v21, s39, v76
    v_lshlrev_b32 v22, 16, v77
    v_and_b32 v23, s39, v77
    v_lshlrev_b32 v24, 16, v78
    v_and_b32 v25, s39, v78
    v_lshlrev_b32 v26, 16, v79
    v_and_b32 v27, s39, v79
    v_pk_fma_f32 v[20:21], v[20:21], v[124:125], v[126:127]
    v_pk_fma_f32 v[22:23], v[22:23], v[124:125], v[126:127]
    v_pk_fma_f32 v[24:25], v[24:25], v[124:125], v[126:127]
    v_pk_fma_f32 v[26:27], v[26:27], v[124:125], v[126:127]
    v_cvt_pk_bf16_f32 v76, v20, v21
    v_cvt_pk_bf16_f32 v77, v22, v23
    v_cvt_pk_bf16_f32 v78, v24, v25
    v_cvt_pk_bf16_f32 v79, v26, v27
    ds_write_b128 v28, v[76:79] offset:35840
    v_lshlrev_b32 v12, 16, v80
    v_and_b32 v13, s39, v80
    v_lshlrev_b32 v14, 16, v81
    v_and_b32 v15, s39, v81
    v_lshlrev_b32 v16, 16, v82
    v_and_b32 v17, s39, v82
    v_lshlrev_b32 v18, 16, v83
    v_and_b32 v19, s39, v83
    v_pk_fma_f32 v[12:13], v[12:13], v[112:113], v[114:115]
    v_pk_fma_f32 v[14:15], v[14:15], v[112:113], v[114:115]
    v_pk_fma_f32 v[16:17], v[16:17], v[112:113], v[114:115]
    v_pk_fma_f32 v[18:19], v[18:19], v[112:113], v[114:115]
    v_cvt_pk_bf16_f32 v80, v12, v13
    v_cvt_pk_bf16_f32 v81, v14, v15
    v_cvt_pk_bf16_f32 v82, v16, v17
    v_cvt_pk_bf16_f32 v83, v18, v19
    v_accvgpr_write_b32 a32, v80
    v_accvgpr_write_b32 a33, v81
    v_accvgpr_write_b32 a34, v82
    v_accvgpr_write_b32 a35, v83
    v_lshlrev_b32 v20, 16, v84
    v_and_b32 v21, s39, v84
    v_lshlrev_b32 v22, 16, v85
    v_and_b32 v23, s39, v85
    v_lshlrev_b32 v24, 16, v86
    v_and_b32 v25, s39, v86
    v_lshlrev_b32 v26, 16, v87
    v_and_b32 v27, s39, v87
    v_pk_fma_f32 v[20:21], v[20:21], v[116:117], v[118:119]
    v_pk_fma_f32 v[22:23], v[22:23], v[116:117], v[118:119]
    v_pk_fma_f32 v[24:25], v[24:25], v[116:117], v[118:119]
    v_pk_fma_f32 v[26:27], v[26:27], v[116:117], v[118:119]
    v_cvt_pk_bf16_f32 v84, v20, v21
    v_cvt_pk_bf16_f32 v85, v22, v23
    v_cvt_pk_bf16_f32 v86, v24, v25
    v_cvt_pk_bf16_f32 v87, v26, v27
    v_accvgpr_write_b32 a36, v84
    v_accvgpr_write_b32 a37, v85
    v_accvgpr_write_b32 a38, v86
    v_accvgpr_write_b32 a39, v87
    v_lshlrev_b32 v12, 16, v88
    v_and_b32 v13, s39, v88
    v_lshlrev_b32 v14, 16, v89
    v_and_b32 v15, s39, v89
    v_lshlrev_b32 v16, 16, v90
    v_and_b32 v17, s39, v90
    v_lshlrev_b32 v18, 16, v91
    v_and_b32 v19, s39, v91
    v_pk_fma_f32 v[12:13], v[12:13], v[120:121], v[122:123]
    v_pk_fma_f32 v[14:15], v[14:15], v[120:121], v[122:123]
    v_pk_fma_f32 v[16:17], v[16:17], v[120:121], v[122:123]
    v_pk_fma_f32 v[18:19], v[18:19], v[120:121], v[122:123]
    v_cvt_pk_bf16_f32 v88, v12, v13
    v_cvt_pk_bf16_f32 v89, v14, v15
    v_cvt_pk_bf16_f32 v90, v16, v17
    v_cvt_pk_bf16_f32 v91, v18, v19
    v_accvgpr_write_b32 a40, v88
    v_accvgpr_write_b32 a41, v89
    v_accvgpr_write_b32 a42, v90
    v_accvgpr_write_b32 a43, v91
    v_lshlrev_b32 v20, 16, v92
    v_and_b32 v21, s39, v92
    v_lshlrev_b32 v22, 16, v93
    v_and_b32 v23, s39, v93
    v_lshlrev_b32 v24, 16, v94
    v_and_b32 v25, s39, v94
    v_lshlrev_b32 v26, 16, v95
    v_and_b32 v27, s39, v95
    v_pk_fma_f32 v[20:21], v[20:21], v[124:125], v[126:127]
    v_pk_fma_f32 v[22:23], v[22:23], v[124:125], v[126:127]
    v_pk_fma_f32 v[24:25], v[24:25], v[124:125], v[126:127]
    v_pk_fma_f32 v[26:27], v[26:27], v[124:125], v[126:127]
    v_cvt_pk_bf16_f32 v92, v20, v21
    v_cvt_pk_bf16_f32 v93, v22, v23
    v_cvt_pk_bf16_f32 v94, v24, v25
    v_cvt_pk_bf16_f32 v95, v26, v27
    v_accvgpr_write_b32 a44, v92
    v_accvgpr_write_b32 a45, v93
    v_accvgpr_write_b32 a46, v94
    v_accvgpr_write_b32 a47, v95
    s_waitcnt lgkmcnt(0)
    v_mov_b32 v32, 0
    v_mov_b32 v33, 0
    v_mov_b32 v34, 0
    v_mov_b32 v35, 0
    v_mov_b32 v36, 0
    v_mov_b32 v37, 0
    v_mov_b32 v38, 0
    v_mov_b32 v39, 0
    v_mov_b32 v40, 0
    v_mov_b32 v41, 0
    v_mov_b32 v42, 0
    v_mov_b32 v43, 0
    v_mov_b32 v44, 0
    v_mov_b32 v45, 0
    v_mov_b32 v46, 0
    v_mov_b32 v47, 0
    v_mov_b32 v48, 0
    v_mov_b32 v49, 0
    v_mov_b32 v50, 0
    v_mov_b32 v51, 0
    v_mov_b32 v52, 0
    v_mov_b32 v53, 0
    v_mov_b32 v54, 0
    v_mov_b32 v55, 0
    v_mov_b32 v56, 0
    v_mov_b32 v57, 0
    v_mov_b32 v58, 0
    v_mov_b32 v59, 0
    v_mov_b32 v60, 0
    v_mov_b32 v61, 0
    v_mov_b32 v62, 0
    v_mov_b32 v63, 0
    v_mov_b32 v64, 0
    v_mov_b32 v65, 0
    v_mov_b32 v66, 0
    v_mov_b32 v67, 0
    v_mov_b32 v68, 0
    v_mov_b32 v69, 0
    v_mov_b32 v70, 0
    v_mov_b32 v71, 0
    v_mov_b32 v72, 0
    v_mov_b32 v73, 0
    v_mov_b32 v74, 0
    v_mov_b32 v75, 0
    v_mov_b32 v76, 0
    v_mov_b32 v77, 0
    v_mov_b32 v78, 0
    v_mov_b32 v79, 0
    v_mov_b32 v80, 0
    v_mov_b32 v81, 0
    v_mov_b32 v82, 0
    v_mov_b32 v83, 0
    v_mov_b32 v84, 0
    v_mov_b32 v85, 0
    v_mov_b32 v86, 0
    v_mov_b32 v87, 0
    v_mov_b32 v88, 0
    v_mov_b32 v89, 0
    v_mov_b32 v90, 0
    v_mov_b32 v91, 0
    v_mov_b32 v92, 0
    v_mov_b32 v93, 0
    v_mov_b32 v94, 0
    v_mov_b32 v95, 0
    v_mov_b32 v112, 0
    v_mov_b32 v113, 0
    v_mov_b32 v114, 0
    v_mov_b32 v115, 0
    v_mov_b32 v116, 0
    v_mov_b32 v117, 0
    v_mov_b32 v118, 0
    v_mov_b32 v119, 0
    v_mov_b32 v120, 0
    v_mov_b32 v121, 0
    v_mov_b32 v122, 0
    v_mov_b32 v123, 0
    v_mov_b32 v124, 0
    v_mov_b32 v125, 0
    v_mov_b32 v126, 0
    v_mov_b32 v127, 0
    s_barrier
    buffer_load_dword v10, v3, s[48:51], s64 offen
    s_add_u32 s64, s64, s68
    s_cmp_ge_u32 s2, 64
    s_cbranch_scc1 L_mega_kernel_pfs_32
    buffer_load_dword v10, v4, s[52:55], s65 offen
    s_add_u32 s65, s65, s69
L_mega_kernel_pfs_32:
    s_branch L_g1_HP
L_g1_H0:
    ds_read_b128 a[0:3], v9 offset:0
    ds_read_b128 a[4:7], v9 offset:1024
    ds_read_b128 a[8:11], v9 offset:2048
    ds_read_b128 a[12:15], v9 offset:3072
    s_add_u32 s80, s80, 1
    s_cmp_ge_u32 s80, 3
    s_cselect_b32 s81, 4294934528, s83
    s_cselect_b32 s80, 0, s80
    v_add_u32 v9, s81, v9
    ds_read_b64_tr_b16 a[48:49], v7 offset:0
    ds_read_b64_tr_b16 a[50:51], v7 offset:1536
    ds_read_b64_tr_b16 a[52:53], v7 offset:256
    ds_read_b64_tr_b16 a[54:55], v7 offset:1792
    ds_read_b64_tr_b16 a[56:57], v7 offset:512
    ds_read_b64_tr_b16 a[58:59], v7 offset:2048
    s_waitcnt lgkmcnt(0)
    s_mov_b32 s78, 7
L_g1_loopH0:
    s_waitcnt lgkmcnt(4)
    v_mfma_f32_16x16x32_bf16 v[32:35], a[48:51], a[0:3], v[32:35]
    ds_read_b64_tr_b16 a[60:61], v7 offset:768
    v_mfma_f32_16x16x32_bf16 v[36:39], a[48:51], a[4:7], v[36:39]
    ds_read_b64_tr_b16 a[62:63], v7 offset:2304
    v_mfma_f32_16x16x32_bf16 v[40:43], a[48:51], a[8:11], v[40:43]
    s_add_u32 s75, s75, 20480
    v_mfma_f32_16x16x32_bf16 v[44:47], a[48:51], a[12:15], v[44:47]
    s_cmp_ge_u32 s75, 102400
    s_cselect_b32 s76, 4294885376, s82
    s_cselect_b32 s75, 0, s75
    s_waitcnt lgkmcnt(4)
    v_mfma_f32_16x16x32_bf16 v[48:51], a[52:55], a[0:3], v[48:51]
    ds_read_b64_tr_b16 a[48:49], v7 offset:1024
    v_mfma_f32_16x16x32_bf16 v[52:55], a[52:55], a[4:7], v[52:55]
    ds_read_b64_tr_b16 a[50:51], v7 offset:2560
    v_mfma_f32_16x16x32_bf16 v[56:59], a[52:55], a[8:11], v[56:59]
    s_add_u32 m0, s72, 0
    v_mfma_f32_16x16x32_bf16 v[60:63], a[52:55], a[12:15], v[60:63]
    buffer_load_dwordx4 v3, s[48:51], s64 offen lds
    s_waitcnt lgkmcnt(4)
    v_mfma_f32_16x16x32_bf16 v[64:67], a[56:59], a[0:3], v[64:67]
    ds_read_b64_tr_b16 a[52:53], v7 offset:1280
    v_mfma_f32_16x16x32_bf16 v[68:71], a[56:59], a[4:7], v[68:71]
    ds_read_b64_tr_b16 a[54:55], v7 offset:2816
    v_mfma_f32_16x16x32_bf16 v[72:75], a[56:59], a[8:11], v[72:75]
    s_add_u32 s64, s64, s68
    v_mfma_f32_16x16x32_bf16 v[76:79], a[56:59], a[12:15], v[76:79]
    s_add_u32 m0, s72, 1024
    s_waitcnt lgkmcnt(4)
    v_mfma_f32_16x16x32_bf16 a[64:67], a[60:63], a[0:3], a[64:67]
    ds_read_b64_tr_b16 a[56:57], v8 offset:6144
    v_mfma_f32_16x16x32_bf16 a[68:71], a[60:63], a[4:7], a[68:71]
    ds_read_b64_tr_b16 a[58:59], v8 offset:7936
    v_mfma_f32_16x16x32_bf16 a[72:75], a[60:63], a[8:11], a[72:75]
    buffer_load_dwordx4 v4, s[52:55], s65 offen lds
    v_mfma_f32_16x16x32_bf16 a[76:79], a[60:63], a[12:15], a[76:79]
    s_add_u32 s65, s65, s69
    s_waitcnt lgkmcnt(4)
    v_mfma_f32_16x16x32_bf16 v[80:83], a[0:3], a[48:51], v[80:83]
    ds_read_b64_tr_b16 a[60:61], v8 offset:6400
    v_mfma_f32_16x16x32_bf16 a[80:83], a[4:7], a[48:51], a[80:83]
    ds_read_b64_tr_b16 a[62:63], v8 offset:8192
    v_mfma_f32_16x16x32_bf16 v[84:87], a[8:11], a[48:51], v[84:87]
    s_add_u32 s72, s72, 20480
    v_mfma_f32_16x16x32_bf16 a[84:87], a[12:15], a[48:51], a[84:87]
    s_cmp_ge_u32 s72, s74
    s_cselect_b32 s72, s73, s72
    s_waitcnt lgkmcnt(4)
    v_mfma_f32_16x16x32_bf16 v[88:91], a[0:3], a[52:55], v[88:91]
    ds_read_b64_tr_b16 a[48:49], v8 offset:13312
    v_mfma_f32_16x16x32_bf16 a[88:91], a[4:7], a[52:55], a[88:91]
    ds_read_b64_tr_b16 a[50:51], v8 offset:15104
    v_mfma_f32_16x16x32_bf16 v[92:95], a[8:11], a[52:55], v[92:95]
    v_add_u32 v7, s76, v7
    v_mfma_f32_16x16x32_bf16 a[92:95], a[12:15], a[52:55], a[92:95]
    s_waitcnt lgkmcnt(4)
    v_mfma_f32_16x16x32_bf16 v[96:99], a[56:59], a[0:3], v[96:99]
    ds_read_b64_tr_b16 a[52:53], v8 offset:13568
    v_mfma_f32_16x16x32_bf16 v[100:103], a[56:59], a[4:7], v[100:103]
    ds_read_b64_tr_b16 a[54:55], v8 offset:15360
    v_mfma_f32_16x16x32_bf16 v[104:107], a[56:59], a[8:11], v[104:107]
    v_mfma_f32_16x16x32_bf16 v[108:111], a[56:59], a[12:15], v[108:111]
    s_waitcnt lgkmcnt(4)
    v_mfma_f32_16x16x32_bf16 v[112:115], a[60:63], a[0:3], v[112:115]
    s_waitcnt vmcnt(8)
    s_barrier
    ds_read_b64_tr_b16 a[56:57], v7 offset:0
    ds_read_b128 a[16:19], v9 offset:0
    v_mfma_f32_16x16x32_bf16 v[116:119], a[60:63], a[4:7], v[116:119]
    ds_read_b64_tr_b16 a[58:59], v7 offset:1536
    ds_read_b128 a[20:23], v9 offset:1024
    v_mfma_f32_16x16x32_bf16 v[120:123], a[60:63], a[8:11], v[120:123]
    ds_read_b128 a[24:27], v9 offset:2048
    ds_read_b128 a[28:31], v9 offset:3072
    v_mfma_f32_16x16x32_bf16 v[124:127], a[60:63], a[12:15], v[124:127]
    s_cmp_eq_u32 s78, 7
    s_cbranch_scc1 L_mega_kernel_fsa_33
    s_add_u32 m0, s79, s3
    s_nop 0
    buffer_load_dwordx4 v2, s[40:43], s77 offen offset:0 sc1 lds
    buffer_load_dwordx4 v2, s[40:43], s77 offen offset:1024 sc1 lds
    buffer_load_dwordx4 v2, s[40:43], s77 offen offset:2048 sc1 lds
    buffer_load_dwordx4 v2, s[40:43], s77 offen offset:3072 sc1 lds
    s_branch L_mega_kernel_fsb_34
    L_mega_kernel_fsa_33:
    buffer_load_dword v10, v28, s[56:59], 0 offen
    buffer_load_dword v10, v28, s[56:59], 0 offen
    buffer_load_dword v10, v28, s[56:59], 0 offen
    buffer_load_dword v10, v28, s[56:59], 0 offen
    L_mega_kernel_fsb_34:
    s_add_u32 s77, s77, 4096
    s_add_u32 s79, s79, 16384
    s_waitcnt lgkmcnt(8)
    v_mfma_f32_16x16x32_bf16 a[96:99], a[48:51], a[0:3], a[96:99]
    ds_read_b64_tr_b16 a[60:61], v7 offset:256
    s_cmp_ge_u32 s79, 49152
    s_cselect_b32 s79, 0, s79
    v_mfma_f32_16x16x32_bf16 a[100:103], a[48:51], a[4:7], a[100:103]
    ds_read_b64_tr_b16 a[62:63], v7 offset:1792
    s_add_u32 s80, s80, 1
    s_cmp_ge_u32 s80, 3
    s_cselect_b32 s81, 4294934528, s83
    s_cselect_b32 s80, 0, s80
    v_mfma_f32_16x16x32_bf16 a[104:107], a[48:51], a[8:11], a[104:107]
    v_add_u32 v8, s76, v8
    v_add_u32 v9, s81, v9
    v_mfma_f32_16x16x32_bf16 a[108:111], a[48:51], a[12:15], a[108:111]
    s_waitcnt lgkmcnt(8)
    v_mfma_f32_16x16x32_bf16 a[112:115], a[52:55], a[0:3], a[112:115]
    ds_read_b64_tr_b16 a[48:49], v7 offset:512
    v_mfma_f32_16x16x32_bf16 a[116:119], a[52:55], a[4:7], a[116:119]
    ds_read_b64_tr_b16 a[50:51], v7 offset:2048
    v_mfma_f32_16x16x32_bf16 a[120:123], a[52:55], a[8:11], a[120:123]
    v_mfma_f32_16x16x32_bf16 a[124:127], a[52:55], a[12:15], a[124:127]
    s_waitcnt lgkmcnt(4)
    v_mfma_f32_16x16x32_bf16 v[32:35], a[56:59], a[16:19], v[32:35]
    ds_read_b64_tr_b16 a[52:53], v7 offset:768
    v_mfma_f32_16x16x32_bf16 v[36:39], a[56:59], a[20:23], v[36:39]
    ds_read_b64_tr_b16 a[54:55], v7 offset:2304
    v_mfma_f32_16x16x32_bf16 v[40:43], a[56:59], a[24:27], v[40:43]
    s_add_u32 s75, s75, 20480
    v_mfma_f32_16x16x32_bf16 v[44:47], a[56:59], a[28:31], v[44:47]
    s_cmp_ge_u32 s75, 102400
    s_cselect_b32 s76, 4294885376, s82
    s_cselect_b32 s75, 0, s75
    s_waitcnt lgkmcnt(4)
    v_mfma_f32_16x16x32_bf16 v[48:51], a[60:63], a[16:19], v[48:51]
    ds_read_b64_tr_b16 a[56:57], v7 offset:1024
    v_mfma_f32_16x16x32_bf16 v[52:55], a[60:63], a[20:23], v[52:55]
    ds_read_b64_tr_b16 a[58:59], v7 offset:2560
    v_mfma_f32_16x16x32_bf16 v[56:59], a[60:63], a[24:27], v[56:59]
    s_add_u32 m0, s72, 0
    v_mfma_f32_16x16x32_bf16 v[60:63], a[60:63], a[28:31], v[60:63]
    buffer_load_dwordx4 v3, s[48:51], s64 offen lds
    s_waitcnt lgkmcnt(4)
    v_mfma_f32_16x16x32_bf16 v[64:67], a[48:51], a[16:19], v[64:67]
    ds_read_b64_tr_b16 a[60:61], v7 offset:1280
    v_mfma_f32_16x16x32_bf16 v[68:71], a[48:51], a[20:23], v[68:71]
    ds_read_b64_tr_b16 a[62:63], v7 offset:2816
    v_mfma_f32_16x16x32_bf16 v[72:75], a[48:51], a[24:27], v[72:75]
    s_add_u32 s64, s64, s68
    v_mfma_f32_16x16x32_bf16 v[76:79], a[48:51], a[28:31], v[76:79]
    s_add_u32 m0, s72, 1024
    s_waitcnt lgkmcnt(4)
    v_mfma_f32_16x16x32_bf16 a[64:67], a[52:55], a[16:19], a[64:67]
    ds_read_b64_tr_b16 a[48:49], v8 offset:6144
    v_mfma_f32_16x16x32_bf16 a[68:71], a[52:55], a[20:23], a[68:71]
    ds_read_b64_tr_b16 a[50:51], v8 offset:7936
    v_mfma_f32_16x16x32_bf16 a[72:75], a[52:55], a[24:27], a[72:75]
    buffer_load_dwordx4 v4, s[52:55], s65 offen lds
    v_mfma_f32_16x16x32_bf16 a[76:79], a[52:55], a[28:31], a[76:79]
    s_add_u32 s65, s65, s69
    s_waitcnt lgkmcnt(4)
    v_mfma_f32_16x16x32_bf16 v[80:83], a[16:19], a[56:59], v[80:83]
    ds_read_b64_tr_b16 a[52:53], v8 offset:6400
    v_mfma_f32_16x16x32_bf16 a[80:83], a[20:23], a[56:59], a[80:83]
    ds_read_b64_tr_b16 a[54:55], v8 offset:8192
    v_mfma_f32_16x16x32_bf16 v[84:87], a[24:27], a[56:59], v[84:87]
    s_add_u32 s72, s72, 20480
    v_mfma_f32_16x16x32_bf16 a[84:87], a[28:31], a[56:59], a[84:87]
    s_cmp_ge_u32 s72, s74
    s_cselect_b32 s72, s73, s72
    s_waitcnt lgkmcnt(4)
    v_mfma_f32_16x16x32_bf16 v[88:91], a[16:19], a[60:63], v[88:91]
    ds_read_b64_tr_b16 a[56:57], v8 offset:13312
    v_mfma_f32_16x16x32_bf16 a[88:91], a[20:23], a[60:63], a[88:91]
    ds_read_b64_tr_b16 a[58:59], v8 offset:15104
    v_mfma_f32_16x16x32_bf16 v[92:95], a[24:27], a[60:63], v[92:95]
    v_add_u32 v7, s76, v7
    v_mfma_f32_16x16x32_bf16 a[92:95], a[28:31], a[60:63], a[92:95]
    s_waitcnt lgkmcnt(4)
    v_mfma_f32_16x16x32_bf16 v[96:99], a[48:51], a[16:19], v[96:99]
    ds_read_b64_tr_b16 a[60:61], v8 offset:13568
    v_mfma_f32_16x16x32_bf16 v[100:103], a[48:51], a[20:23], v[100:103]
    ds_read_b64_tr_b16 a[62:63], v8 offset:15360
    v_mfma_f32_16x16x32_bf16 v[104:107], a[48:51], a[24:27], v[104:107]
    v_mfma_f32_16x16x32_bf16 v[108:111], a[48:51], a[28:31], v[108:111]
    s_waitcnt lgkmcnt(4)
    v_mfma_f32_16x16x32_bf16 v[112:115], a[52:55], a[16:19], v[112:115]
    s_waitcnt vmcnt(8)
    s_barrier
    ds_read_b64_tr_b16 a[48:49], v7 offset:0
    ds_read_b128 a[0:3], v9 offset:0
    v_mfma_f32_16x16x32_bf16 v[116:119], a[52:55], a[20:23], v[116:119]
    ds_read_b64_tr_b16 a[50:51], v7 offset:1536
    ds_read_b128 a[4:7], v9 offset:1024
    v_mfma_f32_16x16x32_bf16 v[120:123], a[52:55], a[24:27], v[120:123]
    ds_read_b128 a[8:11], v9 offset:2048
    ds_read_b128 a[12:15], v9 offset:3072
    v_mfma_f32_16x16x32_bf16 v[124:127], a[52:55], a[28:31], v[124:127]
    s_cmp_lg_u32 s78, 7
    s_cbranch_scc1 L_mega_kernel_fsp_35
    s_mov_b32 s31, 131072
L_mega_kernel_poll_36:
    buffer_load_dwordx2 v[12:13], v15, s[24:27], s37 offen sc1
    s_waitcnt vmcnt(0)
    v_cmp_ne_u64 vcc, s[32:33], v[12:13]
    s_sub_u32 s31, s31, 1
    s_cbranch_scc1 L_mega_kernel_polld_37
    s_cbranch_vccnz L_mega_kernel_poll_36
L_mega_kernel_polld_37:
L_mega_kernel_fsp_35:
    s_add_u32 m0, s79, s3
    s_waitcnt lgkmcnt(8)
    v_mfma_f32_16x16x32_bf16 a[96:99], a[56:59], a[16:19], a[96:99]
    ds_read_b64_tr_b16 a[52:53], v7 offset:256
    buffer_load_dwordx4 v2, s[40:43], s77 offen offset:0 sc1 lds
    v_mfma_f32_16x16x32_bf16 a[100:103], a[56:59], a[20:23], a[100:103]
    ds_read_b64_tr_b16 a[54:55], v7 offset:1792
    buffer_load_dwordx4 v2, s[40:43], s77 offen offset:1024 sc1 lds
    v_mfma_f32_16x16x32_bf16 a[104:107], a[56:59], a[24:27], a[104:107]
    v_add_u32 v8, s76, v8
    buffer_load_dwordx4 v2, s[40:43], s77 offen offset:2048 sc1 lds
    buffer_load_dwordx4 v2, s[40:43], s77 offen offset:3072 sc1 lds
    v_mfma_f32_16x16x32_bf16 a[108:111], a[56:59], a[28:31], a[108:111]
    s_add_u32 s77, s77, 4096
    s_add_u32 s79, s79, 16384
    s_cmp_ge_u32 s79, 49152
    s_cselect_b32 s79, 0, s79
    s_waitcnt lgkmcnt(8)
    v_mfma_f32_16x16x32_bf16 a[112:115], a[60:63], a[16:19], a[112:115]
    ds_read_b64_tr_b16 a[56:57], v7 offset:512
    s_add_u32 s80, s80, 1
    s_cmp_ge_u32 s80, 3
    s_cselect_b32 s81, 4294934528, s83
    s_cselect_b32 s80, 0, s80
    v_mfma_f32_16x16x32_bf16 a[116:119], a[60:63], a[20:23], a[116:119]
    ds_read_b64_tr_b16 a[58:59], v7 offset:2048
    v_add_u32 v9, s81, v9
    v_mfma_f32_16x16x32_bf16 a[120:123], a[60:63], a[24:27], a[120:123]
    v_mfma_f32_16x16x32_bf16 a[124:127], a[60:63], a[28:31], a[124:127]
    s_waitcnt lgkmcnt(4)
    v_mfma_f32_16x16x32_bf16 v[32:35], a[48:51], a[0:3], v[32:35]
    ds_read_b64_tr_b16 a[60:61], v7 offset:768
    v_mfma_f32_16x16x32_bf16 v[36:39], a[48:51], a[4:7], v[36:39]
    ds_read_b64_tr_b16 a[62:63], v7 offset:2304
    v_mfma_f32_16x16x32_bf16 v[40:43], a[48:51], a[8:11], v[40:43]
    s_add_u32 s75, s75, 20480
    v_mfma_f32_16x16x32_bf16 v[44:47], a[48:51], a[12:15], v[44:47]
    s_cmp_ge_u32 s75, 102400
    s_cselect_b32 s76, 4294885376, s82
    s_cselect_b32 s75, 0, s75
    s_waitcnt lgkmcnt(4)
    v_mfma_f32_16x16x32_bf16 v[48:51], a[52:55], a[0:3], v[48:51]
    ds_read_b64_tr_b16 a[48:49], v7 offset:1024
    v_mfma_f32_16x16x32_bf16 v[52:55], a[52:55], a[4:7], v[52:55]
    ds_read_b64_tr_b16 a[50:51], v7 offset:2560
    v_mfma_f32_16x16x32_bf16 v[56:59], a[52:55], a[8:11], v[56:59]
    s_add_u32 m0, s72, 0
    v_mfma_f32_16x16x32_bf16 v[60:63], a[52:55], a[12:15], v[60:63]
    buffer_load_dwordx4 v3, s[48:51], s64 offen lds
    s_waitcnt lgkmcnt(4)
    v_mfma_f32_16x16x32_bf16 v[64:67], a[56:59], a[0:3], v[64:67]
    ds_read_b64_tr_b16 a[52:53], v7 offset:1280
    v_mfma_f32_16x16x32_bf16 v[68:71], a[56:59], a[4:7], v[68:71]
    ds_read_b64_tr_b16 a[54:55], v7 offset:2816
    v_mfma_f32_16x16x32_bf16 v[72:75], a[56:59], a[8:11], v[72:75]
    s_add_u32 s64, s64, s68
    v_mfma_f32_16x16x32_bf16 v[76:79], a[56:59], a[12:15], v[76:79]
    s_add_u32 m0, s72, 1024
    s_waitcnt lgkmcnt(4)
    v_mfma_f32_16x16x32_bf16 a[64:67], a[60:63], a[0:3], a[64:67]
    ds_read_b64_tr_b16 a[56:57], v8 offset:6144
    v_mfma_f32_16x16x32_bf16 a[68:71], a[60:63], a[4:7], a[68:71]
    ds_read_b64_tr_b16 a[58:59], v8 offset:7936
    v_mfma_f32_16x16x32_bf16 a[72:75], a[60:63], a[8:11], a[72:75]
    buffer_load_dwordx4 v4, s[52:55], s65 offen lds
    v_mfma_f32_16x16x32_bf16 a[76:79], a[60:63], a[12:15], a[76:79]
    s_add_u32 s65, s65, s69
    s_waitcnt lgkmcnt(4)
    v_mfma_f32_16x16x32_bf16 v[80:83], a[0:3], a[48:51], v[80:83]
    ds_read_b64_tr_b16 a[60:61], v8 offset:6400
    v_mfma_f32_16x16x32_bf16 a[80:83], a[4:7], a[48:51], a[80:83]
    ds_read_b64_tr_b16 a[62:63], v8 offset:8192
    v_mfma_f32_16x16x32_bf16 v[84:87], a[8:11], a[48:51], v[84:87]
    s_add_u32 s72, s72, 20480
    v_mfma_f32_16x16x32_bf16 a[84:87], a[12:15], a[48:51], a[84:87]
    s_cmp_ge_u32 s72, s74
    s_cselect_b32 s72, s73, s72
    s_waitcnt lgkmcnt(4)
    v_mfma_f32_16x16x32_bf16 v[88:91], a[0:3], a[52:55], v[88:91]
    ds_read_b64_tr_b16 a[48:49], v8 offset:13312
    v_mfma_f32_16x16x32_bf16 a[88:91], a[4:7], a[52:55], a[88:91]
    ds_read_b64_tr_b16 a[50:51], v8 offset:15104
    v_mfma_f32_16x16x32_bf16 v[92:95], a[8:11], a[52:55], v[92:95]
    v_add_u32 v7, s76, v7
    v_mfma_f32_16x16x32_bf16 a[92:95], a[12:15], a[52:55], a[92:95]
    s_waitcnt lgkmcnt(4)
    v_mfma_f32_16x16x32_bf16 v[96:99], a[56:59], a[0:3], v[96:99]
    ds_read_b64_tr_b16 a[52:53], v8 offset:13568
    v_mfma_f32_16x16x32_bf16 v[100:103], a[56:59], a[4:7], v[100:103]
    ds_read_b64_tr_b16 a[54:55], v8 offset:15360
    v_mfma_f32_16x16x32_bf16 v[104:107], a[56:59], a[8:11], v[104:107]
    v_mfma_f32_16x16x32_bf16 v[108:111], a[56:59], a[12:15], v[108:111]
    s_waitcnt lgkmcnt(4)
    v_mfma_f32_16x16x32_bf16 v[112:115], a[60:63], a[0:3], v[112:115]
    s_waitcnt vmcnt(8)
    s_barrier
    ds_read_b64_tr_b16 a[56:57], v7 offset:0
    ds_read_b128 a[16:19], v9 offset:0
    v_mfma_f32_16x16x32_bf16 v[116:119], a[60:63], a[4:7], v[116:119]
    ds_read_b64_tr_b16 a[58:59], v7 offset:1536
    ds_read_b128 a[20:23], v9 offset:1024
    v_mfma_f32_16x16x32_bf16 v[120:123], a[60:63], a[8:11], v[120:123]
    ds_read_b128 a[24:27], v9 offset:2048
    ds_read_b128 a[28:31], v9 offset:3072
    v_mfma_f32_16x16x32_bf16 v[124:127], a[60:63], a[12:15], v[124:127]
    s_add_u32 m0, s79, s3
    s_nop 0
    buffer_load_dwordx4 v2, s[40:43], s77 offen offset:0 sc1 lds
    s_waitcnt lgkmcnt(8)
    v_mfma_f32_16x16x32_bf16 a[96:99], a[48:51], a[0:3], a[96:99]
    ds_read_b64_tr_b16 a[60:61], v7 offset:256
    buffer_load_dwordx4 v2, s[40:43], s77 offen offset:1024 sc1 lds
    v_mfma_f32_16x16x32_bf16 a[100:103], a[48:51], a[4:7], a[100:103]
    ds_read_b64_tr_b16 a[62:63], v7 offset:1792
    buffer_load_dwordx4 v2, s[40:43], s77 offen offset:2048 sc1 lds
    v_mfma_f32_16x16x32_bf16 a[104:107], a[48:51], a[8:11], a[104:107]
    v_add_u32 v8, s76, v8
    buffer_load_dwordx4 v2, s[40:43], s77 offen offset:3072 sc1 lds
    s_add_u32 s77, s77, 4096
    s_add_u32 s79, s79, 16384
    v_mfma_f32_16x16x32_bf16 a[108:111], a[48:51], a[12:15], a[108:111]
    s_cmp_ge_u32 s79, 49152
    s_cselect_b32 s79, 0, s79
    s_add_u32 s80, s80, 1
    s_cmp_ge_u32 s80, 3
    s_cselect_b32 s81, 4294934528, s83
    s_cselect_b32 s80, 0, s80
    s_waitcnt lgkmcnt(8)
    v_mfma_f32_16x16x32_bf16 a[112:115], a[52:55], a[0:3], a[112:115]
    ds_read_b64_tr_b16 a[48:49], v7 offset:512
    v_add_u32 v9, s81, v9
    v_mfma_f32_16x16x32_bf16 a[116:119], a[52:55], a[4:7], a[116:119]
    ds_read_b64_tr_b16 a[50:51], v7 offset:2048
    v_mfma_f32_16x16x32_bf16 a[120:123], a[52:55], a[8:11], a[120:123]
    v_mfma_f32_16x16x32_bf16 a[124:127], a[52:55], a[12:15], a[124:127]
    s_waitcnt lgkmcnt(4)
    v_mfma_f32_16x16x32_bf16 v[32:35], a[56:59], a[16:19], v[32:35]
    ds_read_b64_tr_b16 a[52:53], v7 offset:768
    v_mfma_f32_16x16x32_bf16 v[36:39], a[56:59], a[20:23], v[36:39]
    ds_read_b64_tr_b16 a[54:55], v7 offset:2304
    v_mfma_f32_16x16x32_bf16 v[40:43], a[56:59], a[24:27], v[40:43]
    s_add_u32 s75, s75, 20480
    v_mfma_f32_16x16x32_bf16 v[44:47], a[56:59], a[28:31], v[44:47]
    s_cmp_ge_u32 s75, 102400
    s_cselect_b32 s76, 4294885376, s82
    s_cselect_b32 s75, 0, s75
    s_waitcnt lgkmcnt(4)
    v_mfma_f32_16x16x32_bf16 v[48:51], a[60:63], a[16:19], v[48:51]
    ds_read_b64_tr_b16 a[56:57], v7 offset:1024
    v_mfma_f32_16x16x32_bf16 v[52:55], a[60:63], a[20:23], v[52:55]
    ds_read_b64_tr_b16 a[58:59], v7 offset:2560
    v_mfma_f32_16x16x32_bf16 v[56:59], a[60:63], a[24:27], v[56:59]
    s_add_u32 m0, s72, 0
    v_mfma_f32_16x16x32_bf16 v[60:63], a[60:63], a[28:31], v[60:63]
    buffer_load_dwordx4 v3, s[48:51], s64 offen lds
    s_waitcnt lgkmcnt(4)
    v_mfma_f32_16x16x32_bf16 v[64:67], a[48:51], a[16:19], v[64:67]
    ds_read_b64_tr_b16 a[60:61], v7 offset:1280
    v_mfma_f32_16x16x32_bf16 v[68:71], a[48:51], a[20:23], v[68:71]
    ds_read_b64_tr_b16 a[62:63], v7 offset:2816
    v_mfma_f32_16x16x32_bf16 v[72:75], a[48:51], a[24:27], v[72:75]
    s_add_u32 s64, s64, s68
    v_mfma_f32_16x16x32_bf16 v[76:79], a[48:51], a[28:31], v[76:79]
    s_add_u32 m0, s72, 1024
    s_waitcnt lgkmcnt(4)
    v_mfma_f32_16x16x32_bf16 a[64:67], a[52:55], a[16:19], a[64:67]
    ds_read_b64_tr_b16 a[48:49], v8 offset:6144
    v_mfma_f32_16x16x32_bf16 a[68:71], a[52:55], a[20:23], a[68:71]
    ds_read_b64_tr_b16 a[50:51], v8 offset:7936
    v_mfma_f32_16x16x32_bf16 a[72:75], a[52:55], a[24:27], a[72:75]
    buffer_load_dwordx4 v4, s[52:55], s65 offen lds
    v_mfma_f32_16x16x32_bf16 a[76:79], a[52:55], a[28:31], a[76:79]
    s_add_u32 s65, s65, s69
    s_waitcnt lgkmcnt(4)
    v_mfma_f32_16x16x32_bf16 v[80:83], a[16:19], a[56:59], v[80:83]
    ds_read_b64_tr_b16 a[52:53], v8 offset:6400
    v_mfma_f32_16x16x32_bf16 a[80:83], a[20:23], a[56:59], a[80:83]
    ds_read_b64_tr_b16 a[54:55], v8 offset:8192
    v_mfma_f32_16x16x32_bf16 v[84:87], a[24:27], a[56:59], v[84:87]
    s_add_u32 s72, s72, 20480
    v_mfma_f32_16x16x32_bf16 a[84:87], a[28:31], a[56:59], a[84:87]
    s_cmp_ge_u32 s72, s74
    s_cselect_b32 s72, s73, s72
    s_waitcnt lgkmcnt(4)
    v_mfma_f32_16x16x32_bf16 v[88:91], a[16:19], a[60:63], v[88:91]
    ds_read_b64_tr_b16 a[56:57], v8 offset:13312
    v_mfma_f32_16x16x32_bf16 a[88:91], a[20:23], a[60:63], a[88:91]
    ds_read_b64_tr_b16 a[58:59], v8 offset:15104
    v_mfma_f32_16x16x32_bf16 v[92:95], a[24:27], a[60:63], v[92:95]
    v_add_u32 v7, s76, v7
    v_mfma_f32_16x16x32_bf16 a[92:95], a[28:31], a[60:63], a[92:95]
    s_waitcnt lgkmcnt(4)
    v_mfma_f32_16x16x32_bf16 v[96:99], a[48:51], a[16:19], v[96:99]
    ds_read_b64_tr_b16 a[60:61], v8 offset:13568
    v_mfma_f32_16x16x32_bf16 v[100:103], a[48:51], a[20:23], v[100:103]
    ds_read_b64_tr_b16 a[62:63], v8 offset:15360
    v_mfma_f32_16x16x32_bf16 v[104:107], a[48:51], a[24:27], v[104:107]
    v_mfma_f32_16x16x32_bf16 v[108:111], a[48:51], a[28:31], v[108:111]
    s_waitcnt lgkmcnt(4)
    v_mfma_f32_16x16x32_bf16 v[112:115], a[52:55], a[16:19], v[112:115]
    s_waitcnt vmcnt(8)
    s_barrier
    ds_read_b64_tr_b16 a[48:49], v7 offset:0
    ds_read_b128 a[0:3], v9 offset:0
    v_mfma_f32_16x16x32_bf16 v[116:119], a[52:55], a[20:23], v[116:119]
    ds_read_b64_tr_b16 a[50:51], v7 offset:1536
    ds_read_b128 a[4:7], v9 offset:1024
    v_mfma_f32_16x16x32_bf16 v[120:123], a[52:55], a[24:27], v[120:123]
    ds_read_b128 a[8:11], v9 offset:2048
    ds_read_b128 a[12:15], v9 offset:3072
    v_mfma_f32_16x16x32_bf16 v[124:127], a[52:55], a[28:31], v[124:127]
    s_add_u32 m0, s79, s3
    s_nop 0
    buffer_load_dwordx4 v2, s[40:43], s77 offen offset:0 sc1 lds
    s_waitcnt lgkmcnt(8)
    v_mfma_f32_16x16x32_bf16 a[96:99], a[56:59], a[16:19], a[96:99]
    ds_read_b64_tr_b16 a[52:53], v7 offset:256
    buffer_load_dwordx4 v2, s[40:43], s77 offen offset:1024 sc1 lds
    v_mfma_f32_16x16x32_bf16 a[100:103], a[56:59], a[20:23], a[100:103]
    ds_read_b64_tr_b16 a[54:55], v7 offset:1792
    buffer_load_dwordx4 v2, s[40:43], s77 offen offset:2048 sc1 lds
    v_mfma_f32_16x16x32_bf16 a[104:107], a[56:59], a[24:27], a[104:107]
    v_add_u32 v8, s76, v8
    buffer_load_dwordx4 v2, s[40:43], s77 offen offset:3072 sc1 lds
    s_add_u32 s77, s77, 4096
    s_add_u32 s79, s79, 16384
    v_mfma_f32_16x16x32_bf16 a[108:111], a[56:59], a[28:31], a[108:111]
    s_cmp_ge_u32 s79, 49152
    s_cselect_b32 s79, 0, s79
    s_add_u32 s80, s80, 1
    s_cmp_ge_u32 s80, 3
    s_cselect_b32 s81, 4294934528, s83
    s_cselect_b32 s80, 0, s80
    s_waitcnt lgkmcnt(8)
    v_mfma_f32_16x16x32_bf16 a[112:115], a[60:63], a[16:19], a[112:115]
    ds_read_b64_tr_b16 a[56:57], v7 offset:512
    v_add_u32 v9, s81, v9
    v_mfma_f32_16x16x32_bf16 a[116:119], a[60:63], a[20:23], a[116:119]
    ds_read_b64_tr_b16 a[58:59], v7 offset:2048
    v_mfma_f32_16x16x32_bf16 a[120:123], a[60:63], a[24:27], a[120:123]
    v_mfma_f32_16x16x32_bf16 a[124:127], a[60:63], a[28:31], a[124:127]
    s_sub_u32 s78, s78, 1
    s_cmp_lg_u32 s78, 0
    s_cbranch_scc1 L_g1_loopH0
    s_waitcnt lgkmcnt(4)
    v_mfma_f32_16x16x32_bf16 v[32:35], a[48:51], a[0:3], v[32:35]
    ds_read_b64_tr_b16 a[60:61], v7 offset:768
    v_mfma_f32_16x16x32_bf16 v[36:39], a[48:51], a[4:7], v[36:39]
    ds_read_b64_tr_b16 a[62:63], v7 offset:2304
    v_mfma_f32_16x16x32_bf16 v[40:43], a[48:51], a[8:11], v[40:43]
    s_add_u32 s75, s75, 20480
    v_mfma_f32_16x16x32_bf16 v[44:47], a[48:51], a[12:15], v[44:47]
    s_cmp_ge_u32 s75, 102400
    s_cselect_b32 s76, 4294885376, s82
    s_cselect_b32 s75, 0, s75
    s_waitcnt lgkmcnt(4)
    v_mfma_f32_16x16x32_bf16 v[48:51], a[52:55], a[0:3], v[48:51]
    ds_read_b64_tr_b16 a[48:49], v7 offset:1024
    v_mfma_f32_16x16x32_bf16 v[52:55], a[52:55], a[4:7], v[52:55]
    ds_read_b64_tr_b16 a[50:51], v7 offset:2560
    v_mfma_f32_16x16x32_bf16 v[56:59], a[52:55], a[8:11], v[56:59]
    s_add_u32 m0, s72, 0
    v_mfma_f32_16x16x32_bf16 v[60:63], a[52:55], a[12:15], v[60:63]
    buffer_load_dwordx4 v3, s[48:51], s64 offen lds
    s_waitcnt lgkmcnt(4)
    v_mfma_f32_16x16x32_bf16 v[64:67], a[56:59], a[0:3], v[64:67]
    ds_read_b64_tr_b16 a[52:53], v7 offset:1280
    v_mfma_f32_16x16x32_bf16 v[68:71], a[56:59], a[4:7], v[68:71]
    ds_read_b64_tr_b16 a[54:55], v7 offset:2816
    v_mfma_f32_16x16x32_bf16 v[72:75], a[56:59], a[8:11], v[72:75]
    s_add_u32 s64, s64, s68
    v_mfma_f32_16x16x32_bf16 v[76:79], a[56:59], a[12:15], v[76:79]
    s_add_u32 m0, s72, 1024
    s_waitcnt lgkmcnt(4)
    v_mfma_f32_16x16x32_bf16 a[64:67], a[60:63], a[0:3], a[64:67]
    ds_read_b64_tr_b16 a[56:57], v8 offset:6144
    v_mfma_f32_16x16x32_bf16 a[68:71], a[60:63], a[4:7], a[68:71]
    ds_read_b64_tr_b16 a[58:59], v8 offset:7936
    v_mfma_f32_16x16x32_bf16 a[72:75], a[60:63], a[8:11], a[72:75]
    buffer_load_dwordx4 v4, s[52:55], s65 offen lds
    v_mfma_f32_16x16x32_bf16 a[76:79], a[60:63], a[12:15], a[76:79]
    s_add_u32 s65, s65, s69
    s_waitcnt lgkmcnt(4)
    v_mfma_f32_16x16x32_bf16 v[80:83], a[0:3], a[48:51], v[80:83]
    ds_read_b64_tr_b16 a[60:61], v8 offset:6400
    v_mfma_f32_16x16x32_bf16 a[80:83], a[4:7], a[48:51], a[80:83]
    ds_read_b64_tr_b16 a[62:63], v8 offset:8192
    v_mfma_f32_16x16x32_bf16 v[84:87], a[8:11], a[48:51], v[84:87]
    s_add_u32 s72, s72, 20480
    v_mfma_f32_16x16x32_bf16 a[84:87], a[12:15], a[48:51], a[84:87]
    s_cmp_ge_u32 s72, s74
    s_cselect_b32 s72, s73, s72
    s_waitcnt lgkmcnt(4)
    v_mfma_f32_16x16x32_bf16 v[88:91], a[0:3], a[52:55], v[88:91]
    ds_read_b64_tr_b16 a[48:49], v8 offset:13312
    v_mfma_f32_16x16x32_bf16 a[88:91], a[4:7], a[52:55], a[88:91]
    ds_read_b64_tr_b16 a[50:51], v8 offset:15104
    v_mfma_f32_16x16x32_bf16 v[92:95], a[8:11], a[52:55], v[92:95]
    v_add_u32 v7, s76, v7
    v_mfma_f32_16x16x32_bf16 a[92:95], a[12:15], a[52:55], a[92:95]
    s_waitcnt lgkmcnt(4)
    v_mfma_f32_16x16x32_bf16 v[96:99], a[56:59], a[0:3], v[96:99]
    ds_read_b64_tr_b16 a[52:53], v8 offset:13568
    v_mfma_f32_16x16x32_bf16 v[100:103], a[56:59], a[4:7], v[100:103]
    ds_read_b64_tr_b16 a[54:55], v8 offset:15360
    v_mfma_f32_16x16x32_bf16 v[104:107], a[56:59], a[8:11], v[104:107]
    v_mfma_f32_16x16x32_bf16 v[108:111], a[56:59], a[12:15], v[108:111]
    s_waitcnt lgkmcnt(4)
    v_mfma_f32_16x16x32_bf16 v[112:115], a[60:63], a[0:3], v[112:115]
    s_waitcnt vmcnt(8)
    s_barrier
    ds_read_b64_tr_b16 a[56:57], v7 offset:0
    ds_read_b128 a[16:19], v9 offset:0
    v_mfma_f32_16x16x32_bf16 v[116:119], a[60:63], a[4:7], v[116:119]
    ds_read_b64_tr_b16 a[58:59], v7 offset:1536
    ds_read_b128 a[20:23], v9 offset:1024
    v_mfma_f32_16x16x32_bf16 v[120:123], a[60:63], a[8:11], v[120:123]
    ds_read_b128 a[24:27], v9 offset:2048
    ds_read_b128 a[28:31], v9 offset:3072
    v_mfma_f32_16x16x32_bf16 v[124:127], a[60:63], a[12:15], v[124:127]
    s_add_u32 s80, s80, 1
    s_cmp_ge_u32 s80, 3
    s_cselect_b32 s81, 4294934528, s83
    s_cselect_b32 s80, 0, s80
    v_add_u32 v9, s81, v9
    s_waitcnt lgkmcnt(8)
    v_mfma_f32_16x16x32_bf16 a[96:99], a[48:51], a[0:3], a[96:99]
    ds_read_b64_tr_b16 a[60:61], v7 offset:256
    s_mov_b32 s77, 126976
    v_mfma_f32_16x16x32_bf16 a[100:103], a[48:51], a[4:7], a[100:103]
    ds_read_b64_tr_b16 a[62:63], v7 offset:1792
    buffer_load_dwordx4 a[32:35], v2, s[40:43], s77 offen offset:0 sc1
    v_mfma_f32_16x16x32_bf16 a[104:107], a[48:51], a[8:11], a[104:107]
    v_add_u32 v8, s76, v8
    buffer_load_dwordx4 a[36:39], v2, s[40:43], s77 offen offset:1024 sc1
    buffer_load_dwordx4 a[40:43], v2, s[40:43], s77 offen offset:2048 sc1
    v_mfma_f32_16x16x32_bf16 a[108:111], a[48:51], a[12:15], a[108:111]
    buffer_load_dwordx4 a[44:47], v2, s[40:43], s77 offen offset:3072 sc1
    s_waitcnt lgkmcnt(8)
    v_mfma_f32_16x16x32_bf16 a[112:115], a[52:55], a[0:3], a[112:115]
    ds_read_b64_tr_b16 a[48:49], v7 offset:512
    v_mfma_f32_16x16x32_bf16 a[116:119], a[52:55], a[4:7], a[116:119]
    ds_read_b64_tr_b16 a[50:51], v7 offset:2048
    v_mfma_f32_16x16x32_bf16 a[120:123], a[52:55], a[8:11], a[120:123]
    v_mfma_f32_16x16x32_bf16 a[124:127], a[52:55], a[12:15], a[124:127]
    s_waitcnt lgkmcnt(4)
    v_mfma_f32_16x16x32_bf16 v[32:35], a[56:59], a[16:19], v[32:35]
    ds_read_b64_tr_b16 a[52:53], v7 offset:768
    v_mfma_f32_16x16x32_bf16 v[36:39], a[56:59], a[20:23], v[36:39]
    ds_read_b64_tr_b16 a[54:55], v7 offset:2304
    v_mfma_f32_16x16x32_bf16 v[40:43], a[56:59], a[24:27], v[40:43]
    s_add_u32 s75, s75, 20480
    s_cmp_ge_u32 s75, 102400
    s_cselect_b32 s76, 4294885376, s82
    s_cselect_b32 s75, 0, s75
    s_and_b32 s38, s28, 3
    v_mfma_f32_16x16x32_bf16 v[44:47], a[56:59], a[28:31], v[44:47]
    s_lshl_b32 s38, s38, 1
    s_lshl_b32 s34, s29, 3
    s_add_u32 s38, s38, s34
    s_waitcnt lgkmcnt(4)
    v_mfma_f32_16x16x32_bf16 v[48:51], a[60:63], a[16:19], v[48:51]
    ds_read_b64_tr_b16 a[56:57], v7 offset:1024
    v_mfma_f32_16x16x32_bf16 v[52:55], a[60:63], a[20:23], v[52:55]
    ds_read_b64_tr_b16 a[58:59], v7 offset:2560
    v_mfma_f32_16x16x32_bf16 v[56:59], a[60:63], a[24:27], v[56:59]
    s_mul_i32 s64, s38, 294912
    s_add_u32 s64, s64, 20971520
    s_mov_b32 s69, s64
    v_mfma_f32_16x16x32_bf16 v[60:63], a[60:63], a[28:31], v[60:63]
    s_mul_i32 s34, s30, 7168
    s_add_u32 s64, s64, s34
    s_add_u32 s65, s64, 294912
    s_waitcnt lgkmcnt(4)
    v_mfma_f32_16x16x32_bf16 v[64:67], a[48:51], a[16:19], v[64:67]
    ds_read_b64_tr_b16 a[60:61], v7 offset:1280
    v_mfma_f32_16x16x32_bf16 v[68:71], a[48:51], a[20:23], v[68:71]
    ds_read_b64_tr_b16 a[62:63], v7 offset:2816
    v_mfma_f32_16x16x32_bf16 v[72:75], a[48:51], a[24:27], v[72:75]
    s_lshl_b32 s35, s30, 18
    s_lshl_b32 s36, s38, 12
    s_add_u32 s35, s35, s36
    v_mfma_f32_16x16x32_bf16 v[76:79], a[48:51], a[28:31], v[76:79]
    s_add_u32 s66, s35, 12582912
    s_add_u32 s67, s66, 4096
    s_waitcnt lgkmcnt(4)
    v_mfma_f32_16x16x32_bf16 a[64:67], a[52:55], a[16:19], a[64:67]
    ds_read_b64_tr_b16 a[48:49], v8 offset:6144
    v_mfma_f32_16x16x32_bf16 a[68:71], a[52:55], a[20:23], a[68:71]
    ds_read_b64_tr_b16 a[50:51], v8 offset:7936
    v_mfma_f32_16x16x32_bf16 a[72:75], a[52:55], a[24:27], a[72:75]
    s_mov_b32 s68, 0x3e8293ee
    v_lshrrev_b32 v12, 4, v1
    v_mfma_f32_16x16x32_bf16 a[76:79], a[52:55], a[28:31], a[76:79]
    v_and_b32 v13, 7, v1
    v_lshlrev_b32 v3, 9, v12
    s_waitcnt lgkmcnt(4)
    v_mfma_f32_16x16x32_bf16 v[80:83], a[16:19], a[56:59], v[80:83]
    ds_read_b64_tr_b16 a[52:53], v8 offset:6400
    v_mfma_f32_16x16x32_bf16 a[80:83], a[20:23], a[56:59], a[80:83]
    ds_read_b64_tr_b16 a[54:55], v8 offset:8192
    v_mfma_f32_16x16x32_bf16 v[84:87], a[24:27], a[56:59], v[84:87]
    v_lshl_add_u32 v3, v13, 4, v3
    v_bfe_u32 v13, v1, 3, 1
    v_mfma_f32_16x16x32_bf16 a[84:87], a[28:31], a[56:59], a[84:87]
    v_lshlrev_b32 v4, 9, v12
    v_lshl_add_u32 v3, v13, 8, v3
    s_waitcnt lgkmcnt(4)
    v_mfma_f32_16x16x32_bf16 v[88:91], a[16:19], a[60:63], v[88:91]
    ds_read_b64_tr_b16 a[56:57], v8 offset:13312
    v_mfma_f32_16x16x32_bf16 a[88:91], a[20:23], a[60:63], a[88:91]
    ds_read_b64_tr_b16 a[58:59], v8 offset:15104
    v_mfma_f32_16x16x32_bf16 v[92:95], a[24:27], a[60:63], v[92:95]
    v_add_u32 v7, s76, v7
    v_lshl_add_u32 v4, v13, 6, v4
    v_bfe_u32 v13, v1, 2, 1
    v_mfma_f32_16x16x32_bf16 a[92:95], a[28:31], a[60:63], a[92:95]
    v_lshl_add_u32 v4, v13, 7, v4
    v_and_b32 v13, 3, v1
    s_waitcnt lgkmcnt(4)
    v_mfma_f32_16x16x32_bf16 v[96:99], a[48:51], a[16:19], v[96:99]
    ds_read_b64_tr_b16 a[60:61], v8 offset:13568
    v_mfma_f32_16x16x32_bf16 v[100:103], a[48:51], a[20:23], v[100:103]
    ds_read_b64_tr_b16 a[62:63], v8 offset:15360
    v_mfma_f32_16x16x32_bf16 v[104:107], a[48:51], a[24:27], v[104:107]
    v_add_u32 v8, s76, v8
    v_lshl_add_u32 v4, v13, 4, v4
    s_lshl_b32 s35, s28, 13
    v_mfma_f32_16x16x32_bf16 v[108:111], a[48:51], a[28:31], v[108:111]
    v_add_u32 v5, s35, v3
    v_add_u32 v6, s35, v4
    s_waitcnt lgkmcnt(4)
    v_mfma_f32_16x16x32_bf16 v[112:115], a[52:55], a[16:19], v[112:115]
    s_waitcnt vmcnt(0)
    s_barrier
    ds_read_b64_tr_b16 a[48:49], v7 offset:512
    ds_read_b128 a[0:3], v9 offset:0
    v_mfma_f32_16x16x32_bf16 v[116:119], a[52:55], a[20:23], v[116:119]
    ds_read_b64_tr_b16 a[50:51], v7 offset:2048
    ds_read_b128 a[4:7], v9 offset:1024
    v_mfma_f32_16x16x32_bf16 v[120:123], a[52:55], a[24:27], v[120:123]
    ds_read_b128 a[8:11], v9 offset:2048
    ds_read_b128 a[12:15], v9 offset:3072
    v_mfma_f32_16x16x32_bf16 v[124:127], a[52:55], a[28:31], v[124:127]
    s_waitcnt lgkmcnt(8)
    v_mfma_f32_16x16x32_bf16 a[96:99], a[56:59], a[16:19], a[96:99]
    ds_read_b64_tr_b16 a[52:53], v7 offset:20992
    v_mfma_f32_16x16x32_bf16 a[100:103], a[56:59], a[20:23], a[100:103]
    ds_read_b64_tr_b16 a[54:55], v7 offset:22528
    v_mfma_f32_16x16x32_bf16 a[104:107], a[56:59], a[24:27], a[104:107]
    v_mfma_f32_16x16x32_bf16 a[108:111], a[56:59], a[28:31], a[108:111]
    s_waitcnt lgkmcnt(8)
    v_mfma_f32_16x16x32_bf16 a[112:115], a[60:63], a[16:19], a[112:115]
    ds_read_b64_tr_b16 a[56:57], v7 offset:768
    v_mfma_f32_16x16x32_bf16 a[116:119], a[60:63], a[20:23], a[116:119]
    ds_read_b64_tr_b16 a[58:59], v7 offset:2304
    v_mfma_f32_16x16x32_bf16 a[120:123], a[60:63], a[24:27], a[120:123]
    v_mfma_f32_16x16x32_bf16 a[124:127], a[60:63], a[28:31], a[124:127]
    s_waitcnt lgkmcnt(4)
    v_mfma_f32_16x16x32_bf16 v[64:67], a[48:51], a[0:3], v[64:67]
    ds_read_b64_tr_b16 a[60:61], v7 offset:21248
    v_mfma_f32_16x16x32_bf16 v[68:71], a[48:51], a[4:7], v[68:71]
    ds_read_b64_tr_b16 a[62:63], v7 offset:22784
    v_mfma_f32_16x16x32_bf16 v[72:75], a[48:51], a[8:11], v[72:75]
    v_mfma_f32_16x16x32_bf16 v[76:79], a[48:51], a[12:15], v[76:79]
    s_waitcnt lgkmcnt(4)
    v_mfma_f32_16x16x32_bf16 v[64:67], a[52:55], a[32:35], v[64:67]
    ds_read_b64_tr_b16 a[48:49], v7 offset:1024
    v_mfma_f32_16x16x32_bf16 v[68:71], a[52:55], a[36:39], v[68:71]
    ds_read_b64_tr_b16 a[50:51], v7 offset:2560
    v_mfma_f32_16x16x32_bf16 v[72:75], a[52:55], a[40:43], v[72:75]
    v_mfma_f32_16x16x32_bf16 v[76:79], a[52:55], a[44:47], v[76:79]
    s_waitcnt lgkmcnt(4)
    v_mfma_f32_16x16x32_bf16 a[64:67], a[56:59], a[0:3], a[64:67]
    ds_read_b64_tr_b16 a[52:53], v7 offset:21504
    v_mfma_f32_16x16x32_bf16 a[68:71], a[56:59], a[4:7], a[68:71]
    ds_read_b64_tr_b16 a[54:55], v7 offset:23040
    v_mfma_f32_16x16x32_bf16 a[72:75], a[56:59], a[8:11], a[72:75]
    v_mfma_f32_16x16x32_bf16 a[76:79], a[56:59], a[12:15], a[76:79]
    s_waitcnt lgkmcnt(4)
    v_mfma_f32_16x16x32_bf16 a[64:67], a[60:63], a[32:35], a[64:67]
    ds_read_b64_tr_b16 a[56:57], v7 offset:1280
    v_mfma_f32_16x16x32_bf16 a[68:71], a[60:63], a[36:39], a[68:71]
    ds_read_b64_tr_b16 a[58:59], v7 offset:2816
    v_mfma_f32_16x16x32_bf16 a[72:75], a[60:63], a[40:43], a[72:75]
    v_mfma_f32_16x16x32_bf16 a[76:79], a[60:63], a[44:47], a[76:79]
    s_waitcnt lgkmcnt(4)
    v_mfma_f32_16x16x32_bf16 v[80:83], a[0:3], a[48:51], v[80:83]
    ds_read_b64_tr_b16 a[60:61], v7 offset:21760
    v_mfma_f32_16x16x32_bf16 a[80:83], a[4:7], a[48:51], a[80:83]
    ds_read_b64_tr_b16 a[62:63], v7 offset:23296
    v_mfma_f32_16x16x32_bf16 v[84:87], a[8:11], a[48:51], v[84:87]
    s_nop 4
    v_mfma_f32_16x16x32_bf16 a[84:87], a[12:15], a[48:51], a[84:87]
    v_accvgpr_read_b32 v16, a64
    v_accvgpr_read_b32 v17, a65
    v_accvgpr_read_b32 v18, a66
    s_waitcnt lgkmcnt(4)
    v_mfma_f32_16x16x32_bf16 v[80:83], a[32:35], a[52:55], v[80:83]
    ds_read_b64_tr_b16 a[48:49], v8 offset:6144
    v_accvgpr_read_b32 v19, a67
    v_cvt_pk_bf16_f32 v64, v64, v65
    v_cvt_pk_bf16_f32 v65, v66, v67
    v_mfma_f32_16x16x32_bf16 a[80:83], a[36:39], a[52:55], a[80:83]
    ds_read_b64_tr_b16 a[50:51], v8 offset:7936
    v_cvt_pk_bf16_f32 v66, v16, v17
    v_cvt_pk_bf16_f32 v67, v18, v19
    buffer_store_dwordx4 v[64:67], v3, s[24:27], s66 offen offset:0 sc1
    v_mfma_f32_16x16x32_bf16 v[84:87], a[40:43], a[52:55], v[84:87]
    ds_write_b128 v5, v[64:67] offset:0
    v_accvgpr_read_b32 v12, a68
    v_accvgpr_read_b32 v13, a69
    v_mfma_f32_16x16x32_bf16 a[84:87], a[44:47], a[52:55], a[84:87]
    v_accvgpr_read_b32 v14, a70
    v_accvgpr_read_b32 v15, a71
    v_cvt_pk_bf16_f32 v68, v68, v69
    s_waitcnt lgkmcnt(5)
    v_mfma_f32_16x16x32_bf16 v[88:91], a[0:3], a[56:59], v[88:91]
    ds_read_b64_tr_b16 a[52:53], v8 offset:26624
    v_cvt_pk_bf16_f32 v69, v70, v71
    v_cvt_pk_bf16_f32 v70, v12, v13
    v_cvt_pk_bf16_f32 v71, v14, v15
    v_mfma_f32_16x16x32_bf16 a[88:91], a[4:7], a[56:59], a[88:91]
    ds_read_b64_tr_b16 a[54:55], v8 offset:28416
    buffer_store_dwordx4 v[68:71], v3, s[24:27], s66 offen offset:128 sc1
    ds_write_b128 v5, v[68:71] offset:128
    v_accvgpr_read_b32 v16, a72
    v_mfma_f32_16x16x32_bf16 v[92:95], a[8:11], a[56:59], v[92:95]
    v_accvgpr_read_b32 v17, a73
    v_accvgpr_read_b32 v18, a74
    v_accvgpr_read_b32 v19, a75
    s_nop 4
    v_mfma_f32_16x16x32_bf16 a[92:95], a[12:15], a[56:59], a[92:95]
    v_cvt_pk_bf16_f32 v72, v72, v73
    v_cvt_pk_bf16_f32 v73, v74, v75
    v_cvt_pk_bf16_f32 v74, v16, v17
    s_waitcnt lgkmcnt(6)
    v_mfma_f32_16x16x32_bf16 v[88:91], a[32:35], a[60:63], v[88:91]
    ds_read_b64_tr_b16 a[56:57], v8 offset:13312
    v_cvt_pk_bf16_f32 v75, v18, v19
    buffer_store_dwordx4 v[72:75], v3, s[24:27], s67 offen offset:0 sc1
    ds_write_b128 v5, v[72:75] offset:4096
    v_mfma_f32_16x16x32_bf16 a[88:91], a[36:39], a[60:63], a[88:91]
    ds_read_b64_tr_b16 a[58:59], v8 offset:15104
    v_accvgpr_read_b32 v12, a76
    v_accvgpr_read_b32 v13, a77
    v_accvgpr_read_b32 v14, a78
    v_mfma_f32_16x16x32_bf16 v[92:95], a[40:43], a[60:63], v[92:95]
    v_accvgpr_read_b32 v15, a79
    v_cvt_pk_bf16_f32 v76, v76, v77
    v_cvt_pk_bf16_f32 v77, v78, v79
    v_mfma_f32_16x16x32_bf16 a[92:95], a[44:47], a[60:63], a[92:95]
    v_cvt_pk_bf16_f32 v78, v12, v13
    v_cvt_pk_bf16_f32 v79, v14, v15
    buffer_store_dwordx4 v[76:79], v3, s[24:27], s67 offen offset:128 sc1
    s_waitcnt lgkmcnt(7)
    v_mfma_f32_16x16x32_bf16 v[96:99], a[48:51], a[0:3], v[96:99]
    ds_read_b64_tr_b16 a[60:61], v8 offset:33792
    ds_write_b128 v5, v[76:79] offset:4224
    v_accvgpr_read_b32 v16, a80
    v_accvgpr_read_b32 v17, a81
    v_mfma_f32_16x16x32_bf16 v[100:103], a[48:51], a[4:7], v[100:103]
    ds_read_b64_tr_b16 a[62:63], v8 offset:35584
    v_accvgpr_read_b32 v18, a82
    v_accvgpr_read_b32 v19, a83
    v_cvt_pk_bf16_f32 v80, v80, v81
    v_mfma_f32_16x16x32_bf16 v[104:107], a[48:51], a[8:11], v[104:107]
    v_cvt_pk_bf16_f32 v81, v82, v83
    v_cvt_pk_bf16_f32 v82, v16, v17
    v_cvt_pk_bf16_f32 v83, v18, v19
    s_nop 4
    v_mfma_f32_16x16x32_bf16 v[108:111], a[48:51], a[12:15], v[108:111]
    buffer_store_dwordx4 v[80:83], v4, s[24:27], s66 offen offset:2048 sc1
    ds_write_b128 v6, v[80:83] offset:2048
    v_accvgpr_read_b32 v12, a84
    s_waitcnt lgkmcnt(8)
    v_mfma_f32_16x16x32_bf16 v[96:99], a[52:55], a[32:35], v[96:99]
    ds_read_b64_tr_b16 a[48:49], v8 offset:6400
    v_accvgpr_read_b32 v13, a85
    v_accvgpr_read_b32 v14, a86
    v_accvgpr_read_b32 v15, a87
    v_mfma_f32_16x16x32_bf16 v[100:103], a[52:55], a[36:39], v[100:103]
    ds_read_b64_tr_b16 a[50:51], v8 offset:8192
    v_cvt_pk_bf16_f32 v84, v84, v85
    v_cvt_pk_bf16_f32 v85, v86, v87
    v_cvt_pk_bf16_f32 v86, v12, v13
    v_mfma_f32_16x16x32_bf16 v[104:107], a[52:55], a[40:43], v[104:107]
    v_cvt_pk_bf16_f32 v87, v14, v15
    buffer_store_dwordx4 v[84:87], v4, s[24:27], s67 offen offset:2048 sc1
    ds_write_b128 v6, v[84:87] offset:6144
    v_mfma_f32_16x16x32_bf16 v[108:111], a[52:55], a[44:47], v[108:111]
    v_accvgpr_read_b32 v16, a88
    v_accvgpr_read_b32 v17, a89
    v_accvgpr_read_b32 v18, a90
    s_waitcnt lgkmcnt(7)
    v_mfma_f32_16x16x32_bf16 a[96:99], a[56:59], a[0:3], a[96:99]
    ds_read_b64_tr_b16 a[52:53], v8 offset:26880
    v_accvgpr_read_b32 v19, a91
    v_cvt_pk_bf16_f32 v88, v88, v89
    v_cvt_pk_bf16_f32 v89, v90, v91
    v_mfma_f32_16x16x32_bf16 a[100:103], a[56:59], a[4:7], a[100:103]
    ds_read_b64_tr_b16 a[54:55], v8 offset:28672
    v_cvt_pk_bf16_f32 v90, v16, v17
    v_cvt_pk_bf16_f32 v91, v18, v19
    buffer_store_dwordx4 v[88:91], v4, s[24:27], s66 offen offset:2304 sc1
    v_mfma_f32_16x16x32_bf16 a[104:107], a[56:59], a[8:11], a[104:107]
    ds_write_b128 v6, v[88:91] offset:2304
    v_accvgpr_read_b32 v12, a92
    v_accvgpr_read_b32 v13, a93
    v_mfma_f32_16x16x32_bf16 a[108:111], a[56:59], a[12:15], a[108:111]
    v_accvgpr_read_b32 v14, a94
    v_accvgpr_read_b32 v15, a95
    v_cvt_pk_bf16_f32 v92, v92, v93
    s_waitcnt lgkmcnt(7)
    v_mfma_f32_16x16x32_bf16 a[96:99], a[60:63], a[32:35], a[96:99]
    ds_read_b64_tr_b16 a[56:57], v8 offset:13568
    v_cvt_pk_bf16_f32 v93, v94, v95
    v_cvt_pk_bf16_f32 v94, v12, v13
    v_cvt_pk_bf16_f32 v95, v14, v15
    v_mfma_f32_16x16x32_bf16 a[100:103], a[60:63], a[36:39], a[100:103]
    ds_read_b64_tr_b16 a[58:59], v8 offset:15360
    buffer_store_dwordx4 v[92:95], v4, s[24:27], s67 offen offset:2304 sc1
    ds_write_b128 v6, v[92:95] offset:6400
    v_mfma_f32_16x16x32_bf16 a[104:107], a[60:63], a[40:43], a[104:107]
    v_mfma_f32_16x16x32_bf16 a[108:111], a[60:63], a[44:47], a[108:111]
    s_waitcnt lgkmcnt(7)
    v_mfma_f32_16x16x32_bf16 v[112:115], a[48:51], a[0:3], v[112:115]
    ds_read_b64_tr_b16 a[60:61], v8 offset:34048
    v_mfma_f32_16x16x32_bf16 v[116:119], a[48:51], a[4:7], v[116:119]
    ds_read_b64_tr_b16 a[62:63], v8 offset:35840
    v_mfma_f32_16x16x32_bf16 v[120:123], a[48:51], a[8:11], v[120:123]
    s_nop 4
    v_mfma_f32_16x16x32_bf16 v[124:127], a[48:51], a[12:15], v[124:127]
    v_mul_f32 v96, 0xbfb8aa3b, v96
    v_mul_f32 v97, 0xbfb8aa3b, v97
    v_mul_f32 v98, 0xbfb8aa3b, v98
    s_waitcnt lgkmcnt(6)
    v_mfma_f32_16x16x32_bf16 v[112:115], a[52:55], a[32:35], v[112:115]
    ds_read_b64_tr_b16 a[48:49], v7 offset:0
    v_mul_f32 v99, 0xbfb8aa3b, v99
    v_mul_f32 v100, 0xbfb8aa3b, v100
    v_mul_f32 v101, 0xbfb8aa3b, v101
    v_mfma_f32_16x16x32_bf16 v[116:119], a[52:55], a[36:39], v[116:119]
    ds_read_b64_tr_b16 a[50:51], v7 offset:1536
    v_mul_f32 v102, 0xbfb8aa3b, v102
    v_mul_f32 v103, 0xbfb8aa3b, v103
    v_exp_f32 v96, v96
    v_mfma_f32_16x16x32_bf16 v[120:123], a[52:55], a[40:43], v[120:123]
    v_exp_f32 v97, v97
    v_exp_f32 v98, v98
    v_exp_f32 v99, v99
    v_mfma_f32_16x16x32_bf16 v[124:127], a[52:55], a[44:47], v[124:127]
    v_exp_f32 v100, v100
    v_exp_f32 v101, v101
    v_exp_f32 v102, v102
    s_waitcnt lgkmcnt(5)
    v_mfma_f32_16x16x32_bf16 a[112:115], a[56:59], a[0:3], a[112:115]
    ds_read_b64_tr_b16 a[52:53], v7 offset:20480
    v_exp_f32 v103, v103
    v_add_f32 v96, 1.0, v96
    v_add_f32 v97, 1.0, v97
    v_mfma_f32_16x16x32_bf16 a[116:119], a[56:59], a[4:7], a[116:119]
    ds_read_b64_tr_b16 a[54:55], v7 offset:22016
    v_add_f32 v98, 1.0, v98
    v_add_f32 v99, 1.0, v99
    v_add_f32 v100, 1.0, v100
    v_mfma_f32_16x16x32_bf16 a[120:123], a[56:59], a[8:11], a[120:123]
    v_add_f32 v101, 1.0, v101
    v_add_f32 v102, 1.0, v102
    v_add_f32 v103, 1.0, v103
    v_mfma_f32_16x16x32_bf16 a[124:127], a[56:59], a[12:15], a[124:127]
    v_rcp_f32 v96, v96
    v_rcp_f32 v97, v97
    v_rcp_f32 v98, v98
    s_waitcnt lgkmcnt(4)
    v_mfma_f32_16x16x32_bf16 a[112:115], a[60:63], a[32:35], a[112:115]
    ds_read_b64_tr_b16 a[56:57], v7 offset:256
    v_rcp_f32 v99, v99
    v_rcp_f32 v100, v100
    v_rcp_f32 v101, v101
    v_mfma_f32_16x16x32_bf16 a[116:119], a[60:63], a[36:39], a[116:119]
    ds_read_b64_tr_b16 a[58:59], v7 offset:1792
    v_rcp_f32 v102, v102
    v_rcp_f32 v103, v103
    v_accvgpr_read_b32 v20, a96
    v_mfma_f32_16x16x32_bf16 a[120:123], a[60:63], a[40:43], a[120:123]
    v_accvgpr_read_b32 v21, a97
    v_accvgpr_read_b32 v22, a98
    v_accvgpr_read_b32 v23, a99
    v_mfma_f32_16x16x32_bf16 a[124:127], a[60:63], a[44:47], a[124:127]
    v_accvgpr_read_b32 v24, a100
    v_accvgpr_read_b32 v25, a101
    v_accvgpr_read_b32 v26, a102
    s_waitcnt lgkmcnt(4)
    v_mfma_f32_16x16x32_bf16 v[32:35], a[48:51], a[0:3], v[32:35]
    ds_read_b64_tr_b16 a[60:61], v7 offset:20736
    v_accvgpr_read_b32 v27, a103
    v_mul_f32 v96, v96, v20
    v_mul_f32 v97, v97, v21
    v_mfma_f32_16x16x32_bf16 v[36:39], a[48:51], a[4:7], v[36:39]
    ds_read_b64_tr_b16 a[62:63], v7 offset:22272
    v_mul_f32 v98, v98, v22
    v_mul_f32 v99, v99, v23
    v_mul_f32 v100, v100, v24
    v_mfma_f32_16x16x32_bf16 v[40:43], a[48:51], a[8:11], v[40:43]
    v_mul_f32 v101, v101, v25
    v_mul_f32 v102, v102, v26
    v_mul_f32 v103, v103, v27
    s_nop 4
    v_mfma_f32_16x16x32_bf16 v[44:47], a[48:51], a[12:15], v[44:47]
    v_cvt_pk_bf16_f32 v96, v96, v97
    v_cvt_pk_bf16_f32 v97, v98, v99
    v_cvt_pk_bf16_f32 v98, v100, v101
    s_waitcnt lgkmcnt(4)
    v_mfma_f32_16x16x32_bf16 v[32:35], a[52:55], a[32:35], v[32:35]
    v_cvt_pk_bf16_f32 v99, v102, v103
    s_nop 1
    v_permlane16_swap_b32 v96, v98
    v_mfma_f32_16x16x32_bf16 v[36:39], a[52:55], a[36:39], v[36:39]
    v_permlane16_swap_b32 v97, v99
    buffer_store_dwordx4 v[96:99], v2, s[24:27], s64 offen offset:0 sc1
    v_mul_f32 v104, 0xbfb8aa3b, v104
    v_mfma_f32_16x16x32_bf16 v[40:43], a[52:55], a[40:43], v[40:43]
    v_mul_f32 v105, 0xbfb8aa3b, v105
    v_mul_f32 v106, 0xbfb8aa3b, v106
    v_mul_f32 v107, 0xbfb8aa3b, v107
    v_mfma_f32_16x16x32_bf16 v[44:47], a[52:55], a[44:47], v[44:47]
    v_mul_f32 v108, 0xbfb8aa3b, v108
    v_mul_f32 v109, 0xbfb8aa3b, v109
    v_mul_f32 v110, 0xbfb8aa3b, v110
    s_waitcnt lgkmcnt(2)
    v_mfma_f32_16x16x32_bf16 v[48:51], a[56:59], a[0:3], v[48:51]
    v_mul_f32 v111, 0xbfb8aa3b, v111
    v_exp_f32 v104, v104
    v_exp_f32 v105, v105
    v_mfma_f32_16x16x32_bf16 v[52:55], a[56:59], a[4:7], v[52:55]
    v_exp_f32 v106, v106
    v_exp_f32 v107, v107
    v_exp_f32 v108, v108
    v_mfma_f32_16x16x32_bf16 v[56:59], a[56:59], a[8:11], v[56:59]
    v_exp_f32 v109, v109
    v_exp_f32 v110, v110
    v_exp_f32 v111, v111
    v_mfma_f32_16x16x32_bf16 v[60:63], a[56:59], a[12:15], v[60:63]
    v_add_f32 v104, 1.0, v104
    v_add_f32 v105, 1.0, v105
    v_add_f32 v106, 1.0, v106
    s_waitcnt lgkmcnt(0)
    v_mfma_f32_16x16x32_bf16 v[48:51], a[60:63], a[32:35], v[48:51]
    v_add_f32 v107, 1.0, v107
    v_add_f32 v108, 1.0, v108
    v_add_f32 v109, 1.0, v109
    v_mfma_f32_16x16x32_bf16 v[52:55], a[60:63], a[36:39], v[52:55]
    v_add_f32 v110, 1.0, v110
    v_add_f32 v111, 1.0, v111
    v_rcp_f32 v104, v104
    v_mfma_f32_16x16x32_bf16 v[56:59], a[60:63], a[40:43], v[56:59]
    v_rcp_f32 v105, v105
    v_rcp_f32 v106, v106
    v_rcp_f32 v107, v107
    v_mfma_f32_16x16x32_bf16 v[60:63], a[60:63], a[44:47], v[60:63]
    v_rcp_f32 v108, v108
    v_rcp_f32 v109, v109
    v_rcp_f32 v110, v110
    s_barrier
    s_nop 7
    s_lshl_b32 s35, s28, 12
    s_add_u32 s35, s35, 122880
    v_add_u32 v10, s35, v3
    v_add_u32 v11, s35, v2
    v_mul_f32 v32, s68, v32
    v_mul_f32 v33, s68, v33
    v_mul_f32 v34, s68, v34
    v_mul_f32 v35, s68, v35
    v_mul_f32 v48, s68, v48
    v_mul_f32 v49, s68, v49
    v_mul_f32 v50, s68, v50
    v_mul_f32 v51, s68, v51
    v_cvt_pk_bf16_f32 v32, v32, v33
    v_cvt_pk_bf16_f32 v33, v34, v35
    v_cvt_pk_bf16_f32 v34, v48, v49
    v_cvt_pk_bf16_f32 v35, v50, v51
    ds_write_b128 v10, v[32:35] offset:0
    v_mul_f32 v36, s68, v36
    v_mul_f32 v37, s68, v37
    v_mul_f32 v38, s68, v38
    v_mul_f32 v39, s68, v39
    v_mul_f32 v52, s68, v52
    v_mul_f32 v53, s68, v53
    v_mul_f32 v54, s68, v54
    v_mul_f32 v55, s68, v55
    v_cvt_pk_bf16_f32 v36, v36, v37
    v_cvt_pk_bf16_f32 v37, v38, v39
    v_cvt_pk_bf16_f32 v38, v52, v53
    v_cvt_pk_bf16_f32 v39, v54, v55
    ds_write_b128 v10, v[36:39] offset:128
    v_mul_f32 v40, s68, v40
    v_mul_f32 v41, s68, v41
    v_mul_f32 v42, s68, v42
    v_mul_f32 v43, s68, v43
    v_mul_f32 v56, s68, v56
    v_mul_f32 v57, s68, v57
    v_mul_f32 v58, s68, v58
    v_mul_f32 v59, s68, v59
    v_cvt_pk_bf16_f32 v40, v40, v41
    v_cvt_pk_bf16_f32 v41, v42, v43
    v_cvt_pk_bf16_f32 v42, v56, v57
    v_cvt_pk_bf16_f32 v43, v58, v59
    ds_write_b128 v10, v[40:43] offset:2048
    v_mul_f32 v44, s68, v44
    v_mul_f32 v45, s68, v45
    v_mul_f32 v46, s68, v46
    v_mul_f32 v47, s68, v47
    v_mul_f32 v60, s68, v60
    v_mul_f32 v61, s68, v61
    v_mul_f32 v62, s68, v62
    v_mul_f32 v63, s68, v63
    v_cvt_pk_bf16_f32 v44, v44, v45
    v_cvt_pk_bf16_f32 v45, v46, v47
    v_cvt_pk_bf16_f32 v46, v60, v61
    v_cvt_pk_bf16_f32 v47, v62, v63
    ds_write_b128 v10, v[44:47] offset:2176
    v_rcp_f32 v111, v111
    v_accvgpr_read_b32 v20, a104
    v_accvgpr_read_b32 v21, a105
    v_accvgpr_read_b32 v22, a106
    v_accvgpr_read_b32 v23, a107
    v_accvgpr_read_b32 v24, a108
    v_accvgpr_read_b32 v25, a109
    v_accvgpr_read_b32 v26, a110
    v_accvgpr_read_b32 v27, a111
    v_mul_f32 v104, v104, v20
    v_mul_f32 v105, v105, v21
    v_mul_f32 v106, v106, v22
    v_mul_f32 v107, v107, v23
    v_mul_f32 v108, v108, v24
    v_mul_f32 v109, v109, v25
    v_mul_f32 v110, v110, v26
    v_mul_f32 v111, v111, v27
    v_cvt_pk_bf16_f32 v104, v104, v105
    v_cvt_pk_bf16_f32 v105, v106, v107
    v_cvt_pk_bf16_f32 v106, v108, v109
    v_cvt_pk_bf16_f32 v107, v110, v111
    s_nop 1
    v_permlane16_swap_b32 v104, v106
    v_permlane16_swap_b32 v105, v107
    buffer_store_dwordx4 v[104:107], v2, s[24:27], s65 offen offset:0 sc1
    v_mul_f32 v112, 0xbfb8aa3b, v112
    v_mul_f32 v113, 0xbfb8aa3b, v113
    v_mul_f32 v114, 0xbfb8aa3b, v114
    v_mul_f32 v115, 0xbfb8aa3b, v115
    v_mul_f32 v116, 0xbfb8aa3b, v116
    v_mul_f32 v117, 0xbfb8aa3b, v117
    v_mul_f32 v118, 0xbfb8aa3b, v118
    v_mul_f32 v119, 0xbfb8aa3b, v119
    v_exp_f32 v112, v112
    v_exp_f32 v113, v113
    v_exp_f32 v114, v114
    v_exp_f32 v115, v115
    v_exp_f32 v116, v116
    v_exp_f32 v117, v117
    v_exp_f32 v118, v118
    v_exp_f32 v119, v119
    v_add_f32 v112, 1.0, v112
    v_add_f32 v113, 1.0, v113
    v_add_f32 v114, 1.0, v114
    v_add_f32 v115, 1.0, v115
    v_add_f32 v116, 1.0, v116
    v_add_f32 v117, 1.0, v117
    v_add_f32 v118, 1.0, v118
    v_add_f32 v119, 1.0, v119
    v_rcp_f32 v112, v112
    v_rcp_f32 v113, v113
    v_rcp_f32 v114, v114
    v_rcp_f32 v115, v115
    v_rcp_f32 v116, v116
    v_rcp_f32 v117, v117
    v_rcp_f32 v118, v118
    v_rcp_f32 v119, v119
    v_accvgpr_read_b32 v20, a112
    v_accvgpr_read_b32 v21, a113
    v_accvgpr_read_b32 v22, a114
    v_accvgpr_read_b32 v23, a115
    v_accvgpr_read_b32 v24, a116
    v_accvgpr_read_b32 v25, a117
    v_accvgpr_read_b32 v26, a118
    v_accvgpr_read_b32 v27, a119
    v_mul_f32 v112, v112, v20
    v_mul_f32 v113, v113, v21
    v_mul_f32 v114, v114, v22
    v_mul_f32 v115, v115, v23
    v_mul_f32 v116, v116, v24
    v_mul_f32 v117, v117, v25
    v_mul_f32 v118, v118, v26
    v_mul_f32 v119, v119, v27
    v_cvt_pk_bf16_f32 v112, v112, v113
    v_cvt_pk_bf16_f32 v113, v114, v115
    v_cvt_pk_bf16_f32 v114, v116, v117
    v_cvt_pk_bf16_f32 v115, v118, v119
    s_nop 1
    v_permlane16_swap_b32 v112, v114
    v_permlane16_swap_b32 v113, v115
    buffer_store_dwordx4 v[112:115], v2, s[24:27], s64 offen offset:1024 sc1
    v_mul_f32 v120, 0xbfb8aa3b, v120
    v_mul_f32 v121, 0xbfb8aa3b, v121
    v_mul_f32 v122, 0xbfb8aa3b, v122
    v_mul_f32 v123, 0xbfb8aa3b, v123
    v_mul_f32 v124, 0xbfb8aa3b, v124
    v_mul_f32 v125, 0xbfb8aa3b, v125
    v_mul_f32 v126, 0xbfb8aa3b, v126
    v_mul_f32 v127, 0xbfb8aa3b, v127
    v_exp_f32 v120, v120
    v_exp_f32 v121, v121
    v_exp_f32 v122, v122
    v_exp_f32 v123, v123
    v_exp_f32 v124, v124
    v_exp_f32 v125, v125
    v_exp_f32 v126, v126
    v_exp_f32 v127, v127
    v_add_f32 v120, 1.0, v120
    v_add_f32 v121, 1.0, v121
    v_add_f32 v122, 1.0, v122
    v_add_f32 v123, 1.0, v123
    v_add_f32 v124, 1.0, v124
    v_add_f32 v125, 1.0, v125
    v_add_f32 v126, 1.0, v126
    v_add_f32 v127, 1.0, v127
    v_rcp_f32 v120, v120
    v_rcp_f32 v121, v121
    v_rcp_f32 v122, v122
    v_rcp_f32 v123, v123
    v_rcp_f32 v124, v124
    v_rcp_f32 v125, v125
    v_rcp_f32 v126, v126
    v_rcp_f32 v127, v127
    v_accvgpr_read_b32 v20, a120
    v_accvgpr_read_b32 v21, a121
    v_accvgpr_read_b32 v22, a122
    v_accvgpr_read_b32 v23, a123
    v_accvgpr_read_b32 v24, a124
    v_accvgpr_read_b32 v25, a125
    v_accvgpr_read_b32 v26, a126
    v_accvgpr_read_b32 v27, a127
    v_mul_f32 v120, v120, v20
    v_mul_f32 v121, v121, v21
    v_mul_f32 v122, v122, v22
    v_mul_f32 v123, v123, v23
    v_mul_f32 v124, v124, v24
    v_mul_f32 v125, v125, v25
    v_mul_f32 v126, v126, v26
    v_mul_f32 v127, v127, v27
    v_cvt_pk_bf16_f32 v120, v120, v121
    v_cvt_pk_bf16_f32 v121, v122, v123
    v_cvt_pk_bf16_f32 v122, v124, v125
    v_cvt_pk_bf16_f32 v123, v126, v127
    s_nop 1
    v_permlane16_swap_b32 v120, v122
    v_permlane16_swap_b32 v121, v123
    buffer_store_dwordx4 v[120:123], v2, s[24:27], s65 offen offset:1024 sc1
    ds_read_b128 a[0:3], v11 offset:0
    ds_read_b128 a[4:7], v11 offset:1024
    ds_read_b128 a[8:11], v11 offset:2048
    ds_read_b128 a[12:15], v11 offset:3072
    s_lshl_b32 s34, s30, 18
    s_add_u32 s34, s34, 12582912
    s_add_u32 s48, s22, s34
    s_addc_u32 s49, s23, 0
    s_and_b32 s49, s49, 0xffff
    s_mov_b32 s50, 262144
    s_mov_b32 s51, 0x00020000
    s_lshl_b32 s35, s28, 11
    v_add_u32 v5, s35, v2
    s_add_u32 s66, s35, 0
    s_add_u32 s67, s66, 40960
    s_add_u32 s61, s66, 32768
    s_add_u32 s60, s29, 1
    s_and_b32 s60, s60, 7
    s_lshl_b32 s60, s60, 15
    s_add_u32 s35, s30, 112
    s_lshl_b32 s35, s35, 11
    s_add_u32 s64, s69, s35
    s_add_u32 s65, s64, 294912
    v_and_b32 v12, 7, v1
    v_bfe_u32 v13, v1, 3, 1
    v_bfe_u32 v14, v1, 4, 1
    v_lshrrev_b32 v15, 5, v1
    v_lshlrev_b32 v4, 4, v12
    v_lshl_add_u32 v4, v13, 8, v4
    v_lshl_add_u32 v4, v14, 7, v4
    v_lshl_add_u32 v4, v15, 9, v4
    v_and_b32 v6, 31, v1
    v_lshlrev_b32 v6, 3, v6
    v_and_b32 v13, 1, v1
    v_cmp_eq_u32 vcc, 0, v13
    v_mov_b32 v14, 0x3f803f80
    v_add_u32 v3, 0, v2
    v_cndmask_b32 v7, 0, v14, vcc
    s_mov_b32 s62, 0
    s_mov_b32 s68, 4294934528
    s_mov_b32 s69, 8192
    v_and_b32 v8, 3, v1
    v_lshlrev_b32 v8, 2, v8
    v_add_u32 v9, 156704, v8
    s_lshl_b32 s35, s28, 2
    s_add_u32 s35, s35, 156704
    v_mov_b32 v10, s35
    v_mov_b32 v11, 0
    s_mov_b32 s71, 0
    s_nop 1
    v_mov_b32 v104, v7
    v_mov_b32 v105, v7
    v_xor_b32 v106, 0x3f803f80, v7
    v_xor_b32 v107, 0x3f803f80, v7
    v_bfe_u32 v13, v1, 1, 1
    v_mul_u32_u24 v13, 0xaaaa, v13
    v_or_b32 v108, 0x4444, v13
    v_mov_b32 v64, 0
    v_mov_b32 v65, 0
    v_mov_b32 v66, 0
    v_mov_b32 v67, 0
    v_mov_b32 v68, 0
    v_mov_b32 v69, 0
    v_mov_b32 v70, 0
    v_mov_b32 v71, 0
    v_mov_b32 v72, 0
    v_mov_b32 v73, 0
    v_mov_b32 v74, 0
    v_mov_b32 v75, 0
    v_mov_b32 v76, 0
    v_mov_b32 v77, 0
    v_mov_b32 v78, 0
    v_mov_b32 v79, 0
    v_mov_b32 v80, 0
    v_mov_b32 v81, 0
    v_mov_b32 v82, 0
    v_mov_b32 v83, 0
    v_mov_b32 v84, 0
    v_mov_b32 v85, 0
    v_mov_b32 v86, 0
    v_mov_b32 v87, 0
    v_mov_b32 v88, 0
    v_mov_b32 v89, 0
    v_mov_b32 v90, 0
    v_mov_b32 v91, 0
    v_mov_b32 v92, 0
    v_mov_b32 v93, 0
    v_mov_b32 v94, 0
    v_mov_b32 v95, 0
    v_mov_b32 v96, 0
    v_mov_b32 v97, 0
    v_mov_b32 v98, 0
    v_mov_b32 v99, 0
    v_mov_b32 v100, 0
    v_mov_b32 v101, 0
    v_mov_b32 v102, 0
    v_mov_b32 v103, 0
    s_waitcnt lgkmcnt(0)
    v_add_u32 v11, 1, v11
    ds_write_b32 v10, v11
    ds_read_b32 v15, v9
    s_lshl_b32 s34, s30, 3
    s_add_u32 s34, s34, s29
    s_lshl_b32 s34, s34, 2
    s_add_u32 s34, s34, s28
    s_lshl_b32 s34, s34, 3
    s_add_u32 s34, s34, 41975808
    s_waitcnt vmcnt(4)
    v_mov_b32 v12, s32
    v_mov_b32 v13, s33
    v_mov_b32 v14, 0
    s_mov_b64 exec, 1
    buffer_store_dwordx2 v[12:13], v14, s[24:27], s34 offen sc1
    s_mov_b64 exec, -1
    s_add_u32 s71, s71, 1
    s_waitcnt lgkmcnt(0)
    v_cmp_gt_u32 vcc, s71, v15
    s_cbranch_vccz L_mega_kernel_aok_39
    s_mov_b32 s31, 1048576
L_mega_kernel_aretry_40:
    ds_read_b32 v15, v9
    s_waitcnt lgkmcnt(0)
    v_cmp_gt_u32 vcc, s71, v15
    s_sub_u32 s31, s31, 1
    s_cbranch_scc1 L_mega_kernel_aok_39
    s_cbranch_vccnz L_mega_kernel_aretry_40
L_mega_kernel_aok_39:
    ds_read_b128 a[16:19], v3 offset:0
    ds_read_b128 a[20:23], v3 offset:1024
    s_waitcnt lgkmcnt(0)
    v_mfma_f32_32x32x16_bf16 v[16:31], a[16:19], a[0:3], 0
    ds_read_b128 a[32:35], v3 offset:2048
    ds_read_b128 a[36:39], v3 offset:3072
    v_mfma_f32_32x32x16_bf16 v[16:31], a[20:23], a[4:7], v[16:31]
    s_nop 15
    v_mfma_f32_32x32x16_bf16 v[32:47], a[16:19], a[8:11], 0
    ds_read_b128 a[24:27], v3 offset:4096
    v_exp_f32 v16, v16
    v_exp_f32 v17, v17
    v_exp_f32 v18, v18
    v_exp_f32 v19, v19
    ds_read_b128 a[28:31], v3 offset:5120
    v_exp_f32 v20, v20
    v_exp_f32 v21, v21
    v_exp_f32 v22, v22
    v_exp_f32 v23, v23
    v_mfma_f32_32x32x16_bf16 v[32:47], a[20:23], a[12:15], v[32:47]
    s_add_u32 s62, s62, 8192
    v_exp_f32 v24, v24
    v_exp_f32 v25, v25
    v_exp_f32 v26, v26
    v_exp_f32 v27, v27
    s_cmp_ge_u32 s62, 40960
    s_cselect_b32 s70, s68, s69
    s_cselect_b32 s62, 0, s62
    v_exp_f32 v28, v28
    v_cvt_pk_bf16_f32 v48, v16, v17
    v_exp_f32 v29, v29
    v_cvt_pk_bf16_f32 v49, v18, v19
    v_cvt_pk_bf16_f32 v50, v20, v21
    v_cvt_pk_bf16_f32 v51, v22, v23
    v_add_u32 v11, 1, v11
    ds_write_b32 v10, v11
    v_exp_f32 v30, v30
    v_exp_f32 v31, v31
    v_cvt_pk_bf16_f32 v52, v24, v25
    v_cvt_pk_bf16_f32 v53, v26, v27
    v_cvt_pk_bf16_f32 v54, v28, v29
    v_cvt_pk_bf16_f32 v55, v30, v31
    s_waitcnt lgkmcnt(1)
    v_mfma_f32_32x32x16_bf16 v[16:31], a[24:27], a[0:3], 0
    ds_read_b128 a[40:43], v3 offset:6144
    v_exp_f32 v32, v32
    v_exp_f32 v33, v33
    v_exp_f32 v34, v34
    v_exp_f32 v35, v35
    v_mfma_f32_32x32x16_bf16 v[64:79], a[32:35], v[48:51], v[64:79]
    ds_read_b128 a[44:47], v3 offset:7168
    v_exp_f32 v36, v36
    v_exp_f32 v37, v37
    v_exp_f32 v38, v38
    v_exp_f32 v39, v39
    v_mfma_f32_32x32x16_bf16 v[16:31], a[28:31], a[4:7], v[16:31]
    v_add_u32 v3, s70, v3
    v_exp_f32 v40, v40
    v_exp_f32 v41, v41
    v_exp_f32 v42, v42
    v_exp_f32 v43, v43
    s_nop 0
    v_mfma_f32_32x32x16_bf16 v[64:79], a[36:39], v[52:55], v[64:79]
    ds_read_b32 v15, v9
    v_exp_f32 v44, v44
    v_cvt_pk_bf16_f32 v56, v32, v33
    v_exp_f32 v45, v45
    v_cvt_pk_bf16_f32 v57, v34, v35
    v_cvt_pk_bf16_f32 v58, v36, v37
    v_cvt_pk_bf16_f32 v59, v38, v39
    v_smfmac_f32_16x16x64_bf16 v[96:99], v[104:107], v[48:55], v108
    v_exp_f32 v46, v46
    v_exp_f32 v47, v47
    v_cvt_pk_bf16_f32 v60, v40, v41
    v_cvt_pk_bf16_f32 v61, v42, v43
    v_cvt_pk_bf16_f32 v62, v44, v45
    v_cvt_pk_bf16_f32 v63, v46, v47
    s_add_u32 s71, s71, 1
    s_waitcnt lgkmcnt(0)
    v_cmp_gt_u32 vcc, s71, v15
    s_cbranch_vccz L_mega_kernel_aok_41
    s_mov_b32 s31, 1048576
L_mega_kernel_aretry_42:
    ds_read_b32 v15, v9
    s_waitcnt lgkmcnt(0)
    v_cmp_gt_u32 vcc, s71, v15
    s_sub_u32 s31, s31, 1
    s_cbranch_scc1 L_mega_kernel_aok_41
    s_cbranch_vccnz L_mega_kernel_aretry_42
L_mega_kernel_aok_41:
    v_mfma_f32_32x32x16_bf16 v[32:47], a[24:27], a[8:11], 0
    ds_read_b128 a[16:19], v3 offset:0
    v_exp_f32 v16, v16
    v_exp_f32 v17, v17
    v_exp_f32 v18, v18
    v_exp_f32 v19, v19
    v_mfma_f32_32x32x16_bf16 v[80:95], a[32:35], v[56:59], v[80:95]
    ds_read_b128 a[20:23], v3 offset:1024
    v_exp_f32 v20, v20
    v_exp_f32 v21, v21
    v_exp_f32 v22, v22
    v_exp_f32 v23, v23
    v_mfma_f32_32x32x16_bf16 v[32:47], a[28:31], a[12:15], v[32:47]
    v_exp_f32 v24, v24
    v_exp_f32 v25, v25
    v_exp_f32 v26, v26
    v_exp_f32 v27, v27
    v_mfma_f32_32x32x16_bf16 v[80:95], a[36:39], v[60:63], v[80:95]
    v_exp_f32 v28, v28
    v_cvt_pk_bf16_f32 v48, v16, v17
    v_exp_f32 v29, v29
    v_cvt_pk_bf16_f32 v49, v18, v19
    v_cvt_pk_bf16_f32 v50, v20, v21
    v_cvt_pk_bf16_f32 v51, v22, v23
    v_smfmac_f32_16x16x64_bf16 v[100:103], v[104:107], v[56:63], v108
    v_exp_f32 v30, v30
    v_exp_f32 v31, v31
    v_cvt_pk_bf16_f32 v52, v24, v25
    v_cvt_pk_bf16_f32 v53, v26, v27
    v_cvt_pk_bf16_f32 v54, v28, v29
    v_cvt_pk_bf16_f32 v55, v30, v31
    s_waitcnt lgkmcnt(0)
    v_mfma_f32_32x32x16_bf16 v[16:31], a[16:19], a[0:3], 0
    ds_read_b128 a[32:35], v3 offset:2048
    v_exp_f32 v32, v32
    v_exp_f32 v33, v33
    v_exp_f32 v34, v34
    v_exp_f32 v35, v35
    v_mfma_f32_32x32x16_bf16 v[64:79], a[40:43], v[48:51], v[64:79]
    ds_read_b128 a[36:39], v3 offset:3072
    v_exp_f32 v36, v36
    v_exp_f32 v37, v37
    v_exp_f32 v38, v38
    v_exp_f32 v39, v39
    v_mfma_f32_32x32x16_bf16 v[16:31], a[20:23], a[4:7], v[16:31]
    v_exp_f32 v40, v40
    v_exp_f32 v41, v41
    v_exp_f32 v42, v42
    v_exp_f32 v43, v43
    v_mfma_f32_32x32x16_bf16 v[64:79], a[44:47], v[52:55], v[64:79]
    v_exp_f32 v44, v44
    v_cvt_pk_bf16_f32 v56, v32, v33
    v_exp_f32 v45, v45
    v_cvt_pk_bf16_f32 v57, v34, v35
    v_cvt_pk_bf16_f32 v58, v36, v37
    v_cvt_pk_bf16_f32 v59, v38, v39
    v_smfmac_f32_16x16x64_bf16 v[96:99], v[104:107], v[48:55], v108
    v_exp_f32 v46, v46
    v_exp_f32 v47, v47
    v_cvt_pk_bf16_f32 v60, v40, v41
    v_cvt_pk_bf16_f32 v61, v42, v43
    v_cvt_pk_bf16_f32 v62, v44, v45
    v_cvt_pk_bf16_f32 v63, v46, v47
    v_mfma_f32_32x32x16_bf16 v[32:47], a[16:19], a[8:11], 0
    ds_read_b128 a[24:27], v3 offset:4096
    v_exp_f32 v16, v16
    v_exp_f32 v17, v17
    v_exp_f32 v18, v18
    v_exp_f32 v19, v19
    v_mfma_f32_32x32x16_bf16 v[80:95], a[40:43], v[56:59], v[80:95]
    ds_read_b128 a[28:31], v3 offset:5120
    v_exp_f32 v20, v20
    v_exp_f32 v21, v21
    v_exp_f32 v22, v22
    v_exp_f32 v23, v23
    v_mfma_f32_32x32x16_bf16 v[32:47], a[20:23], a[12:15], v[32:47]
    s_add_u32 s62, s62, 8192
    v_exp_f32 v24, v24
    v_exp_f32 v25, v25
    v_exp_f32 v26, v26
    v_exp_f32 v27, v27
    s_cmp_ge_u32 s62, 40960
    s_cselect_b32 s70, s68, s69
    s_cselect_b32 s62, 0, s62
    v_mfma_f32_32x32x16_bf16 v[80:95], a[44:47], v[60:63], v[80:95]
    v_exp_f32 v28, v28
    v_cvt_pk_bf16_f32 v48, v16, v17
    v_exp_f32 v29, v29
    v_cvt_pk_bf16_f32 v49, v18, v19
    v_cvt_pk_bf16_f32 v50, v20, v21
    v_cvt_pk_bf16_f32 v51, v22, v23
    v_add_u32 v11, 1, v11
    v_smfmac_f32_16x16x64_bf16 v[100:103], v[104:107], v[56:63], v108
    ds_write_b32 v10, v11
    v_exp_f32 v30, v30
    v_exp_f32 v31, v31
    v_cvt_pk_bf16_f32 v52, v24, v25
    v_cvt_pk_bf16_f32 v53, v26, v27
    v_cvt_pk_bf16_f32 v54, v28, v29
    v_cvt_pk_bf16_f32 v55, v30, v31
    s_waitcnt lgkmcnt(1)
    v_mfma_f32_32x32x16_bf16 v[16:31], a[24:27], a[0:3], 0
    ds_read_b128 a[40:43], v3 offset:6144
    v_exp_f32 v32, v32
    v_exp_f32 v33, v33
    v_exp_f32 v34, v34
    v_exp_f32 v35, v35
    v_mfma_f32_32x32x16_bf16 v[64:79], a[32:35], v[48:51], v[64:79]
    ds_read_b128 a[44:47], v3 offset:7168
    v_exp_f32 v36, v36
    v_exp_f32 v37, v37
    v_exp_f32 v38, v38
    v_exp_f32 v39, v39
    v_mfma_f32_32x32x16_bf16 v[16:31], a[28:31], a[4:7], v[16:31]
    v_add_u32 v3, s70, v3
    v_exp_f32 v40, v40
    v_exp_f32 v41, v41
    v_exp_f32 v42, v42
    v_exp_f32 v43, v43
    s_nop 0
    v_mfma_f32_32x32x16_bf16 v[64:79], a[36:39], v[52:55], v[64:79]
    ds_read_b32 v15, v9
    v_exp_f32 v44, v44
    v_cvt_pk_bf16_f32 v56, v32, v33
    v_exp_f32 v45, v45
    v_cvt_pk_bf16_f32 v57, v34, v35
    v_cvt_pk_bf16_f32 v58, v36, v37
    v_cvt_pk_bf16_f32 v59, v38, v39
    v_smfmac_f32_16x16x64_bf16 v[96:99], v[104:107], v[48:55], v108
    v_exp_f32 v46, v46
    v_exp_f32 v47, v47
    v_cvt_pk_bf16_f32 v60, v40, v41
    v_cvt_pk_bf16_f32 v61, v42, v43
    v_cvt_pk_bf16_f32 v62, v44, v45
    v_cvt_pk_bf16_f32 v63, v46, v47
    s_lshl_b32 s34, s30, 8
    s_add_u32 s34, s34, 41975808
    s_mov_b32 s31, 131072
L_mega_kernel_poll_43:
    buffer_load_dwordx2 v[12:13], v6, s[24:27], s34 offen sc1
    s_waitcnt vmcnt(0)
    v_cmp_ne_u64 vcc, s[32:33], v[12:13]
    s_sub_u32 s31, s31, 1
    s_cbranch_scc1 L_mega_kernel_polld_44
    s_cbranch_vccnz L_mega_kernel_poll_43
L_mega_kernel_polld_44:
    s_mov_b32 m0, s61
    s_nop 0
    buffer_load_dwordx4 v5, s[48:51], s60 offen sc1 lds
    buffer_load_dwordx4 v5, s[48:51], s60 offen offset:1024 sc1 lds
    s_add_u32 s60, s60, 8192
    s_and_b32 s60, s60, 262143
    s_add_u32 s61, s61, 8192
    s_cmp_ge_u32 s61, s67
    s_cselect_b32 s61, s66, s61
    v_mov_b32 v12, 156676
    v_mov_b32 v13, 1
    s_mov_b64 exec, 1
    ds_add_rtn_u32 v14, v12, v13
    s_mov_b64 exec, -1
    s_lshl_b32 s34, s29, 5
    s_add_u32 s34, s34, s30
    s_lshl_b32 s34, s34, 3
    s_add_u32 s34, s34, 41951232
    s_waitcnt lgkmcnt(0)
    v_readfirstlane_b32 s35, v14
    s_cmp_lg_u32 s35, 7
    s_cbranch_scc1 L_mega_kernel_na_46
    v_mov_b32 v12, s32
    v_mov_b32 v13, s33
    v_mov_b32 v14, 0
    s_mov_b64 exec, 1
    buffer_store_dwordx2 v[12:13], v14, s[24:27], s34 offen sc1
    s_mov_b64 exec, -1
L_mega_kernel_na_46:
    ds_read_b32 v15, v9
    s_add_u32 s71, s71, 1
    s_waitcnt lgkmcnt(0)
    v_cmp_gt_u32 vcc, s71, v15
    s_cbranch_vccz L_mega_kernel_aok_47
    s_mov_b32 s31, 1048576
L_mega_kernel_aretry_48:
    ds_read_b32 v15, v9
    s_waitcnt lgkmcnt(0)
    v_cmp_gt_u32 vcc, s71, v15
    s_sub_u32 s31, s31, 1
    s_cbranch_scc1 L_mega_kernel_aok_47
    s_cbranch_vccnz L_mega_kernel_aretry_48
L_mega_kernel_aok_47:
    v_mfma_f32_32x32x16_bf16 v[32:47], a[24:27], a[8:11], 0
    ds_read_b128 a[16:19], v3 offset:0
    v_exp_f32 v16, v16
    v_exp_f32 v17, v17
    v_exp_f32 v18, v18
    v_exp_f32 v19, v19
    v_mfma_f32_32x32x16_bf16 v[80:95], a[32:35], v[56:59], v[80:95]
    ds_read_b128 a[20:23], v3 offset:1024
    v_exp_f32 v20, v20
    v_exp_f32 v21, v21
    v_exp_f32 v22, v22
    v_exp_f32 v23, v23
    v_mfma_f32_32x32x16_bf16 v[32:47], a[28:31], a[12:15], v[32:47]
    s_mov_b32 m0, s61
    v_exp_f32 v24, v24
    v_exp_f32 v25, v25
    v_exp_f32 v26, v26
    v_exp_f32 v27, v27
    buffer_load_dwordx4 v5, s[48:51], s60 offen sc1 lds
    v_mfma_f32_32x32x16_bf16 v[80:95], a[36:39], v[60:63], v[80:95]
    buffer_load_dwordx4 v5, s[48:51], s60 offen offset:1024 sc1 lds
    v_exp_f32 v28, v28
    v_cvt_pk_bf16_f32 v48, v16, v17
    v_exp_f32 v29, v29
    v_cvt_pk_bf16_f32 v49, v18, v19
    v_cvt_pk_bf16_f32 v50, v20, v21
    v_cvt_pk_bf16_f32 v51, v22, v23
    s_add_u32 s60, s60, 8192
    s_and_b32 s60, s60, 262143
    v_smfmac_f32_16x16x64_bf16 v[100:103], v[104:107], v[56:63], v108
    s_add_u32 s61, s61, 8192
    v_exp_f32 v30, v30
    v_exp_f32 v31, v31
    v_cvt_pk_bf16_f32 v52, v24, v25
    v_cvt_pk_bf16_f32 v53, v26, v27
    v_cvt_pk_bf16_f32 v54, v28, v29
    v_cvt_pk_bf16_f32 v55, v30, v31
    s_cmp_ge_u32 s61, s67
    s_cselect_b32 s61, s66, s61
    s_waitcnt lgkmcnt(0)
    v_mfma_f32_32x32x16_bf16 v[16:31], a[16:19], a[0:3], 0
    ds_read_b128 a[32:35], v3 offset:2048
    v_exp_f32 v32, v32
    v_exp_f32 v33, v33
    v_exp_f32 v34, v34
    v_exp_f32 v35, v35
    v_mfma_f32_32x32x16_bf16 v[64:79], a[40:43], v[48:51], v[64:79]
    ds_read_b128 a[36:39], v3 offset:3072
    v_exp_f32 v36, v36
    v_exp_f32 v37, v37
    v_exp_f32 v38, v38
    v_exp_f32 v39, v39
    v_mfma_f32_32x32x16_bf16 v[16:31], a[20:23], a[4:7], v[16:31]
    v_exp_f32 v40, v40
    v_exp_f32 v41, v41
    v_exp_f32 v42, v42
    v_exp_f32 v43, v43
    v_mfma_f32_32x32x16_bf16 v[64:79], a[44:47], v[52:55], v[64:79]
    v_exp_f32 v44, v44
    v_cvt_pk_bf16_f32 v56, v32, v33
    v_exp_f32 v45, v45
    v_cvt_pk_bf16_f32 v57, v34, v35
    v_cvt_pk_bf16_f32 v58, v36, v37
    v_cvt_pk_bf16_f32 v59, v38, v39
    v_smfmac_f32_16x16x64_bf16 v[96:99], v[104:107], v[48:55], v108
    v_exp_f32 v46, v46
    v_exp_f32 v47, v47
    v_cvt_pk_bf16_f32 v60, v40, v41
    v_cvt_pk_bf16_f32 v61, v42, v43
    v_cvt_pk_bf16_f32 v62, v44, v45
    v_cvt_pk_bf16_f32 v63, v46, v47
    v_mfma_f32_32x32x16_bf16 v[32:47], a[16:19], a[8:11], 0
    ds_read_b128 a[24:27], v3 offset:4096
    v_exp_f32 v16, v16
    v_exp_f32 v17, v17
    v_exp_f32 v18, v18
    v_exp_f32 v19, v19
    v_mfma_f32_32x32x16_bf16 v[80:95], a[40:43], v[56:59], v[80:95]
    ds_read_b128 a[28:31], v3 offset:5120
    v_exp_f32 v20, v20
    v_exp_f32 v21, v21
    v_exp_f32 v22, v22
    v_exp_f32 v23, v23
    v_mfma_f32_32x32x16_bf16 v[32:47], a[20:23], a[12:15], v[32:47]
    s_add_u32 s62, s62, 8192
    v_exp_f32 v24, v24
    v_exp_f32 v25, v25
    v_exp_f32 v26, v26
    v_exp_f32 v27, v27
    s_cmp_ge_u32 s62, 40960
    s_cselect_b32 s70, s68, s69
    s_cselect_b32 s62, 0, s62
    v_mfma_f32_32x32x16_bf16 v[80:95], a[44:47], v[60:63], v[80:95]
    s_waitcnt vmcnt(4)
    v_exp_f32 v28, v28
    v_cvt_pk_bf16_f32 v48, v16, v17
    v_exp_f32 v29, v29
    v_cvt_pk_bf16_f32 v49, v18, v19
    v_cvt_pk_bf16_f32 v50, v20, v21
    v_cvt_pk_bf16_f32 v51, v22, v23
    v_add_u32 v11, 1, v11
    v_smfmac_f32_16x16x64_bf16 v[100:103], v[104:107], v[56:63], v108
    ds_write_b32 v10, v11
    v_exp_f32 v30, v30
    v_exp_f32 v31, v31
    v_cvt_pk_bf16_f32 v52, v24, v25
    v_cvt_pk_bf16_f32 v53, v26, v27
    v_cvt_pk_bf16_f32 v54, v28, v29
    v_cvt_pk_bf16_f32 v55, v30, v31
    s_waitcnt lgkmcnt(1)
    v_mfma_f32_32x32x16_bf16 v[16:31], a[24:27], a[0:3], 0
    ds_read_b128 a[40:43], v3 offset:6144
    v_exp_f32 v32, v32
    v_exp_f32 v33, v33
    v_exp_f32 v34, v34
    v_exp_f32 v35, v35
    v_mfma_f32_32x32x16_bf16 v[64:79], a[32:35], v[48:51], v[64:79]
    ds_read_b128 a[44:47], v3 offset:7168
    v_exp_f32 v36, v36
    v_exp_f32 v37, v37
    v_exp_f32 v38, v38
    v_exp_f32 v39, v39
    v_mfma_f32_32x32x16_bf16 v[16:31], a[28:31], a[4:7], v[16:31]
    v_add_u32 v3, s70, v3
    v_exp_f32 v40, v40
    v_exp_f32 v41, v41
    v_exp_f32 v42, v42
    v_exp_f32 v43, v43
    s_nop 0
    v_mfma_f32_32x32x16_bf16 v[64:79], a[36:39], v[52:55], v[64:79]
    ds_read_b32 v15, v9
    v_exp_f32 v44, v44
    v_cvt_pk_bf16_f32 v56, v32, v33
    v_exp_f32 v45, v45
    v_cvt_pk_bf16_f32 v57, v34, v35
    v_cvt_pk_bf16_f32 v58, v36, v37
    v_cvt_pk_bf16_f32 v59, v38, v39
    v_smfmac_f32_16x16x64_bf16 v[96:99], v[104:107], v[48:55], v108
    v_exp_f32 v46, v46
    v_exp_f32 v47, v47
    v_cvt_pk_bf16_f32 v60, v40, v41
    v_cvt_pk_bf16_f32 v61, v42, v43
    v_cvt_pk_bf16_f32 v62, v44, v45
    v_cvt_pk_bf16_f32 v63, v46, v47
    s_mov_b32 s63, 29
L_at_loop:
    s_add_u32 s71, s71, 1
    s_waitcnt lgkmcnt(0)
    v_cmp_gt_u32 vcc, s71, v15
    s_cbranch_vccz L_mega_kernel_aok_49
    s_mov_b32 s31, 1048576
L_mega_kernel_aretry_50:
    ds_read_b32 v15, v9
    s_waitcnt lgkmcnt(0)
    v_cmp_gt_u32 vcc, s71, v15
    s_sub_u32 s31, s31, 1
    s_cbranch_scc1 L_mega_kernel_aok_49
    s_cbranch_vccnz L_mega_kernel_aretry_50
L_mega_kernel_aok_49:
    v_mfma_f32_32x32x16_bf16 v[32:47], a[24:27], a[8:11], 0
    ds_read_b128 a[16:19], v3 offset:0
    v_exp_f32 v16, v16
    v_exp_f32 v17, v17
    v_exp_f32 v18, v18
    v_exp_f32 v19, v19
    v_mfma_f32_32x32x16_bf16 v[80:95], a[32:35], v[56:59], v[80:95]
    ds_read_b128 a[20:23], v3 offset:1024
    v_exp_f32 v20, v20
    v_exp_f32 v21, v21
    v_exp_f32 v22, v22
    v_exp_f32 v23, v23
    v_mfma_f32_32x32x16_bf16 v[32:47], a[28:31], a[12:15], v[32:47]
    s_mov_b32 m0, s61
    v_exp_f32 v24, v24
    v_exp_f32 v25, v25
    v_exp_f32 v26, v26
    v_exp_f32 v27, v27
    buffer_load_dwordx4 v5, s[48:51], s60 offen sc1 lds
    v_mfma_f32_32x32x16_bf16 v[80:95], a[36:39], v[60:63], v[80:95]
    buffer_load_dwordx4 v5, s[48:51], s60 offen offset:1024 sc1 lds
    v_exp_f32 v28, v28
    v_cvt_pk_bf16_f32 v48, v16, v17
    v_exp_f32 v29, v29
    v_cvt_pk_bf16_f32 v49, v18, v19
    v_cvt_pk_bf16_f32 v50, v20, v21
    v_cvt_pk_bf16_f32 v51, v22, v23
    s_add_u32 s60, s60, 8192
    s_and_b32 s60, s60, 262143
    v_smfmac_f32_16x16x64_bf16 v[100:103], v[104:107], v[56:63], v108
    s_add_u32 s61, s61, 8192
    v_exp_f32 v30, v30
    v_exp_f32 v31, v31
    v_cvt_pk_bf16_f32 v52, v24, v25
    v_cvt_pk_bf16_f32 v53, v26, v27
    v_cvt_pk_bf16_f32 v54, v28, v29
    v_cvt_pk_bf16_f32 v55, v30, v31
    s_cmp_ge_u32 s61, s67
    s_cselect_b32 s61, s66, s61
    s_waitcnt lgkmcnt(0)
    v_mfma_f32_32x32x16_bf16 v[16:31], a[16:19], a[0:3], 0
    ds_read_b128 a[32:35], v3 offset:2048
    v_exp_f32 v32, v32
    v_exp_f32 v33, v33
    v_exp_f32 v34, v34
    v_exp_f32 v35, v35
    v_mfma_f32_32x32x16_bf16 v[64:79], a[40:43], v[48:51], v[64:79]
    ds_read_b128 a[36:39], v3 offset:3072
    v_exp_f32 v36, v36
    v_exp_f32 v37, v37
    v_exp_f32 v38, v38
    v_exp_f32 v39, v39
    v_mfma_f32_32x32x16_bf16 v[16:31], a[20:23], a[4:7], v[16:31]
    v_exp_f32 v40, v40
    v_exp_f32 v41, v41
    v_exp_f32 v42, v42
    v_exp_f32 v43, v43
    v_mfma_f32_32x32x16_bf16 v[64:79], a[44:47], v[52:55], v[64:79]
    v_exp_f32 v44, v44
    v_cvt_pk_bf16_f32 v56, v32, v33
    v_exp_f32 v45, v45
    v_cvt_pk_bf16_f32 v57, v34, v35
    v_cvt_pk_bf16_f32 v58, v36, v37
    v_cvt_pk_bf16_f32 v59, v38, v39
    v_smfmac_f32_16x16x64_bf16 v[96:99], v[104:107], v[48:55], v108
    v_exp_f32 v46, v46
    v_exp_f32 v47, v47
    v_cvt_pk_bf16_f32 v60, v40, v41
    v_cvt_pk_bf16_f32 v61, v42, v43
    v_cvt_pk_bf16_f32 v62, v44, v45
    v_cvt_pk_bf16_f32 v63, v46, v47
    v_mfma_f32_32x32x16_bf16 v[32:47], a[16:19], a[8:11], 0
    ds_read_b128 a[24:27], v3 offset:4096
    v_exp_f32 v16, v16
    v_exp_f32 v17, v17
    v_exp_f32 v18, v18
    v_exp_f32 v19, v19
    v_mfma_f32_32x32x16_bf16 v[80:95], a[40:43], v[56:59], v[80:95]
    ds_read_b128 a[28:31], v3 offset:5120
    v_exp_f32 v20, v20
    v_exp_f32 v21, v21
    v_exp_f32 v22, v22
    v_exp_f32 v23, v23
    v_mfma_f32_32x32x16_bf16 v[32:47], a[20:23], a[12:15], v[32:47]
    s_add_u32 s62, s62, 8192
    v_exp_f32 v24, v24
    v_exp_f32 v25, v25
    v_exp_f32 v26, v26
    v_exp_f32 v27, v27
    s_cmp_ge_u32 s62, 40960
    s_cselect_b32 s70, s68, s69
    s_cselect_b32 s62, 0, s62
    v_mfma_f32_32x32x16_bf16 v[80:95], a[44:47], v[60:63], v[80:95]
    s_waitcnt vmcnt(4)
    v_exp_f32 v28, v28
    v_cvt_pk_bf16_f32 v48, v16, v17
    v_exp_f32 v29, v29
    v_cvt_pk_bf16_f32 v49, v18, v19
    v_cvt_pk_bf16_f32 v50, v20, v21
    v_cvt_pk_bf16_f32 v51, v22, v23
    v_add_u32 v11, 1, v11
    v_smfmac_f32_16x16x64_bf16 v[100:103], v[104:107], v[56:63], v108
    ds_write_b32 v10, v11
    v_exp_f32 v30, v30
    v_exp_f32 v31, v31
    v_cvt_pk_bf16_f32 v52, v24, v25
    v_cvt_pk_bf16_f32 v53, v26, v27
    v_cvt_pk_bf16_f32 v54, v28, v29
    v_cvt_pk_bf16_f32 v55, v30, v31
    s_waitcnt lgkmcnt(1)
    v_mfma_f32_32x32x16_bf16 v[16:31], a[24:27], a[0:3], 0
    ds_read_b128 a[40:43], v3 offset:6144
    v_exp_f32 v32, v32
    v_exp_f32 v33, v33
    v_exp_f32 v34, v34
    v_exp_f32 v35, v35
    v_mfma_f32_32x32x16_bf16 v[64:79], a[32:35], v[48:51], v[64:79]
    ds_read_b128 a[44:47], v3 offset:7168
    v_exp_f32 v36, v36
    v_exp_f32 v37, v37
    v_exp_f32 v38, v38
    v_exp_f32 v39, v39
    v_mfma_f32_32x32x16_bf16 v[16:31], a[28:31], a[4:7], v[16:31]
    v_add_u32 v3, s70, v3
    v_exp_f32 v40, v40
    v_exp_f32 v41, v41
    v_exp_f32 v42, v42
    v_exp_f32 v43, v43
    s_nop 0
    v_mfma_f32_32x32x16_bf16 v[64:79], a[36:39], v[52:55], v[64:79]
    ds_read_b32 v15, v9
    v_exp_f32 v44, v44
    v_cvt_pk_bf16_f32 v56, v32, v33
    v_exp_f32 v45, v45
    v_cvt_pk_bf16_f32 v57, v34, v35
    v_cvt_pk_bf16_f32 v58, v36, v37
    v_cvt_pk_bf16_f32 v59, v38, v39
    v_smfmac_f32_16x16x64_bf16 v[96:99], v[104:107], v[48:55], v108
    v_exp_f32 v46, v46
    v_exp_f32 v47, v47
    v_cvt_pk_bf16_f32 v60, v40, v41
    v_cvt_pk_bf16_f32 v61, v42, v43
    v_cvt_pk_bf16_f32 v62, v44, v45
    v_cvt_pk_bf16_f32 v63, v46, v47
    s_sub_u32 s63, s63, 1
    s_cmp_lg_u32 s63, 0
    s_cbranch_scc1 L_at_loop
    v_mfma_f32_32x32x16_bf16 v[32:47], a[24:27], a[8:11], 0
    v_exp_f32 v16, v16
    v_exp_f32 v17, v17
    v_exp_f32 v18, v18
    v_exp_f32 v19, v19
    v_mfma_f32_32x32x16_bf16 v[80:95], a[32:35], v[56:59], v[80:95]
    v_exp_f32 v20, v20
    v_exp_f32 v21, v21
    v_exp_f32 v22, v22
    v_exp_f32 v23, v23
    v_mfma_f32_32x32x16_bf16 v[32:47], a[28:31], a[12:15], v[32:47]
    v_exp_f32 v24, v24
    v_exp_f32 v25, v25
    v_exp_f32 v26, v26
    v_exp_f32 v27, v27
    v_mfma_f32_32x32x16_bf16 v[80:95], a[36:39], v[60:63], v[80:95]
    v_exp_f32 v28, v28
    v_cvt_pk_bf16_f32 v48, v16, v17
    v_exp_f32 v29, v29
    v_cvt_pk_bf16_f32 v49, v18, v19
    v_cvt_pk_bf16_f32 v50, v20, v21
    v_cvt_pk_bf16_f32 v51, v22, v23
    v_smfmac_f32_16x16x64_bf16 v[100:103], v[104:107], v[56:63], v108
    v_exp_f32 v30, v30
    v_exp_f32 v31, v31
    v_cvt_pk_bf16_f32 v52, v24, v25
    v_cvt_pk_bf16_f32 v53, v26, v27
    v_cvt_pk_bf16_f32 v54, v28, v29
    v_cvt_pk_bf16_f32 v55, v30, v31
    v_exp_f32 v32, v32
    v_exp_f32 v33, v33
    v_exp_f32 v34, v34
    v_exp_f32 v35, v35
    s_waitcnt lgkmcnt(1)
    v_mfma_f32_32x32x16_bf16 v[64:79], a[40:43], v[48:51], v[64:79]
    v_exp_f32 v36, v36
    v_exp_f32 v37, v37
    v_exp_f32 v38, v38
    v_exp_f32 v39, v39
    v_exp_f32 v40, v40
    v_exp_f32 v41, v41
    v_exp_f32 v42, v42
    v_exp_f32 v43, v43
    v_mfma_f32_32x32x16_bf16 v[64:79], a[44:47], v[52:55], v[64:79]
    v_exp_f32 v44, v44
    v_cvt_pk_bf16_f32 v56, v32, v33
    v_exp_f32 v45, v45
    v_cvt_pk_bf16_f32 v57, v34, v35
    v_cvt_pk_bf16_f32 v58, v36, v37
    v_cvt_pk_bf16_f32 v59, v38, v39
    v_smfmac_f32_16x16x64_bf16 v[96:99], v[104:107], v[48:55], v108
    v_exp_f32 v46, v46
    v_exp_f32 v47, v47
    v_cvt_pk_bf16_f32 v60, v40, v41
    v_cvt_pk_bf16_f32 v61, v42, v43
    v_cvt_pk_bf16_f32 v62, v44, v45
    v_cvt_pk_bf16_f32 v63, v46, v47
    s_nop 1
    v_mfma_f32_32x32x16_bf16 v[80:95], a[40:43], v[56:59], v[80:95]
    v_mfma_f32_32x32x16_bf16 v[80:95], a[44:47], v[60:63], v[80:95]
    v_smfmac_f32_16x16x64_bf16 v[100:103], v[104:107], v[56:63], v108
    s_nop 15
    v_and_b32 v7, 16, v1
    v_cmp_eq_u32 s[52:53], 0, v7
    s_mov_b32 s54, 0x2b800000
    s_mov_b32 s55, 0x67800000
    s_mov_b32 s56, 0x21800000
    s_mov_b32 s57, 0x7f000000
    s_mov_b64 s[58:59], 0
    v_add_f32 v96, v96, v98
    v_add_f32 v97, v97, v99
    v_cndmask_b32 v110, v97, v96, s[52:53]
    v_max_f32 v7, |v64|, |v65|
    v_add_f32 v8, v64, v65
    v_max3_f32 v7, |v66|, |v67|, v7
    v_add_f32 v8, v8, v66
    v_add_f32 v8, v8, v67
    v_max3_f32 v7, |v68|, |v69|, v7
    v_add_f32 v8, v8, v68
    v_add_f32 v8, v8, v69
    v_max3_f32 v7, |v70|, |v71|, v7
    v_add_f32 v8, v8, v70
    v_add_f32 v8, v8, v71
    v_max3_f32 v7, |v72|, |v73|, v7
    v_add_f32 v8, v8, v72
    v_add_f32 v8, v8, v73
    v_max3_f32 v7, |v74|, |v75|, v7
    v_add_f32 v8, v8, v74
    v_add_f32 v8, v8, v75
    v_max3_f32 v7, |v76|, |v77|, v7
    v_add_f32 v8, v8, v76
    v_add_f32 v8, v8, v77
    v_max3_f32 v7, |v78|, |v79|, v7
    v_add_f32 v8, v8, v78
    v_add_f32 v8, v8, v79
    v_mul_f32 v9, s56, v110
    v_cmp_nle_f32 vcc, s54, v110
    s_or_b64 s[58:59], s[58:59], vcc
    v_cmp_nge_f32 vcc, s55, v110
    s_or_b64 s[58:59], s[58:59], vcc
    v_cmp_ngt_f32 vcc, s57, v7
    s_or_b64 s[58:59], s[58:59], vcc
    v_cmp_nge_f32 vcc, v7, v9
    s_or_b64 s[58:59], s[58:59], vcc
    v_cmp_u_f32 vcc, v8, v8
    s_or_b64 s[58:59], s[58:59], vcc
    v_add_f32 v100, v100, v102
    v_add_f32 v101, v101, v103
    v_cndmask_b32 v111, v101, v100, s[52:53]
    v_max_f32 v7, |v80|, |v81|
    v_add_f32 v8, v80, v81
    v_max3_f32 v7, |v82|, |v83|, v7
    v_add_f32 v8, v8, v82
    v_add_f32 v8, v8, v83
    v_max3_f32 v7, |v84|, |v85|, v7
    v_add_f32 v8, v8, v84
    v_add_f32 v8, v8, v85
    v_max3_f32 v7, |v86|, |v87|, v7
    v_add_f32 v8, v8, v86
    v_add_f32 v8, v8, v87
    v_max3_f32 v7, |v88|, |v89|, v7
    v_add_f32 v8, v8, v88
    v_add_f32 v8, v8, v89
    v_max3_f32 v7, |v90|, |v91|, v7
    v_add_f32 v8, v8, v90
    v_add_f32 v8, v8, v91
    v_max3_f32 v7, |v92|, |v93|, v7
    v_add_f32 v8, v8, v92
    v_add_f32 v8, v8, v93
    v_max3_f32 v7, |v94|, |v95|, v7
    v_add_f32 v8, v8, v94
    v_add_f32 v8, v8, v95
    v_mul_f32 v9, s56, v111
    v_cmp_nle_f32 vcc, s54, v111
    s_or_b64 s[58:59], s[58:59], vcc
    v_cmp_nge_f32 vcc, s55, v111
    s_or_b64 s[58:59], s[58:59], vcc
    v_cmp_ngt_f32 vcc, s57, v7
    s_or_b64 s[58:59], s[58:59], vcc
    v_cmp_nge_f32 vcc, v7, v9
    s_or_b64 s[58:59], s[58:59], vcc
    v_cmp_u_f32 vcc, v8, v8
    s_or_b64 s[58:59], s[58:59], vcc
    s_cmp_lg_u64 s[58:59], 0
    s_cbranch_scc1 L_at_slow
L_at_fin:
    v_rcp_f32 v7, v110
    s_nop 0
    v_mul_f32 v64, v64, v7
    v_mul_f32 v65, v65, v7
    v_mul_f32 v66, v66, v7
    v_mul_f32 v67, v67, v7
    v_mul_f32 v68, v68, v7
    v_mul_f32 v69, v69, v7
    v_mul_f32 v70, v70, v7
    v_mul_f32 v71, v71, v7
    v_mul_f32 v72, v72, v7
    v_mul_f32 v73, v73, v7
    v_mul_f32 v74, v74, v7
    v_mul_f32 v75, v75, v7
    v_mul_f32 v76, v76, v7
    v_mul_f32 v77, v77, v7
    v_mul_f32 v78, v78, v7
    v_mul_f32 v79, v79, v7
    v_cvt_pk_bf16_f32 v112, v64, v65
    v_cvt_pk_bf16_f32 v113, v66, v67
    v_cvt_pk_bf16_f32 v114, v68, v69
    v_cvt_pk_bf16_f32 v115, v70, v71
    v_cvt_pk_bf16_f32 v116, v72, v73
    v_cvt_pk_bf16_f32 v117, v74, v75
    v_cvt_pk_bf16_f32 v118, v76, v77
    v_cvt_pk_bf16_f32 v119, v78, v79
    buffer_store_dwordx4 v[112:115], v4, s[24:27], s64 offen offset:0 sc1
    buffer_store_dwordx4 v[116:119], v4, s[24:27], s64 offen offset:1024 sc1
    v_rcp_f32 v7, v111
    s_nop 0
    v_mul_f32 v80, v80, v7
    v_mul_f32 v81, v81, v7
    v_mul_f32 v82, v82, v7
    v_mul_f32 v83, v83, v7
    v_mul_f32 v84, v84, v7
    v_mul_f32 v85, v85, v7
    v_mul_f32 v86, v86, v7
    v_mul_f32 v87, v87, v7
    v_mul_f32 v88, v88, v7
    v_mul_f32 v89, v89, v7
    v_mul_f32 v90, v90, v7
    v_mul_f32 v91, v91, v7
    v_mul_f32 v92, v92, v7
    v_mul_f32 v93, v93, v7
    v_mul_f32 v94, v94, v7
    v_mul_f32 v95, v95, v7
    v_cvt_pk_bf16_f32 v120, v80, v81
    v_cvt_pk_bf16_f32 v121, v82, v83
    v_cvt_pk_bf16_f32 v122, v84, v85
    v_cvt_pk_bf16_f32 v123, v86, v87
    v_cvt_pk_bf16_f32 v124, v88, v89
    v_cvt_pk_bf16_f32 v125, v90, v91
    v_cvt_pk_bf16_f32 v126, v92, v93
    v_cvt_pk_bf16_f32 v127, v94, v95
    buffer_store_dwordx4 v[120:123], v4, s[24:27], s65 offen offset:0 sc1
    buffer_store_dwordx4 v[124:127], v4, s[24:27], s65 offen offset:1024 sc1
    s_lshl_b32 s34, s29, 1
    s_lshr_b32 s35, s28, 1
    s_add_u32 s34, s34, s35
    s_lshl_b32 s34, s34, 5
    s_add_u32 s34, s34, s30
    s_lshl_b32 s34, s34, 1
    s_and_b32 s35, s28, 1
    s_add_u32 s34, s34, s35
    s_lshl_b32 s34, s34, 3
    s_add_u32 s34, s34, 42008576
    s_waitcnt vmcnt(0)
    v_mov_b32 v12, s32
    v_mov_b32 v13, s33
    v_mov_b32 v14, 0
    s_mov_b64 exec, 1
    buffer_store_dwordx2 v[12:13], v14, s[24:27], s34 offen sc1
    s_mov_b64 exec, -1
    v_and_b32 v8, 3, v1
    v_lshlrev_b32 v8, 2, v8
    v_add_u32 v9, 156704, v8
    s_lshl_b32 s35, s28, 2
    s_add_u32 s35, s35, 156704
    v_mov_b32 v10, s35
    v_mov_b32 v11, 34
    ds_write_b32 v10, v11
    s_and_b32 s34, s2, 7
    s_lshr_b32 s35, s2, 3
    s_lshr_b32 s60, s34, 1
    s_lshl_b32 s60, s60, 2
    s_and_b32 s36, s35, 3
    s_add_u32 s60, s60, s36
    s_and_b32 s61, s34, 1
    s_lshl_b32 s61, s61, 3
    s_lshr_b32 s36, s35, 2
    s_add_u32 s61, s61, s36
    s_lshl_b32 s34, s61, 7
    s_add_u32 s48, s8, s34
    s_addc_u32 s49, s9, 0
    s_and_b32 s49, s49, 0xffff
    s_sub_u32 s50, 2097152, s34
    s_mov_b32 s51, 0x00020000
    s_lshl_b32 s35, s60, 2
    s_add_u32 s35, s35, s28
    s_mul_i32 s36, s35, 294912
    s_add_u32 s36, s36, 21200896
    s_add_u32 s52, s22, s36
    s_addc_u32 s53, s23, 0
    s_and_b32 s53, s53, 0xffff
    s_mov_b32 s54, 65536
    s_mov_b32 s55, 0x00020000
    v_lshrrev_b32 v13, 3, v1
    s_lshl_b32 s36, s28, 4
    v_add_u32 v13, s36, v13
    v_lshlrev_b32 v3, 11, v13
    v_lshrrev_b32 v13, 2, v1
    v_xor_b32 v13, v13, v1
    v_bfe_u32 v13, v13, 2, 1
    v_lshl_add_u32 v3, v13, 6, v3
    v_and_b32 v13, 3, v1
    v_lshl_add_u32 v3, v13, 4, v3
    v_lshrrev_b32 v12, 5, v1
    v_and_b32 v13, 31, v1
    s_lshl_b32 s35, s35, 5
    v_add_u32 v13, s35, v13
    v_lshlrev_b32 v7, 11, v13
    v_lshl_add_u32 v7, v12, 5, v7
    v_add_u32 v7, s34, v7
    v_lshlrev_b32 v4, 10, v12
    v_and_b32 v13, 1, v1
    v_lshl_add_u32 v4, v13, 5, v4
    v_bfe_u32 v13, v1, 2, 2
    v_lshl_add_u32 v4, v13, 7, v4
    v_bfe_u32 v13, v1, 3, 1
    v_lshl_add_u32 v4, v13, 6, v4
    v_bfe_u32 v13, v1, 4, 1
    v_lshl_add_u32 v4, v13, 4, v4
    v_bfe_u32 v13, v1, 1, 1
    v_lshl_add_u32 v4, v13, 3, v4
    v_xor_b32 v5, 64, v4
    v_lshlrev_b32 v6, 1, v6
    s_lshl_b32 s62, s60, 9
    s_lshr_b32 s36, s28, 1
    s_lshl_b32 s36, s36, 3
    s_add_u32 s62, s62, s36
    s_add_u32 s62, s62, 42008576
    s_lshl_b32 s63, s28, 11
    s_mov_b32 s71, 33
    v_mov_b32 v16, 0
    v_mov_b32 v17, 0
    v_mov_b32 v18, 0
    v_mov_b32 v19, 0
    v_mov_b32 v20, 0
    v_mov_b32 v21, 0
    v_mov_b32 v22, 0
    v_mov_b32 v23, 0
    v_mov_b32 v24, 0
    v_mov_b32 v25, 0
    v_mov_b32 v26, 0
    v_mov_b32 v27, 0
    v_mov_b32 v28, 0
    v_mov_b32 v29, 0
    v_mov_b32 v30, 0
    v_mov_b32 v31, 0
    v_mov_b32 v32, 0
    v_mov_b32 v33, 0
    v_mov_b32 v34, 0
    v_mov_b32 v35, 0
    v_mov_b32 v36, 0
    v_mov_b32 v37, 0
    v_mov_b32 v38, 0
    v_mov_b32 v39, 0
    v_mov_b32 v40, 0
    v_mov_b32 v41, 0
    v_mov_b32 v42, 0
    v_mov_b32 v43, 0
    v_mov_b32 v44, 0
    v_mov_b32 v45, 0
    v_mov_b32 v46, 0
    v_mov_b32 v47, 0
    s_add_u32 s71, s71, 1
    s_mov_b32 s31, 1048576
L_mega_kernel_xretry_52:
    ds_read_b32 v15, v9
    s_waitcnt lgkmcnt(0)
    v_cmp_gt_u32 vcc, s71, v15
    s_sub_u32 s31, s31, 1
    s_cbranch_scc1 L_mega_kernel_xok_51
    s_cbranch_vccnz L_mega_kernel_xretry_52
L_mega_kernel_xok_51:
    s_add_u32 m0, s63, 0
    s_mov_b32 s64, 0
    buffer_load_dwordx4 v3, s[48:51], s64 offen lds
    s_add_u32 m0, s63, 1024
    s_mov_b32 s64, 16384
    buffer_load_dwordx4 v3, s[48:51], s64 offen lds
    s_add_u32 m0, s63, 8192
    s_mov_b32 s64, 131072
    buffer_load_dwordx4 v3, s[48:51], s64 offen lds
    s_add_u32 m0, s63, 9216
    s_mov_b32 s64, 147456
    buffer_load_dwordx4 v3, s[48:51], s64 offen lds
    s_add_u32 m0, s63, 16384
    s_mov_b32 s64, 262144
    buffer_load_dwordx4 v3, s[48:51], s64 offen lds
    s_add_u32 m0, s63, 17408
    s_mov_b32 s64, 278528
    buffer_load_dwordx4 v3, s[48:51], s64 offen lds
    s_add_u32 m0, s63, 24576
    s_mov_b32 s64, 393216
    buffer_load_dwordx4 v3, s[48:51], s64 offen lds
    s_add_u32 m0, s63, 25600
    s_mov_b32 s64, 409600
    buffer_load_dwordx4 v3, s[48:51], s64 offen lds
    s_add_u32 m0, s63, 32768
    s_mov_b32 s64, 524288
    buffer_load_dwordx4 v3, s[48:51], s64 offen lds
    s_add_u32 m0, s63, 33792
    s_mov_b32 s64, 540672
    buffer_load_dwordx4 v3, s[48:51], s64 offen lds
    s_mov_b32 s40, s4
    s_and_b32 s41, s5, 0xffff
    s_mov_b32 s42, 4194304
    s_mov_b32 s43, 0x00020000
    s_mov_b32 s44, s18
    s_and_b32 s45, s19, 0xffff
    s_mov_b32 s46, 4194304
    s_mov_b32 s47, 0x00020000
    buffer_load_dwordx4 v[80:83], v7, s[40:43], 0 offen offset:0
    buffer_load_dwordx4 v[84:87], v7, s[40:43], 0 offen offset:16
    buffer_load_dwordx4 v[88:91], v7, s[40:43], 0 offen offset:64
    buffer_load_dwordx4 v[92:95], v7, s[40:43], 0 offen offset:80
    s_mov_b32 s31, 131072
L_mega_kernel_poll_53:
    buffer_load_dwordx2 v[12:13], v6, s[24:27], s62 offen sc1
    s_waitcnt vmcnt(0)
    v_cmp_ne_u64 vcc, s[32:33], v[12:13]
    s_sub_u32 s31, s31, 1
    s_cbranch_scc1 L_mega_kernel_polld_54
    s_cbranch_vccnz L_mega_kernel_poll_53
L_mega_kernel_polld_54:
    v_add_u32 v11, 1, v11
    ds_write_b32 v10, v11
    s_mov_b32 s65, 0
    buffer_load_dwordx4 a[0:3], v2, s[52:55], s65 offen offset:0 sc1
    buffer_load_dwordx4 a[4:7], v2, s[52:55], s65 offen offset:1024 sc1
    s_mov_b32 s65, 2048
    buffer_load_dwordx4 a[8:11], v2, s[52:55], s65 offen offset:0 sc1
    buffer_load_dwordx4 a[12:15], v2, s[52:55], s65 offen offset:1024 sc1
    s_mov_b32 s65, 4096
    buffer_load_dwordx4 a[16:19], v2, s[52:55], s65 offen offset:0 sc1
    buffer_load_dwordx4 a[20:23], v2, s[52:55], s65 offen offset:1024 sc1
    s_mov_b32 s65, 6144
    buffer_load_dwordx4 a[24:27], v2, s[52:55], s65 offen offset:0 sc1
    buffer_load_dwordx4 a[28:31], v2, s[52:55], s65 offen offset:1024 sc1
    s_mov_b32 s65, 8192
    buffer_load_dwordx4 a[32:35], v2, s[52:55], s65 offen offset:0 sc1
    buffer_load_dwordx4 a[36:39], v2, s[52:55], s65 offen offset:1024 sc1
    s_mov_b32 s65, 10240
    buffer_load_dwordx4 a[40:43], v2, s[52:55], s65 offen offset:0 sc1
    buffer_load_dwordx4 a[44:47], v2, s[52:55], s65 offen offset:1024 sc1
    s_mov_b32 s65, 12288
    buffer_load_dwordx4 a[48:51], v2, s[52:55], s65 offen offset:0 sc1
    buffer_load_dwordx4 a[52:55], v2, s[52:55], s65 offen offset:1024 sc1
    s_mov_b32 s65, 14336
    buffer_load_dwordx4 a[56:59], v2, s[52:55], s65 offen offset:0 sc1
    buffer_load_dwordx4 a[60:63], v2, s[52:55], s65 offen offset:1024 sc1
    s_mov_b32 s65, 16384
    buffer_load_dwordx4 a[64:67], v2, s[52:55], s65 offen offset:0 sc1
    buffer_load_dwordx4 a[68:71], v2, s[52:55], s65 offen offset:1024 sc1
    s_mov_b32 s65, 18432
    buffer_load_dwordx4 a[72:75], v2, s[52:55], s65 offen offset:0 sc1
    buffer_load_dwordx4 a[76:79], v2, s[52:55], s65 offen offset:1024 sc1
    s_mov_b32 s65, 20480
    buffer_load_dwordx4 a[80:83], v2, s[52:55], s65 offen offset:0 sc1
    buffer_load_dwordx4 a[84:87], v2, s[52:55], s65 offen offset:1024 sc1
    s_mov_b32 s65, 22528
    buffer_load_dwordx4 a[88:91], v2, s[52:55], s65 offen offset:0 sc1
    buffer_load_dwordx4 a[92:95], v2, s[52:55], s65 offen offset:1024 sc1
    s_mov_b32 s65, 24576
    buffer_load_dwordx4 a[96:99], v2, s[52:55], s65 offen offset:0 sc1
    buffer_load_dwordx4 a[100:103], v2, s[52:55], s65 offen offset:1024 sc1
    s_mov_b32 s65, 26624
    buffer_load_dwordx4 a[104:107], v2, s[52:55], s65 offen offset:0 sc1
    buffer_load_dwordx4 a[108:111], v2, s[52:55], s65 offen offset:1024 sc1
    s_mov_b32 s65, 28672
    buffer_load_dwordx4 a[112:115], v2, s[52:55], s65 offen offset:0 sc1
    buffer_load_dwordx4 a[116:119], v2, s[52:55], s65 offen offset:1024 sc1
    s_mov_b32 s65, 30720
    buffer_load_dwordx4 a[120:123], v2, s[52:55], s65 offen offset:0 sc1
    buffer_load_dwordx4 a[124:127], v2, s[52:55], s65 offen offset:1024 sc1
    s_add_u32 s71, s71, 1
    s_mov_b32 s31, 1048576
L_mega_kernel_xretry_57:
    ds_read_b32 v15, v9
    s_waitcnt lgkmcnt(0)
    v_cmp_gt_u32 vcc, s71, v15
    s_sub_u32 s31, s31, 1
    s_cbranch_scc1 L_mega_kernel_xok_56
    s_cbranch_vccnz L_mega_kernel_xretry_57
L_mega_kernel_xok_56:
    ds_read_b64_tr_b16 v[48:49], v4 offset:0
    ds_read_b64_tr_b16 v[50:51], v4 offset:512
    ds_read_b64_tr_b16 v[52:53], v5 offset:0
    ds_read_b64_tr_b16 v[54:55], v5 offset:512
    ds_read_b64_tr_b16 v[56:57], v4 offset:2048
    ds_read_b64_tr_b16 v[58:59], v4 offset:2560
    ds_read_b64_tr_b16 v[60:61], v5 offset:2048
    ds_read_b64_tr_b16 v[62:63], v5 offset:2560
    ds_read_b64_tr_b16 v[64:65], v4 offset:4096
    ds_read_b64_tr_b16 v[66:67], v4 offset:4608
    ds_read_b64_tr_b16 v[68:69], v5 offset:4096
    ds_read_b64_tr_b16 v[70:71], v5 offset:4608
    s_waitcnt vmcnt(30)
    s_waitcnt lgkmcnt(10)
    v_mfma_f32_32x32x16_bf16 v[16:31], v[48:51], a[0:3], v[16:31]
    ds_read_b64_tr_b16 v[72:73], v4 offset:6144
    ds_read_b64_tr_b16 v[74:75], v4 offset:6656
    s_waitcnt lgkmcnt(10)
    v_mfma_f32_32x32x16_bf16 v[32:47], v[52:55], a[0:3], v[32:47]
    ds_read_b64_tr_b16 v[76:77], v5 offset:6144
    ds_read_b64_tr_b16 v[78:79], v5 offset:6656
    v_add_u32 v11, 1, v11
    ds_write_b32 v10, v11
    s_waitcnt lgkmcnt(11)
    v_mfma_f32_32x32x16_bf16 v[16:31], v[56:59], a[4:7], v[16:31]
    ds_read_b64_tr_b16 v[48:49], v4 offset:8192
    ds_read_b64_tr_b16 v[50:51], v4 offset:8704
    s_waitcnt lgkmcnt(11)
    v_mfma_f32_32x32x16_bf16 v[32:47], v[60:63], a[4:7], v[32:47]
    ds_read_b64_tr_b16 v[52:53], v5 offset:8192
    ds_read_b64_tr_b16 v[54:55], v5 offset:8704
    s_waitcnt vmcnt(28)
    s_waitcnt lgkmcnt(11)
    v_mfma_f32_32x32x16_bf16 v[16:31], v[64:67], a[8:11], v[16:31]
    ds_read_b64_tr_b16 v[56:57], v4 offset:10240
    ds_read_b64_tr_b16 v[58:59], v4 offset:10752
    s_mov_b32 s65, 32768
    buffer_load_dwordx4 a[0:3], v2, s[52:55], s65 offen offset:0 sc1
    buffer_load_dwordx4 a[4:7], v2, s[52:55], s65 offen offset:1024 sc1
    s_waitcnt lgkmcnt(11)
    v_mfma_f32_32x32x16_bf16 v[32:47], v[68:71], a[8:11], v[32:47]
    ds_read_b64_tr_b16 v[60:61], v5 offset:10240
    ds_read_b64_tr_b16 v[62:63], v5 offset:10752
    s_waitcnt lgkmcnt(11)
    v_mfma_f32_32x32x16_bf16 v[16:31], v[72:75], a[12:15], v[16:31]
    ds_read_b64_tr_b16 v[64:65], v4 offset:12288
    ds_read_b64_tr_b16 v[66:67], v4 offset:12800
    ds_read_b32 v15, v9
    s_waitcnt lgkmcnt(12)
    v_mfma_f32_32x32x16_bf16 v[32:47], v[76:79], a[12:15], v[32:47]
    ds_read_b64_tr_b16 v[68:69], v5 offset:12288
    ds_read_b64_tr_b16 v[70:71], v5 offset:12800
    s_waitcnt vmcnt(28)
    s_waitcnt lgkmcnt(11)
    v_mfma_f32_32x32x16_bf16 v[16:31], v[48:51], a[16:19], v[16:31]
    ds_read_b64_tr_b16 v[72:73], v4 offset:14336
    ds_read_b64_tr_b16 v[74:75], v4 offset:14848
    s_mov_b32 s65, 34816
    buffer_load_dwordx4 a[8:11], v2, s[52:55], s65 offen offset:0 sc1
    buffer_load_dwordx4 a[12:15], v2, s[52:55], s65 offen offset:1024 sc1
    s_waitcnt lgkmcnt(11)
    v_mfma_f32_32x32x16_bf16 v[32:47], v[52:55], a[16:19], v[32:47]
    ds_read_b64_tr_b16 v[76:77], v5 offset:14336
    ds_read_b64_tr_b16 v[78:79], v5 offset:14848
    s_add_u32 s71, s71, 1
    s_waitcnt lgkmcnt(6)
    v_cmp_gt_u32 vcc, s71, v15
    s_cbranch_vccz L_mega_kernel_xok_58
    s_mov_b32 s31, 1048576
L_mega_kernel_xretry_59:
    ds_read_b32 v15, v9
    s_waitcnt lgkmcnt(0)
    v_cmp_gt_u32 vcc, s71, v15
    s_sub_u32 s31, s31, 1
    s_cbranch_scc1 L_mega_kernel_xok_58
    s_cbranch_vccnz L_mega_kernel_xretry_59
L_mega_kernel_xok_58:
    v_add_u32 v11, 1, v11
    ds_write_b32 v10, v11
    v_mfma_f32_32x32x16_bf16 v[16:31], v[56:59], a[20:23], v[16:31]
    ds_read_b64_tr_b16 v[48:49], v4 offset:16384
    ds_read_b64_tr_b16 v[50:51], v4 offset:16896
    s_add_u32 m0, s63, 0
    s_mov_b32 s64, 655360
    buffer_load_dwordx4 v3, s[48:51], s64 offen lds
    v_mfma_f32_32x32x16_bf16 v[32:47], v[60:63], a[20:23], v[32:47]
    ds_read_b64_tr_b16 v[52:53], v5 offset:16384
    ds_read_b64_tr_b16 v[54:55], v5 offset:16896
    s_add_u32 m0, s63, 1024
    s_mov_b32 s64, 671744
    buffer_load_dwordx4 v3, s[48:51], s64 offen lds
    s_waitcnt vmcnt(30)
    v_mfma_f32_32x32x16_bf16 v[16:31], v[64:67], a[24:27], v[16:31]
    ds_read_b64_tr_b16 v[56:57], v4 offset:18432
    ds_read_b64_tr_b16 v[58:59], v4 offset:18944
    s_mov_b32 s65, 36864
    buffer_load_dwordx4 a[16:19], v2, s[52:55], s65 offen offset:0 sc1
    buffer_load_dwordx4 a[20:23], v2, s[52:55], s65 offen offset:1024 sc1
    s_waitcnt lgkmcnt(11)
    v_mfma_f32_32x32x16_bf16 v[32:47], v[68:71], a[24:27], v[32:47]
    ds_read_b64_tr_b16 v[60:61], v5 offset:18432
    ds_read_b64_tr_b16 v[62:63], v5 offset:18944
    s_waitcnt lgkmcnt(11)
    v_mfma_f32_32x32x16_bf16 v[16:31], v[72:75], a[28:31], v[16:31]
    ds_read_b64_tr_b16 v[64:65], v4 offset:20480
    ds_read_b64_tr_b16 v[66:67], v4 offset:20992
    ds_read_b32 v15, v9
    s_waitcnt lgkmcnt(12)
    v_mfma_f32_32x32x16_bf16 v[32:47], v[76:79], a[28:31], v[32:47]
    ds_read_b64_tr_b16 v[68:69], v5 offset:20480
    ds_read_b64_tr_b16 v[70:71], v5 offset:20992
    s_waitcnt vmcnt(30)
    s_waitcnt lgkmcnt(11)
    v_mfma_f32_32x32x16_bf16 v[16:31], v[48:51], a[32:35], v[16:31]
    ds_read_b64_tr_b16 v[72:73], v4 offset:22528
    ds_read_b64_tr_b16 v[74:75], v4 offset:23040
    s_mov_b32 s65, 38912
    buffer_load_dwordx4 a[24:27], v2, s[52:55], s65 offen offset:0 sc1
    buffer_load_dwordx4 a[28:31], v2, s[52:55], s65 offen offset:1024 sc1
    s_waitcnt lgkmcnt(11)
    v_mfma_f32_32x32x16_bf16 v[32:47], v[52:55], a[32:35], v[32:47]
    ds_read_b64_tr_b16 v[76:77], v5 offset:22528
    ds_read_b64_tr_b16 v[78:79], v5 offset:23040
    s_add_u32 s71, s71, 1
    s_waitcnt lgkmcnt(6)
    v_cmp_gt_u32 vcc, s71, v15
    s_cbranch_vccz L_mega_kernel_xok_60
    s_mov_b32 s31, 1048576
L_mega_kernel_xretry_61:
    ds_read_b32 v15, v9
    s_waitcnt lgkmcnt(0)
    v_cmp_gt_u32 vcc, s71, v15
    s_sub_u32 s31, s31, 1
    s_cbranch_scc1 L_mega_kernel_xok_60
    s_cbranch_vccnz L_mega_kernel_xretry_61
L_mega_kernel_xok_60:
    v_add_u32 v11, 1, v11
    ds_write_b32 v10, v11
    v_mfma_f32_32x32x16_bf16 v[16:31], v[56:59], a[36:39], v[16:31]
    ds_read_b64_tr_b16 v[48:49], v4 offset:24576
    ds_read_b64_tr_b16 v[50:51], v4 offset:25088
    s_add_u32 m0, s63, 8192
    s_mov_b32 s64, 786432
    buffer_load_dwordx4 v3, s[48:51], s64 offen lds
    v_mfma_f32_32x32x16_bf16 v[32:47], v[60:63], a[36:39], v[32:47]
    ds_read_b64_tr_b16 v[52:53], v5 offset:24576
    ds_read_b64_tr_b16 v[54:55], v5 offset:25088
    s_add_u32 m0, s63, 9216
    s_mov_b32 s64, 802816
    buffer_load_dwordx4 v3, s[48:51], s64 offen lds
    s_waitcnt vmcnt(32)
    v_mfma_f32_32x32x16_bf16 v[16:31], v[64:67], a[40:43], v[16:31]
    ds_read_b64_tr_b16 v[56:57], v4 offset:26624
    ds_read_b64_tr_b16 v[58:59], v4 offset:27136
    s_mov_b32 s65, 40960
    buffer_load_dwordx4 a[32:35], v2, s[52:55], s65 offen offset:0 sc1
    buffer_load_dwordx4 a[36:39], v2, s[52:55], s65 offen offset:1024 sc1
    s_waitcnt lgkmcnt(11)
    v_mfma_f32_32x32x16_bf16 v[32:47], v[68:71], a[40:43], v[32:47]
    ds_read_b64_tr_b16 v[60:61], v5 offset:26624
    ds_read_b64_tr_b16 v[62:63], v5 offset:27136
    s_waitcnt lgkmcnt(11)
    v_mfma_f32_32x32x16_bf16 v[16:31], v[72:75], a[44:47], v[16:31]
    ds_read_b64_tr_b16 v[64:65], v4 offset:28672
    ds_read_b64_tr_b16 v[66:67], v4 offset:29184
    ds_read_b32 v15, v9
    s_waitcnt lgkmcnt(12)
    v_mfma_f32_32x32x16_bf16 v[32:47], v[76:79], a[44:47], v[32:47]
    ds_read_b64_tr_b16 v[68:69], v5 offset:28672
    ds_read_b64_tr_b16 v[70:71], v5 offset:29184
    s_waitcnt vmcnt(32)
    s_waitcnt lgkmcnt(11)
    v_mfma_f32_32x32x16_bf16 v[16:31], v[48:51], a[48:51], v[16:31]
    ds_read_b64_tr_b16 v[72:73], v4 offset:30720
    ds_read_b64_tr_b16 v[74:75], v4 offset:31232
    s_mov_b32 s65, 43008
    buffer_load_dwordx4 a[40:43], v2, s[52:55], s65 offen offset:0 sc1
    buffer_load_dwordx4 a[44:47], v2, s[52:55], s65 offen offset:1024 sc1
    s_waitcnt lgkmcnt(11)
    v_mfma_f32_32x32x16_bf16 v[32:47], v[52:55], a[48:51], v[32:47]
    ds_read_b64_tr_b16 v[76:77], v5 offset:30720
    ds_read_b64_tr_b16 v[78:79], v5 offset:31232
    s_add_u32 s71, s71, 1
    s_waitcnt lgkmcnt(6)
    v_cmp_gt_u32 vcc, s71, v15
    s_cbranch_vccz L_mega_kernel_xok_62
    s_mov_b32 s31, 1048576
L_mega_kernel_xretry_63:
    ds_read_b32 v15, v9
    s_waitcnt lgkmcnt(0)
    v_cmp_gt_u32 vcc, s71, v15
    s_sub_u32 s31, s31, 1
    s_cbranch_scc1 L_mega_kernel_xok_62
    s_cbranch_vccnz L_mega_kernel_xretry_63
L_mega_kernel_xok_62:
    s_waitcnt vmcnt(10)
    v_add_u32 v11, 1, v11
    ds_write_b32 v10, v11
    v_mfma_f32_32x32x16_bf16 v[16:31], v[56:59], a[52:55], v[16:31]
    ds_read_b64_tr_b16 v[48:49], v4 offset:32768
    ds_read_b64_tr_b16 v[50:51], v4 offset:33280
    s_add_u32 m0, s63, 16384
    s_mov_b32 s64, 917504
    buffer_load_dwordx4 v3, s[48:51], s64 offen lds
    v_mfma_f32_32x32x16_bf16 v[32:47], v[60:63], a[52:55], v[32:47]
    ds_read_b64_tr_b16 v[52:53], v5 offset:32768
    ds_read_b64_tr_b16 v[54:55], v5 offset:33280
    s_add_u32 m0, s63, 17408
    s_mov_b32 s64, 933888
    buffer_load_dwordx4 v3, s[48:51], s64 offen lds
    v_mfma_f32_32x32x16_bf16 v[16:31], v[64:67], a[56:59], v[16:31]
    ds_read_b64_tr_b16 v[56:57], v4 offset:34816
    ds_read_b64_tr_b16 v[58:59], v4 offset:35328
    s_mov_b32 s65, 45056
    buffer_load_dwordx4 a[48:51], v2, s[52:55], s65 offen offset:0 sc1
    buffer_load_dwordx4 a[52:55], v2, s[52:55], s65 offen offset:1024 sc1
    s_waitcnt lgkmcnt(11)
    v_mfma_f32_32x32x16_bf16 v[32:47], v[68:71], a[56:59], v[32:47]
    ds_read_b64_tr_b16 v[60:61], v5 offset:34816
    ds_read_b64_tr_b16 v[62:63], v5 offset:35328
    s_waitcnt lgkmcnt(11)
    v_mfma_f32_32x32x16_bf16 v[16:31], v[72:75], a[60:63], v[16:31]
    ds_read_b64_tr_b16 v[64:65], v4 offset:36864
    ds_read_b64_tr_b16 v[66:67], v4 offset:37376
    ds_read_b32 v15, v9
    s_waitcnt lgkmcnt(12)
    v_mfma_f32_32x32x16_bf16 v[32:47], v[76:79], a[60:63], v[32:47]
    ds_read_b64_tr_b16 v[68:69], v5 offset:36864
    ds_read_b64_tr_b16 v[70:71], v5 offset:37376
    s_waitcnt lgkmcnt(11)
    v_mfma_f32_32x32x16_bf16 v[16:31], v[48:51], a[64:67], v[16:31]
    ds_read_b64_tr_b16 v[72:73], v4 offset:38912
    ds_read_b64_tr_b16 v[74:75], v4 offset:39424
    s_mov_b32 s65, 47104
    buffer_load_dwordx4 a[56:59], v2, s[52:55], s65 offen offset:0 sc1
    buffer_load_dwordx4 a[60:63], v2, s[52:55], s65 offen offset:1024 sc1
    s_waitcnt lgkmcnt(11)
    v_mfma_f32_32x32x16_bf16 v[32:47], v[52:55], a[64:67], v[32:47]
    ds_read_b64_tr_b16 v[76:77], v5 offset:38912
    ds_read_b64_tr_b16 v[78:79], v5 offset:39424
    s_add_u32 s71, s71, 1
    s_waitcnt lgkmcnt(6)
    v_cmp_gt_u32 vcc, s71, v15
    s_cbranch_vccz L_mega_kernel_xok_64
    s_mov_b32 s31, 1048576
L_mega_kernel_xretry_65:
    ds_read_b32 v15, v9
    s_waitcnt lgkmcnt(0)
    v_cmp_gt_u32 vcc, s71, v15
    s_sub_u32 s31, s31, 1
    s_cbranch_scc1 L_mega_kernel_xok_64
    s_cbranch_vccnz L_mega_kernel_xretry_65
L_mega_kernel_xok_64:
    s_waitcnt vmcnt(10)
    v_add_u32 v11, 1, v11
    ds_write_b32 v10, v11
    v_mfma_f32_32x32x16_bf16 v[16:31], v[56:59], a[68:71], v[16:31]
    ds_read_b64_tr_b16 v[48:49], v4 offset:0
    ds_read_b64_tr_b16 v[50:51], v4 offset:512
    s_add_u32 m0, s63, 24576
    s_mov_b32 s64, 1048576
    buffer_load_dwordx4 v3, s[48:51], s64 offen lds
    v_mfma_f32_32x32x16_bf16 v[32:47], v[60:63], a[68:71], v[32:47]
    ds_read_b64_tr_b16 v[52:53], v5 offset:0
    ds_read_b64_tr_b16 v[54:55], v5 offset:512
    s_add_u32 m0, s63, 25600
    s_mov_b32 s64, 1064960
    buffer_load_dwordx4 v3, s[48:51], s64 offen lds
    v_mfma_f32_32x32x16_bf16 v[16:31], v[64:67], a[72:75], v[16:31]
    ds_read_b64_tr_b16 v[56:57], v4 offset:2048
    ds_read_b64_tr_b16 v[58:59], v4 offset:2560
    s_mov_b32 s65, 49152
    buffer_load_dwordx4 a[64:67], v2, s[52:55], s65 offen offset:0 sc1
    buffer_load_dwordx4 a[68:71], v2, s[52:55], s65 offen offset:1024 sc1
    s_waitcnt lgkmcnt(11)
    v_mfma_f32_32x32x16_bf16 v[32:47], v[68:71], a[72:75], v[32:47]
    ds_read_b64_tr_b16 v[60:61], v5 offset:2048
    ds_read_b64_tr_b16 v[62:63], v5 offset:2560
    s_waitcnt lgkmcnt(11)
    v_mfma_f32_32x32x16_bf16 v[16:31], v[72:75], a[76:79], v[16:31]
    ds_read_b64_tr_b16 v[64:65], v4 offset:4096
    ds_read_b64_tr_b16 v[66:67], v4 offset:4608
    ds_read_b32 v15, v9
    s_waitcnt lgkmcnt(12)
    v_mfma_f32_32x32x16_bf16 v[32:47], v[76:79], a[76:79], v[32:47]
    ds_read_b64_tr_b16 v[68:69], v5 offset:4096
    ds_read_b64_tr_b16 v[70:71], v5 offset:4608
    s_waitcnt lgkmcnt(11)
    v_mfma_f32_32x32x16_bf16 v[16:31], v[48:51], a[80:83], v[16:31]
    ds_read_b64_tr_b16 v[72:73], v4 offset:6144
    ds_read_b64_tr_b16 v[74:75], v4 offset:6656
    s_mov_b32 s65, 51200
    buffer_load_dwordx4 a[72:75], v2, s[52:55], s65 offen offset:0 sc1
    buffer_load_dwordx4 a[76:79], v2, s[52:55], s65 offen offset:1024 sc1
    s_waitcnt lgkmcnt(11)
    v_mfma_f32_32x32x16_bf16 v[32:47], v[52:55], a[80:83], v[32:47]
    ds_read_b64_tr_b16 v[76:77], v5 offset:6144
    ds_read_b64_tr_b16 v[78:79], v5 offset:6656
    s_add_u32 s71, s71, 1
    s_waitcnt lgkmcnt(6)
    v_cmp_gt_u32 vcc, s71, v15
    s_cbranch_vccz L_mega_kernel_xok_66
    s_mov_b32 s31, 1048576
L_mega_kernel_xretry_67:
    ds_read_b32 v15, v9
    s_waitcnt lgkmcnt(0)
    v_cmp_gt_u32 vcc, s71, v15
    s_sub_u32 s31, s31, 1
    s_cbranch_scc1 L_mega_kernel_xok_66
    s_cbranch_vccnz L_mega_kernel_xretry_67
L_mega_kernel_xok_66:
    s_waitcnt vmcnt(10)
    v_add_u32 v11, 1, v11
    ds_write_b32 v10, v11
    v_mfma_f32_32x32x16_bf16 v[16:31], v[56:59], a[84:87], v[16:31]
    ds_read_b64_tr_b16 v[48:49], v4 offset:8192
    ds_read_b64_tr_b16 v[50:51], v4 offset:8704
    s_add_u32 m0, s63, 32768
    s_mov_b32 s64, 1179648
    buffer_load_dwordx4 v3, s[48:51], s64 offen lds
    v_mfma_f32_32x32x16_bf16 v[32:47], v[60:63], a[84:87], v[32:47]
    ds_read_b64_tr_b16 v[52:53], v5 offset:8192
    ds_read_b64_tr_b16 v[54:55], v5 offset:8704
    s_add_u32 m0, s63, 33792
    s_mov_b32 s64, 1196032
    buffer_load_dwordx4 v3, s[48:51], s64 offen lds
    v_mfma_f32_32x32x16_bf16 v[16:31], v[64:67], a[88:91], v[16:31]
    ds_read_b64_tr_b16 v[56:57], v4 offset:10240
    ds_read_b64_tr_b16 v[58:59], v4 offset:10752
    s_mov_b32 s65, 53248
    buffer_load_dwordx4 a[80:83], v2, s[52:55], s65 offen offset:0 sc1
    buffer_load_dwordx4 a[84:87], v2, s[52:55], s65 offen offset:1024 sc1
    s_waitcnt lgkmcnt(11)
    v_mfma_f32_32x32x16_bf16 v[32:47], v[68:71], a[88:91], v[32:47]
    ds_read_b64_tr_b16 v[60:61], v5 offset:10240
    ds_read_b64_tr_b16 v[62:63], v5 offset:10752
    s_waitcnt lgkmcnt(11)
    v_mfma_f32_32x32x16_bf16 v[16:31], v[72:75], a[92:95], v[16:31]
    ds_read_b64_tr_b16 v[64:65], v4 offset:12288
    ds_read_b64_tr_b16 v[66:67], v4 offset:12800
    ds_read_b32 v15, v9
    s_waitcnt lgkmcnt(12)
    v_mfma_f32_32x32x16_bf16 v[32:47], v[76:79], a[92:95], v[32:47]
    ds_read_b64_tr_b16 v[68:69], v5 offset:12288
    ds_read_b64_tr_b16 v[70:71], v5 offset:12800
    s_waitcnt lgkmcnt(11)
    v_mfma_f32_32x32x16_bf16 v[16:31], v[48:51], a[96:99], v[16:31]
    ds_read_b64_tr_b16 v[72:73], v4 offset:14336
    ds_read_b64_tr_b16 v[74:75], v4 offset:14848
    s_mov_b32 s65, 55296
    buffer_load_dwordx4 a[88:91], v2, s[52:55], s65 offen offset:0 sc1
    buffer_load_dwordx4 a[92:95], v2, s[52:55], s65 offen offset:1024 sc1
    s_waitcnt lgkmcnt(11)
    v_mfma_f32_32x32x16_bf16 v[32:47], v[52:55], a[96:99], v[32:47]
    ds_read_b64_tr_b16 v[76:77], v5 offset:14336
    ds_read_b64_tr_b16 v[78:79], v5 offset:14848
    s_add_u32 s71, s71, 1
    s_waitcnt lgkmcnt(6)
    v_cmp_gt_u32 vcc, s71, v15
    s_cbranch_vccz L_mega_kernel_xok_68
    s_mov_b32 s31, 1048576
L_mega_kernel_xretry_69:
    ds_read_b32 v15, v9
    s_waitcnt lgkmcnt(0)
    v_cmp_gt_u32 vcc, s71, v15
    s_sub_u32 s31, s31, 1
    s_cbranch_scc1 L_mega_kernel_xok_68
    s_cbranch_vccnz L_mega_kernel_xretry_69
L_mega_kernel_xok_68:
    s_waitcnt vmcnt(10)
    v_add_u32 v11, 1, v11
    ds_write_b32 v10, v11
    v_mfma_f32_32x32x16_bf16 v[16:31], v[56:59], a[100:103], v[16:31]
    ds_read_b64_tr_b16 v[48:49], v4 offset:16384
    ds_read_b64_tr_b16 v[50:51], v4 offset:16896
    s_add_u32 m0, s63, 0
    s_mov_b32 s64, 1310720
    buffer_load_dwordx4 v3, s[48:51], s64 offen lds
    v_mfma_f32_32x32x16_bf16 v[32:47], v[60:63], a[100:103], v[32:47]
    ds_read_b64_tr_b16 v[52:53], v5 offset:16384
    ds_read_b64_tr_b16 v[54:55], v5 offset:16896
    s_add_u32 m0, s63, 1024
    s_mov_b32 s64, 1327104
    buffer_load_dwordx4 v3, s[48:51], s64 offen lds
    v_mfma_f32_32x32x16_bf16 v[16:31], v[64:67], a[104:107], v[16:31]
    ds_read_b64_tr_b16 v[56:57], v4 offset:18432
    ds_read_b64_tr_b16 v[58:59], v4 offset:18944
    s_mov_b32 s65, 57344
    buffer_load_dwordx4 a[96:99], v2, s[52:55], s65 offen offset:0 sc1
    buffer_load_dwordx4 a[100:103], v2, s[52:55], s65 offen offset:1024 sc1
    s_waitcnt lgkmcnt(11)
    v_mfma_f32_32x32x16_bf16 v[32:47], v[68:71], a[104:107], v[32:47]
    ds_read_b64_tr_b16 v[60:61], v5 offset:18432
    ds_read_b64_tr_b16 v[62:63], v5 offset:18944
    s_waitcnt lgkmcnt(11)
    v_mfma_f32_32x32x16_bf16 v[16:31], v[72:75], a[108:111], v[16:31]
    ds_read_b64_tr_b16 v[64:65], v4 offset:20480
    ds_read_b64_tr_b16 v[66:67], v4 offset:20992
    ds_read_b32 v15, v9
    s_waitcnt lgkmcnt(12)
    v_mfma_f32_32x32x16_bf16 v[32:47], v[76:79], a[108:111], v[32:47]
    ds_read_b64_tr_b16 v[68:69], v5 offset:20480
    ds_read_b64_tr_b16 v[70:71], v5 offset:20992
    s_waitcnt lgkmcnt(11)
    v_mfma_f32_32x32x16_bf16 v[16:31], v[48:51], a[112:115], v[16:31]
    ds_read_b64_tr_b16 v[72:73], v4 offset:22528
    ds_read_b64_tr_b16 v[74:75], v4 offset:23040
    s_mov_b32 s65, 59392
    buffer_load_dwordx4 a[104:107], v2, s[52:55], s65 offen offset:0 sc1
    buffer_load_dwordx4 a[108:111], v2, s[52:55], s65 offen offset:1024 sc1
    s_waitcnt lgkmcnt(11)
    v_mfma_f32_32x32x16_bf16 v[32:47], v[52:55], a[112:115], v[32:47]
    ds_read_b64_tr_b16 v[76:77], v5 offset:22528
    ds_read_b64_tr_b16 v[78:79], v5 offset:23040
    s_add_u32 s71, s71, 1
    s_waitcnt lgkmcnt(6)
    v_cmp_gt_u32 vcc, s71, v15
    s_cbranch_vccz L_mega_kernel_xok_70
    s_mov_b32 s31, 1048576
L_mega_kernel_xretry_71:
    ds_read_b32 v15, v9
    s_waitcnt lgkmcnt(0)
    v_cmp_gt_u32 vcc, s71, v15
    s_sub_u32 s31, s31, 1
    s_cbranch_scc1 L_mega_kernel_xok_70
    s_cbranch_vccnz L_mega_kernel_xretry_71
L_mega_kernel_xok_70:
    s_waitcnt vmcnt(10)
    v_add_u32 v11, 1, v11
    ds_write_b32 v10, v11
    v_mfma_f32_32x32x16_bf16 v[16:31], v[56:59], a[116:119], v[16:31]
    ds_read_b64_tr_b16 v[48:49], v4 offset:24576
    ds_read_b64_tr_b16 v[50:51], v4 offset:25088
    s_add_u32 m0, s63, 8192
    s_mov_b32 s64, 1441792
    buffer_load_dwordx4 v3, s[48:51], s64 offen lds
    v_mfma_f32_32x32x16_bf16 v[32:47], v[60:63], a[116:119], v[32:47]
    ds_read_b64_tr_b16 v[52:53], v5 offset:24576
    ds_read_b64_tr_b16 v[54:55], v5 offset:25088
    s_add_u32 m0, s63, 9216
    s_mov_b32 s64, 1458176
    buffer_load_dwordx4 v3, s[48:51], s64 offen lds
    v_mfma_f32_32x32x16_bf16 v[16:31], v[64:67], a[120:123], v[16:31]
    ds_read_b64_tr_b16 v[56:57], v4 offset:26624
    ds_read_b64_tr_b16 v[58:59], v4 offset:27136
    s_mov_b32 s65, 61440
    buffer_load_dwordx4 a[112:115], v2, s[52:55], s65 offen offset:0 sc1
    buffer_load_dwordx4 a[116:119], v2, s[52:55], s65 offen offset:1024 sc1
    s_waitcnt lgkmcnt(11)
    v_mfma_f32_32x32x16_bf16 v[32:47], v[68:71], a[120:123], v[32:47]
    ds_read_b64_tr_b16 v[60:61], v5 offset:26624
    ds_read_b64_tr_b16 v[62:63], v5 offset:27136
    s_waitcnt lgkmcnt(11)
    v_mfma_f32_32x32x16_bf16 v[16:31], v[72:75], a[124:127], v[16:31]
    ds_read_b64_tr_b16 v[64:65], v4 offset:28672
    ds_read_b64_tr_b16 v[66:67], v4 offset:29184
    ds_read_b32 v15, v9
    s_waitcnt lgkmcnt(12)
    v_mfma_f32_32x32x16_bf16 v[32:47], v[76:79], a[124:127], v[32:47]
    ds_read_b64_tr_b16 v[68:69], v5 offset:28672
    ds_read_b64_tr_b16 v[70:71], v5 offset:29184
    s_waitcnt lgkmcnt(11)
    v_mfma_f32_32x32x16_bf16 v[16:31], v[48:51], a[0:3], v[16:31]
    ds_read_b64_tr_b16 v[72:73], v4 offset:30720
    ds_read_b64_tr_b16 v[74:75], v4 offset:31232
    s_mov_b32 s65, 63488
    buffer_load_dwordx4 a[120:123], v2, s[52:55], s65 offen offset:0 sc1
    buffer_load_dwordx4 a[124:127], v2, s[52:55], s65 offen offset:1024 sc1
    s_waitcnt lgkmcnt(11)
    v_mfma_f32_32x32x16_bf16 v[32:47], v[52:55], a[0:3], v[32:47]
    ds_read_b64_tr_b16 v[76:77], v5 offset:30720
    ds_read_b64_tr_b16 v[78:79], v5 offset:31232
    s_add_u32 s71, s71, 1
    s_waitcnt lgkmcnt(6)
    v_cmp_gt_u32 vcc, s71, v15
    s_cbranch_vccz L_mega_kernel_xok_72
    s_mov_b32 s31, 1048576
L_mega_kernel_xretry_73:
    ds_read_b32 v15, v9
    s_waitcnt lgkmcnt(0)
    v_cmp_gt_u32 vcc, s71, v15
    s_sub_u32 s31, s31, 1
    s_cbranch_scc1 L_mega_kernel_xok_72
    s_cbranch_vccnz L_mega_kernel_xretry_73
L_mega_kernel_xok_72:
    s_waitcnt vmcnt(10)
    v_add_u32 v11, 1, v11
    ds_write_b32 v10, v11
    v_mfma_f32_32x32x16_bf16 v[16:31], v[56:59], a[4:7], v[16:31]
    ds_read_b64_tr_b16 v[48:49], v4 offset:32768
    ds_read_b64_tr_b16 v[50:51], v4 offset:33280
    s_add_u32 m0, s63, 16384
    s_mov_b32 s64, 1572864
    buffer_load_dwordx4 v3, s[48:51], s64 offen lds
    v_mfma_f32_32x32x16_bf16 v[32:47], v[60:63], a[4:7], v[32:47]
    ds_read_b64_tr_b16 v[52:53], v5 offset:32768
    ds_read_b64_tr_b16 v[54:55], v5 offset:33280
    s_add_u32 m0, s63, 17408
    s_mov_b32 s64, 1589248
    buffer_load_dwordx4 v3, s[48:51], s64 offen lds
    v_mfma_f32_32x32x16_bf16 v[16:31], v[64:67], a[8:11], v[16:31]
    ds_read_b64_tr_b16 v[56:57], v4 offset:34816
    ds_read_b64_tr_b16 v[58:59], v4 offset:35328
    s_waitcnt lgkmcnt(11)
    v_mfma_f32_32x32x16_bf16 v[32:47], v[68:71], a[8:11], v[32:47]
    ds_read_b64_tr_b16 v[60:61], v5 offset:34816
    ds_read_b64_tr_b16 v[62:63], v5 offset:35328
    s_waitcnt lgkmcnt(11)
    v_mfma_f32_32x32x16_bf16 v[16:31], v[72:75], a[12:15], v[16:31]
    ds_read_b64_tr_b16 v[64:65], v4 offset:36864
    ds_read_b64_tr_b16 v[66:67], v4 offset:37376
    ds_read_b32 v15, v9
    s_waitcnt lgkmcnt(12)
    v_mfma_f32_32x32x16_bf16 v[32:47], v[76:79], a[12:15], v[32:47]
    ds_read_b64_tr_b16 v[68:69], v5 offset:36864
    ds_read_b64_tr_b16 v[70:71], v5 offset:37376
    s_waitcnt lgkmcnt(11)
    v_mfma_f32_32x32x16_bf16 v[16:31], v[48:51], a[16:19], v[16:31]
    ds_read_b64_tr_b16 v[72:73], v4 offset:38912
    ds_read_b64_tr_b16 v[74:75], v4 offset:39424
    s_waitcnt lgkmcnt(11)
    v_mfma_f32_32x32x16_bf16 v[32:47], v[52:55], a[16:19], v[32:47]
    ds_read_b64_tr_b16 v[76:77], v5 offset:38912
    ds_read_b64_tr_b16 v[78:79], v5 offset:39424
    s_add_u32 s71, s71, 1
    s_waitcnt lgkmcnt(6)
    v_cmp_gt_u32 vcc, s71, v15
    s_cbranch_vccz L_mega_kernel_xok_74
    s_mov_b32 s31, 1048576
L_mega_kernel_xretry_75:
    ds_read_b32 v15, v9
    s_waitcnt lgkmcnt(0)
    v_cmp_gt_u32 vcc, s71, v15
    s_sub_u32 s31, s31, 1
    s_cbranch_scc1 L_mega_kernel_xok_74
    s_cbranch_vccnz L_mega_kernel_xretry_75
L_mega_kernel_xok_74:
    s_waitcnt vmcnt(6)
    v_add_u32 v11, 1, v11
    ds_write_b32 v10, v11
    v_mfma_f32_32x32x16_bf16 v[16:31], v[56:59], a[20:23], v[16:31]
    ds_read_b64_tr_b16 v[48:49], v4 offset:0
    ds_read_b64_tr_b16 v[50:51], v4 offset:512
    s_add_u32 m0, s63, 24576
    s_mov_b32 s64, 1703936
    buffer_load_dwordx4 v3, s[48:51], s64 offen lds
    v_mfma_f32_32x32x16_bf16 v[32:47], v[60:63], a[20:23], v[32:47]
    ds_read_b64_tr_b16 v[52:53], v5 offset:0
    ds_read_b64_tr_b16 v[54:55], v5 offset:512
    s_add_u32 m0, s63, 25600
    s_mov_b32 s64, 1720320
    buffer_load_dwordx4 v3, s[48:51], s64 offen lds
    v_mfma_f32_32x32x16_bf16 v[16:31], v[64:67], a[24:27], v[16:31]
    ds_read_b64_tr_b16 v[56:57], v4 offset:2048
    ds_read_b64_tr_b16 v[58:59], v4 offset:2560
    s_waitcnt lgkmcnt(11)
    v_mfma_f32_32x32x16_bf16 v[32:47], v[68:71], a[24:27], v[32:47]
    ds_read_b64_tr_b16 v[60:61], v5 offset:2048
    ds_read_b64_tr_b16 v[62:63], v5 offset:2560
    s_waitcnt lgkmcnt(11)
    v_mfma_f32_32x32x16_bf16 v[16:31], v[72:75], a[28:31], v[16:31]
    ds_read_b64_tr_b16 v[64:65], v4 offset:4096
    ds_read_b64_tr_b16 v[66:67], v4 offset:4608
    ds_read_b32 v15, v9
    s_waitcnt lgkmcnt(12)
    v_mfma_f32_32x32x16_bf16 v[32:47], v[76:79], a[28:31], v[32:47]
    ds_read_b64_tr_b16 v[68:69], v5 offset:4096
    ds_read_b64_tr_b16 v[70:71], v5 offset:4608
    s_waitcnt lgkmcnt(11)
    v_mfma_f32_32x32x16_bf16 v[16:31], v[48:51], a[32:35], v[16:31]
    ds_read_b64_tr_b16 v[72:73], v4 offset:6144
    ds_read_b64_tr_b16 v[74:75], v4 offset:6656
    s_waitcnt lgkmcnt(11)
    v_mfma_f32_32x32x16_bf16 v[32:47], v[52:55], a[32:35], v[32:47]
    ds_read_b64_tr_b16 v[76:77], v5 offset:6144
    ds_read_b64_tr_b16 v[78:79], v5 offset:6656
    s_add_u32 s71, s71, 1
    s_waitcnt lgkmcnt(6)
    v_cmp_gt_u32 vcc, s71, v15
    s_cbranch_vccz L_mega_kernel_xok_76
    s_mov_b32 s31, 1048576
L_mega_kernel_xretry_77:
    ds_read_b32 v15, v9
    s_waitcnt lgkmcnt(0)
    v_cmp_gt_u32 vcc, s71, v15
    s_sub_u32 s31, s31, 1
    s_cbranch_scc1 L_mega_kernel_xok_76
    s_cbranch_vccnz L_mega_kernel_xretry_77
L_mega_kernel_xok_76:
    s_waitcnt vmcnt(2)
    v_add_u32 v11, 1, v11
    ds_write_b32 v10, v11
    v_mfma_f32_32x32x16_bf16 v[16:31], v[56:59], a[36:39], v[16:31]
    ds_read_b64_tr_b16 v[48:49], v4 offset:8192
    ds_read_b64_tr_b16 v[50:51], v4 offset:8704
    s_add_u32 m0, s63, 32768
    s_mov_b32 s64, 1835008
    buffer_load_dwordx4 v3, s[48:51], s64 offen lds
    v_mfma_f32_32x32x16_bf16 v[32:47], v[60:63], a[36:39], v[32:47]
    ds_read_b64_tr_b16 v[52:53], v5 offset:8192
    ds_read_b64_tr_b16 v[54:55], v5 offset:8704
    s_add_u32 m0, s63, 33792
    s_mov_b32 s64, 1851392
    buffer_load_dwordx4 v3, s[48:51], s64 offen lds
    v_mfma_f32_32x32x16_bf16 v[16:31], v[64:67], a[40:43], v[16:31]
    ds_read_b64_tr_b16 v[56:57], v4 offset:10240
    ds_read_b64_tr_b16 v[58:59], v4 offset:10752
    s_waitcnt lgkmcnt(11)
    v_mfma_f32_32x32x16_bf16 v[32:47], v[68:71], a[40:43], v[32:47]
    ds_read_b64_tr_b16 v[60:61], v5 offset:10240
    ds_read_b64_tr_b16 v[62:63], v5 offset:10752
    s_waitcnt lgkmcnt(11)
    v_mfma_f32_32x32x16_bf16 v[16:31], v[72:75], a[44:47], v[16:31]
    ds_read_b64_tr_b16 v[64:65], v4 offset:12288
    ds_read_b64_tr_b16 v[66:67], v4 offset:12800
    ds_read_b32 v15, v9
    s_waitcnt lgkmcnt(12)
    v_mfma_f32_32x32x16_bf16 v[32:47], v[76:79], a[44:47], v[32:47]
    ds_read_b64_tr_b16 v[68:69], v5 offset:12288
    ds_read_b64_tr_b16 v[70:71], v5 offset:12800
    s_waitcnt lgkmcnt(11)
    v_mfma_f32_32x32x16_bf16 v[16:31], v[48:51], a[48:51], v[16:31]
    ds_read_b64_tr_b16 v[72:73], v4 offset:14336
    ds_read_b64_tr_b16 v[74:75], v4 offset:14848
    s_waitcnt lgkmcnt(11)
    v_mfma_f32_32x32x16_bf16 v[32:47], v[52:55], a[48:51], v[32:47]
    ds_read_b64_tr_b16 v[76:77], v5 offset:14336
    ds_read_b64_tr_b16 v[78:79], v5 offset:14848
    s_add_u32 s71, s71, 1
    s_waitcnt lgkmcnt(6)
    v_cmp_gt_u32 vcc, s71, v15
    s_cbranch_vccz L_mega_kernel_xok_78
    s_mov_b32 s31, 1048576
L_mega_kernel_xretry_79:
    ds_read_b32 v15, v9
    s_waitcnt lgkmcnt(0)
    v_cmp_gt_u32 vcc, s71, v15
    s_sub_u32 s31, s31, 1
    s_cbranch_scc1 L_mega_kernel_xok_78
    s_cbranch_vccnz L_mega_kernel_xretry_79
L_mega_kernel_xok_78:
    s_waitcnt vmcnt(2)
    v_add_u32 v11, 1, v11
    ds_write_b32 v10, v11
    v_mfma_f32_32x32x16_bf16 v[16:31], v[56:59], a[52:55], v[16:31]
    ds_read_b64_tr_b16 v[48:49], v4 offset:16384
    ds_read_b64_tr_b16 v[50:51], v4 offset:16896
    s_add_u32 m0, s63, 0
    s_mov_b32 s64, 1966080
    buffer_load_dwordx4 v3, s[48:51], s64 offen lds
    v_mfma_f32_32x32x16_bf16 v[32:47], v[60:63], a[52:55], v[32:47]
    ds_read_b64_tr_b16 v[52:53], v5 offset:16384
    ds_read_b64_tr_b16 v[54:55], v5 offset:16896
    s_add_u32 m0, s63, 1024
    s_mov_b32 s64, 1982464
    buffer_load_dwordx4 v3, s[48:51], s64 offen lds
    v_mfma_f32_32x32x16_bf16 v[16:31], v[64:67], a[56:59], v[16:31]
    ds_read_b64_tr_b16 v[56:57], v4 offset:18432
    ds_read_b64_tr_b16 v[58:59], v4 offset:18944
    s_waitcnt lgkmcnt(11)
    v_mfma_f32_32x32x16_bf16 v[32:47], v[68:71], a[56:59], v[32:47]
    ds_read_b64_tr_b16 v[60:61], v5 offset:18432
    ds_read_b64_tr_b16 v[62:63], v5 offset:18944
    s_waitcnt lgkmcnt(11)
    v_mfma_f32_32x32x16_bf16 v[16:31], v[72:75], a[60:63], v[16:31]
    ds_read_b64_tr_b16 v[64:65], v4 offset:20480
    ds_read_b64_tr_b16 v[66:67], v4 offset:20992
    ds_read_b32 v15, v9
    s_waitcnt lgkmcnt(12)
    v_mfma_f32_32x32x16_bf16 v[32:47], v[76:79], a[60:63], v[32:47]
    ds_read_b64_tr_b16 v[68:69], v5 offset:20480
    ds_read_b64_tr_b16 v[70:71], v5 offset:20992
    s_waitcnt lgkmcnt(11)
    v_mfma_f32_32x32x16_bf16 v[16:31], v[48:51], a[64:67], v[16:31]
    ds_read_b64_tr_b16 v[72:73], v4 offset:22528
    ds_read_b64_tr_b16 v[74:75], v4 offset:23040
    s_waitcnt lgkmcnt(11)
    v_mfma_f32_32x32x16_bf16 v[32:47], v[52:55], a[64:67], v[32:47]
    ds_read_b64_tr_b16 v[76:77], v5 offset:22528
    ds_read_b64_tr_b16 v[78:79], v5 offset:23040
    s_add_u32 s71, s71, 1
    s_waitcnt lgkmcnt(6)
    v_cmp_gt_u32 vcc, s71, v15
    s_cbranch_vccz L_mega_kernel_xok_80
    s_mov_b32 s31, 1048576
L_mega_kernel_xretry_81:
    ds_read_b32 v15, v9
    s_waitcnt lgkmcnt(0)
    v_cmp_gt_u32 vcc, s71, v15
    s_sub_u32 s31, s31, 1
    s_cbranch_scc1 L_mega_kernel_xok_80
    s_cbranch_vccnz L_mega_kernel_xretry_81
L_mega_kernel_xok_80:
    s_waitcnt vmcnt(2)
    v_add_u32 v11, 1, v11
    ds_write_b32 v10, v11
    v_mfma_f32_32x32x16_bf16 v[16:31], v[56:59], a[68:71], v[16:31]
    ds_read_b64_tr_b16 v[48:49], v4 offset:24576
    ds_read_b64_tr_b16 v[50:51], v4 offset:25088
    v_mfma_f32_32x32x16_bf16 v[32:47], v[60:63], a[68:71], v[32:47]
    ds_read_b64_tr_b16 v[52:53], v5 offset:24576
    ds_read_b64_tr_b16 v[54:55], v5 offset:25088
    v_mfma_f32_32x32x16_bf16 v[16:31], v[64:67], a[72:75], v[16:31]
    ds_read_b64_tr_b16 v[56:57], v4 offset:26624
    ds_read_b64_tr_b16 v[58:59], v4 offset:27136
    s_waitcnt lgkmcnt(11)
    v_mfma_f32_32x32x16_bf16 v[32:47], v[68:71], a[72:75], v[32:47]
    ds_read_b64_tr_b16 v[60:61], v5 offset:26624
    ds_read_b64_tr_b16 v[62:63], v5 offset:27136
    s_waitcnt lgkmcnt(11)
    v_mfma_f32_32x32x16_bf16 v[16:31], v[72:75], a[76:79], v[16:31]
    ds_read_b64_tr_b16 v[64:65], v4 offset:28672
    ds_read_b64_tr_b16 v[66:67], v4 offset:29184
    ds_read_b32 v15, v9
    s_waitcnt lgkmcnt(12)
    v_mfma_f32_32x32x16_bf16 v[32:47], v[76:79], a[76:79], v[32:47]
    ds_read_b64_tr_b16 v[68:69], v5 offset:28672
    ds_read_b64_tr_b16 v[70:71], v5 offset:29184
    s_waitcnt lgkmcnt(11)
    v_mfma_f32_32x32x16_bf16 v[16:31], v[48:51], a[80:83], v[16:31]
    ds_read_b64_tr_b16 v[72:73], v4 offset:30720
    ds_read_b64_tr_b16 v[74:75], v4 offset:31232
    s_waitcnt lgkmcnt(11)
    v_mfma_f32_32x32x16_bf16 v[32:47], v[52:55], a[80:83], v[32:47]
    ds_read_b64_tr_b16 v[76:77], v5 offset:30720
    ds_read_b64_tr_b16 v[78:79], v5 offset:31232
    s_add_u32 s71, s71, 1
    s_waitcnt lgkmcnt(6)
    v_cmp_gt_u32 vcc, s71, v15
    s_cbranch_vccz L_mega_kernel_xok_82
    s_mov_b32 s31, 1048576
L_mega_kernel_xretry_83:
    ds_read_b32 v15, v9
    s_waitcnt lgkmcnt(0)
    v_cmp_gt_u32 vcc, s71, v15
    s_sub_u32 s31, s31, 1
    s_cbranch_scc1 L_mega_kernel_xok_82
    s_cbranch_vccnz L_mega_kernel_xretry_83
L_mega_kernel_xok_82:
    s_waitcnt vmcnt(0)
    v_add_u32 v11, 1, v11
    ds_write_b32 v10, v11
    v_mfma_f32_32x32x16_bf16 v[16:31], v[56:59], a[84:87], v[16:31]
    ds_read_b64_tr_b16 v[48:49], v4 offset:32768
    ds_read_b64_tr_b16 v[50:51], v4 offset:33280
    v_mfma_f32_32x32x16_bf16 v[32:47], v[60:63], a[84:87], v[32:47]
    ds_read_b64_tr_b16 v[52:53], v5 offset:32768
    ds_read_b64_tr_b16 v[54:55], v5 offset:33280
    v_mfma_f32_32x32x16_bf16 v[16:31], v[64:67], a[88:91], v[16:31]
    ds_read_b64_tr_b16 v[56:57], v4 offset:34816
    ds_read_b64_tr_b16 v[58:59], v4 offset:35328
    s_waitcnt lgkmcnt(11)
    v_mfma_f32_32x32x16_bf16 v[32:47], v[68:71], a[88:91], v[32:47]
    ds_read_b64_tr_b16 v[60:61], v5 offset:34816
    ds_read_b64_tr_b16 v[62:63], v5 offset:35328
    s_waitcnt lgkmcnt(11)
    v_mfma_f32_32x32x16_bf16 v[16:31], v[72:75], a[92:95], v[16:31]
    ds_read_b64_tr_b16 v[64:65], v4 offset:36864
    ds_read_b64_tr_b16 v[66:67], v4 offset:37376
    ds_read_b32 v15, v9
    s_waitcnt lgkmcnt(12)
    v_mfma_f32_32x32x16_bf16 v[32:47], v[76:79], a[92:95], v[32:47]
    ds_read_b64_tr_b16 v[68:69], v5 offset:36864
    ds_read_b64_tr_b16 v[70:71], v5 offset:37376
    s_waitcnt lgkmcnt(11)
    v_mfma_f32_32x32x16_bf16 v[16:31], v[48:51], a[96:99], v[16:31]
    ds_read_b64_tr_b16 v[72:73], v4 offset:38912
    ds_read_b64_tr_b16 v[74:75], v4 offset:39424
    s_waitcnt lgkmcnt(11)
    v_mfma_f32_32x32x16_bf16 v[32:47], v[52:55], a[96:99], v[32:47]
    ds_read_b64_tr_b16 v[76:77], v5 offset:38912
    ds_read_b64_tr_b16 v[78:79], v5 offset:39424
    s_add_u32 s71, s71, 1
    s_waitcnt lgkmcnt(6)
    v_cmp_gt_u32 vcc, s71, v15
    s_cbranch_vccz L_mega_kernel_xok_84
    s_mov_b32 s31, 1048576
L_mega_kernel_xretry_85:
    ds_read_b32 v15, v9
    s_waitcnt lgkmcnt(0)
    v_cmp_gt_u32 vcc, s71, v15
    s_sub_u32 s31, s31, 1
    s_cbranch_scc1 L_mega_kernel_xok_84
    s_cbranch_vccnz L_mega_kernel_xretry_85
L_mega_kernel_xok_84:
    v_mfma_f32_32x32x16_bf16 v[16:31], v[56:59], a[100:103], v[16:31]
    ds_read_b64_tr_b16 v[48:49], v4 offset:0
    ds_read_b64_tr_b16 v[50:51], v4 offset:512
    v_mfma_f32_32x32x16_bf16 v[32:47], v[60:63], a[100:103], v[32:47]
    ds_read_b64_tr_b16 v[52:53], v5 offset:0
    ds_read_b64_tr_b16 v[54:55], v5 offset:512
    v_mfma_f32_32x32x16_bf16 v[16:31], v[64:67], a[104:107], v[16:31]
    ds_read_b64_tr_b16 v[56:57], v4 offset:2048
    ds_read_b64_tr_b16 v[58:59], v4 offset:2560
    s_waitcnt lgkmcnt(10)
    v_mfma_f32_32x32x16_bf16 v[32:47], v[68:71], a[104:107], v[32:47]
    ds_read_b64_tr_b16 v[60:61], v5 offset:2048
    ds_read_b64_tr_b16 v[62:63], v5 offset:2560
    s_waitcnt lgkmcnt(10)
    v_mfma_f32_32x32x16_bf16 v[16:31], v[72:75], a[108:111], v[16:31]
    ds_read_b64_tr_b16 v[64:65], v4 offset:4096
    ds_read_b64_tr_b16 v[66:67], v4 offset:4608
    s_waitcnt lgkmcnt(10)
    v_mfma_f32_32x32x16_bf16 v[32:47], v[76:79], a[108:111], v[32:47]
    ds_read_b64_tr_b16 v[68:69], v5 offset:4096
    ds_read_b64_tr_b16 v[70:71], v5 offset:4608
    s_waitcnt lgkmcnt(10)
    v_mfma_f32_32x32x16_bf16 v[16:31], v[48:51], a[112:115], v[16:31]
    ds_read_b64_tr_b16 v[72:73], v4 offset:6144
    ds_read_b64_tr_b16 v[74:75], v4 offset:6656
    s_waitcnt lgkmcnt(10)
    v_mfma_f32_32x32x16_bf16 v[32:47], v[52:55], a[112:115], v[32:47]
    ds_read_b64_tr_b16 v[76:77], v5 offset:6144
    ds_read_b64_tr_b16 v[78:79], v5 offset:6656
    s_waitcnt lgkmcnt(10)
    v_mfma_f32_32x32x16_bf16 v[16:31], v[56:59], a[116:119], v[16:31]
    s_waitcnt lgkmcnt(8)
    v_mfma_f32_32x32x16_bf16 v[32:47], v[60:63], a[116:119], v[32:47]
    s_waitcnt lgkmcnt(6)
    v_mfma_f32_32x32x16_bf16 v[16:31], v[64:67], a[120:123], v[16:31]
    s_waitcnt lgkmcnt(4)
    v_mfma_f32_32x32x16_bf16 v[32:47], v[68:71], a[120:123], v[32:47]
    s_waitcnt lgkmcnt(2)
    v_mfma_f32_32x32x16_bf16 v[16:31], v[72:75], a[124:127], v[16:31]
    s_waitcnt lgkmcnt(0)
    v_mfma_f32_32x32x16_bf16 v[32:47], v[76:79], a[124:127], v[32:47]
    v_and_b32 v13, 31, v1
    v_mul_u32_u24 v12, 272, v13
    v_lshrrev_b32 v13, 5, v1
    v_lshl_add_u32 v12, v13, 6, v12
    s_mul_i32 s34, s28, 8704
    s_add_u32 s34, s34, 40960
    v_add_u32 v12, s34, v12
    s_mov_b32 s63, 0xffff0000
    s_waitcnt lgkmcnt(0)
    s_barrier
    ds_read_b128 v[48:51], v12 offset:0
    ds_read_b128 v[52:55], v12 offset:16
    ds_read_b128 v[56:59], v12 offset:32
    ds_read_b128 v[60:63], v12 offset:48
    ds_read_b128 v[64:67], v12 offset:128
    ds_read_b128 v[68:71], v12 offset:144
    ds_read_b128 v[72:75], v12 offset:160
    ds_read_b128 v[76:79], v12 offset:176
    s_waitcnt vmcnt(0)
    v_lshlrev_b32 v8, 16, v80
    v_and_b32 v9, s63, v80
    v_add_f32 v16, v16, v8
    v_add_f32 v17, v17, v9
    v_lshlrev_b32 v8, 16, v81
    v_and_b32 v9, s63, v81
    v_add_f32 v18, v18, v8
    v_add_f32 v19, v19, v9
    v_lshlrev_b32 v8, 16, v82
    v_and_b32 v9, s63, v82
    v_add_f32 v20, v20, v8
    v_add_f32 v21, v21, v9
    v_lshlrev_b32 v8, 16, v83
    v_and_b32 v9, s63, v83
    v_add_f32 v22, v22, v8
    v_add_f32 v23, v23, v9
    v_lshlrev_b32 v8, 16, v84
    v_and_b32 v9, s63, v84
    v_add_f32 v24, v24, v8
    v_add_f32 v25, v25, v9
    v_lshlrev_b32 v8, 16, v85
    v_and_b32 v9, s63, v85
    v_add_f32 v26, v26, v8
    v_add_f32 v27, v27, v9
    v_lshlrev_b32 v8, 16, v86
    v_and_b32 v9, s63, v86
    v_add_f32 v28, v28, v8
    v_add_f32 v29, v29, v9
    v_lshlrev_b32 v8, 16, v87
    v_and_b32 v9, s63, v87
    v_add_f32 v30, v30, v8
    v_add_f32 v31, v31, v9
    v_lshlrev_b32 v8, 16, v88
    v_and_b32 v9, s63, v88
    v_add_f32 v32, v32, v8
    v_add_f32 v33, v33, v9
    v_lshlrev_b32 v8, 16, v89
    v_and_b32 v9, s63, v89
    v_add_f32 v34, v34, v8
    v_add_f32 v35, v35, v9
    v_lshlrev_b32 v8, 16, v90
    v_and_b32 v9, s63, v90
    v_add_f32 v36, v36, v8
    v_add_f32 v37, v37, v9
    v_lshlrev_b32 v8, 16, v91
    v_and_b32 v9, s63, v91
    v_add_f32 v38, v38, v8
    v_add_f32 v39, v39, v9
    v_lshlrev_b32 v8, 16, v92
    v_and_b32 v9, s63, v92
    v_add_f32 v40, v40, v8
    v_add_f32 v41, v41, v9
    v_lshlrev_b32 v8, 16, v93
    v_and_b32 v9, s63, v93
    v_add_f32 v42, v42, v8
    v_add_f32 v43, v43, v9
    v_lshlrev_b32 v8, 16, v94
    v_and_b32 v9, s63, v94
    v_add_f32 v44, v44, v8
    v_add_f32 v45, v45, v9
    v_lshlrev_b32 v8, 16, v95
    v_and_b32 v9, s63, v95
    v_add_f32 v46, v46, v8
    v_add_f32 v47, v47, v9
    s_waitcnt lgkmcnt(0)
    v_add_f32 v16, v16, v48
    v_add_f32 v17, v17, v49
    v_cvt_pk_bf16_f32 v80, v16, v17
    v_add_f32 v18, v18, v50
    v_add_f32 v19, v19, v51
    v_cvt_pk_bf16_f32 v81, v18, v19
    v_add_f32 v20, v20, v52
    v_add_f32 v21, v21, v53
    v_cvt_pk_bf16_f32 v82, v20, v21
    v_add_f32 v22, v22, v54
    v_add_f32 v23, v23, v55
    v_cvt_pk_bf16_f32 v83, v22, v23
    buffer_store_dwordx4 v[80:83], v7, s[44:47], 0 offen offset:0
    v_add_f32 v24, v24, v56
    v_add_f32 v25, v25, v57
    v_cvt_pk_bf16_f32 v84, v24, v25
    v_add_f32 v26, v26, v58
    v_add_f32 v27, v27, v59
    v_cvt_pk_bf16_f32 v85, v26, v27
    v_add_f32 v28, v28, v60
    v_add_f32 v29, v29, v61
    v_cvt_pk_bf16_f32 v86, v28, v29
    v_add_f32 v30, v30, v62
    v_add_f32 v31, v31, v63
    v_cvt_pk_bf16_f32 v87, v30, v31
    buffer_store_dwordx4 v[84:87], v7, s[44:47], 0 offen offset:16
    v_add_f32 v32, v32, v64
    v_add_f32 v33, v33, v65
    v_cvt_pk_bf16_f32 v88, v32, v33
    v_add_f32 v34, v34, v66
    v_add_f32 v35, v35, v67
    v_cvt_pk_bf16_f32 v89, v34, v35
    v_add_f32 v36, v36, v68
    v_add_f32 v37, v37, v69
    v_cvt_pk_bf16_f32 v90, v36, v37
    v_add_f32 v38, v38, v70
    v_add_f32 v39, v39, v71
    v_cvt_pk_bf16_f32 v91, v38, v39
    buffer_store_dwordx4 v[88:91], v7, s[44:47], 0 offen offset:64
    v_add_f32 v40, v40, v72
    v_add_f32 v41, v41, v73
    v_cvt_pk_bf16_f32 v92, v40, v41
    v_add_f32 v42, v42, v74
    v_add_f32 v43, v43, v75
    v_cvt_pk_bf16_f32 v93, v42, v43
    v_add_f32 v44, v44, v76
    v_add_f32 v45, v45, v77
    v_cvt_pk_bf16_f32 v94, v44, v45
    v_add_f32 v46, v46, v78
    v_add_f32 v47, v47, v79
    v_cvt_pk_bf16_f32 v95, v46, v47
    buffer_store_dwordx4 v[92:95], v7, s[44:47], 0 offen offset:80
    s_endpgm
L_g1_HP:
    ds_read_b128 a[0:3], v9 offset:0
    ds_read_b128 a[4:7], v9 offset:1024
    ds_read_b128 a[8:11], v9 offset:2048
    ds_read_b128 a[12:15], v9 offset:3072
    s_add_u32 s80, s80, 1
    s_cmp_ge_u32 s80, 3
    s_cselect_b32 s81, 4294934528, s83
    s_cselect_b32 s80, 0, s80
    v_add_u32 v9, s81, v9
    ds_read_b64_tr_b16 a[48:49], v8 offset:6656
    ds_read_b64_tr_b16 a[50:51], v8 offset:8448
    ds_read_b64_tr_b16 a[52:53], v8 offset:6912
    ds_read_b64_tr_b16 a[54:55], v8 offset:8704
    ds_read_b64_tr_b16 a[56:57], v8 offset:7168
    ds_read_b64_tr_b16 a[58:59], v8 offset:8960
    s_waitcnt lgkmcnt(0)
    s_mov_b32 s78, 7
L_g1_loopHP:
    s_waitcnt lgkmcnt(4)
    v_mfma_f32_16x16x32_bf16 v[32:35], a[48:51], a[0:3], v[32:35]
    ds_read_b64_tr_b16 a[60:61], v8 offset:7424
    v_mfma_f32_16x16x32_bf16 v[36:39], a[48:51], a[4:7], v[36:39]
    ds_read_b64_tr_b16 a[62:63], v8 offset:9216
    v_mfma_f32_16x16x32_bf16 v[40:43], a[48:51], a[8:11], v[40:43]
    s_add_u32 s75, s75, 20480
    v_mfma_f32_16x16x32_bf16 v[44:47], a[48:51], a[12:15], v[44:47]
    s_cmp_ge_u32 s75, 102400
    s_cselect_b32 s76, 4294885376, s82
    s_cselect_b32 s75, 0, s75
    s_waitcnt lgkmcnt(4)
    v_mfma_f32_16x16x32_bf16 v[48:51], a[52:55], a[0:3], v[48:51]
    ds_read_b64_tr_b16 a[48:49], v8 offset:7680
    v_mfma_f32_16x16x32_bf16 v[52:55], a[52:55], a[4:7], v[52:55]
    ds_read_b64_tr_b16 a[50:51], v8 offset:9472
    v_mfma_f32_16x16x32_bf16 v[56:59], a[52:55], a[8:11], v[56:59]
    buffer_load_dword v10, v3, s[48:51], s64 offen
    v_mfma_f32_16x16x32_bf16 v[60:63], a[52:55], a[12:15], v[60:63]
    s_add_u32 s64, s64, s68
    s_waitcnt lgkmcnt(4)
    v_mfma_f32_16x16x32_bf16 v[64:67], a[56:59], a[0:3], v[64:67]
    ds_read_b64_tr_b16 a[52:53], v8 offset:13824
    v_mfma_f32_16x16x32_bf16 v[68:71], a[56:59], a[4:7], v[68:71]
    ds_read_b64_tr_b16 a[54:55], v8 offset:15616
    v_mfma_f32_16x16x32_bf16 v[72:75], a[56:59], a[8:11], v[72:75]
    v_mfma_f32_16x16x32_bf16 v[76:79], a[56:59], a[12:15], v[76:79]
    s_waitcnt lgkmcnt(4)
    v_mfma_f32_16x16x32_bf16 v[80:83], a[60:63], a[0:3], v[80:83]
    ds_read_b64_tr_b16 a[56:57], v8 offset:14080
    v_mfma_f32_16x16x32_bf16 v[84:87], a[60:63], a[4:7], v[84:87]
    ds_read_b64_tr_b16 a[58:59], v8 offset:15872
    v_mfma_f32_16x16x32_bf16 v[88:91], a[60:63], a[8:11], v[88:91]
    v_mfma_f32_16x16x32_bf16 v[92:95], a[60:63], a[12:15], v[92:95]
    s_waitcnt lgkmcnt(4)
    v_mfma_f32_16x16x32_bf16 v[96:99], a[48:51], a[0:3], v[96:99]
    ds_read_b64_tr_b16 a[60:61], v8 offset:14336
    v_mfma_f32_16x16x32_bf16 v[100:103], a[48:51], a[4:7], v[100:103]
    ds_read_b64_tr_b16 a[62:63], v8 offset:16128
    v_mfma_f32_16x16x32_bf16 v[104:107], a[48:51], a[8:11], v[104:107]
    v_mfma_f32_16x16x32_bf16 v[108:111], a[48:51], a[12:15], v[108:111]
    s_waitcnt lgkmcnt(4)
    v_mfma_f32_16x16x32_bf16 a[64:67], a[52:55], a[0:3], a[64:67]
    ds_read_b64_tr_b16 a[48:49], v8 offset:14592
    v_mfma_f32_16x16x32_bf16 a[68:71], a[52:55], a[4:7], a[68:71]
    ds_read_b64_tr_b16 a[50:51], v8 offset:16384
    v_mfma_f32_16x16x32_bf16 a[72:75], a[52:55], a[8:11], a[72:75]
    v_mfma_f32_16x16x32_bf16 a[76:79], a[52:55], a[12:15], a[76:79]
    s_waitcnt lgkmcnt(4)
    v_mfma_f32_16x16x32_bf16 a[80:83], a[56:59], a[0:3], a[80:83]
    ds_read_b64_tr_b16 a[52:53], v8 offset:14848
    v_mfma_f32_16x16x32_bf16 a[84:87], a[56:59], a[4:7], a[84:87]
    ds_read_b64_tr_b16 a[54:55], v8 offset:16640
    v_mfma_f32_16x16x32_bf16 a[88:91], a[56:59], a[8:11], a[88:91]
    v_add_u32 v8, s76, v8
    v_mfma_f32_16x16x32_bf16 a[92:95], a[56:59], a[12:15], a[92:95]
    s_waitcnt lgkmcnt(4)
    v_mfma_f32_16x16x32_bf16 a[96:99], a[60:63], a[0:3], a[96:99]
    s_barrier
    ds_read_b64_tr_b16 a[56:57], v8 offset:6656
    ds_read_b128 a[16:19], v9 offset:0
    v_mfma_f32_16x16x32_bf16 a[100:103], a[60:63], a[4:7], a[100:103]
    ds_read_b64_tr_b16 a[58:59], v8 offset:8448
    ds_read_b128 a[20:23], v9 offset:1024
    v_mfma_f32_16x16x32_bf16 a[104:107], a[60:63], a[8:11], a[104:107]
    ds_read_b128 a[24:27], v9 offset:2048
    ds_read_b128 a[28:31], v9 offset:3072
    v_mfma_f32_16x16x32_bf16 a[108:111], a[60:63], a[12:15], a[108:111]
    s_cmp_lg_u32 s78, 7
    s_cbranch_scc1 L_mega_kernel_fsw_86
    ds_write_b128 v28, a[32:35] offset:0
    ds_write_b128 v28, a[36:39] offset:1024
    ds_write_b128 v28, a[40:43] offset:2048
    ds_write_b128 v28, a[44:47] offset:3072
    L_mega_kernel_fsw_86:
    s_add_u32 s80, s80, 1
    s_cmp_ge_u32 s80, 3
    s_cselect_b32 s81, 4294934528, s83
    s_cselect_b32 s80, 0, s80
    s_waitcnt lgkmcnt(8)
    v_mfma_f32_16x16x32_bf16 a[112:115], a[48:51], a[0:3], a[112:115]
    ds_read_b64_tr_b16 a[60:61], v8 offset:6912
    v_add_u32 v9, s81, v9
    v_mfma_f32_16x16x32_bf16 a[116:119], a[48:51], a[4:7], a[116:119]
    ds_read_b64_tr_b16 a[62:63], v8 offset:8704
    v_mfma_f32_16x16x32_bf16 a[120:123], a[48:51], a[8:11], a[120:123]
    v_mfma_f32_16x16x32_bf16 a[124:127], a[48:51], a[12:15], a[124:127]
    s_waitcnt lgkmcnt(8)
    v_mfma_f32_16x16x32_bf16 v[112:115], a[52:55], a[0:3], v[112:115]
    ds_read_b64_tr_b16 a[48:49], v8 offset:7168
    v_mfma_f32_16x16x32_bf16 v[116:119], a[52:55], a[4:7], v[116:119]
    ds_read_b64_tr_b16 a[50:51], v8 offset:8960
    v_mfma_f32_16x16x32_bf16 v[120:123], a[52:55], a[8:11], v[120:123]
    v_mfma_f32_16x16x32_bf16 v[124:127], a[52:55], a[12:15], v[124:127]
    s_waitcnt lgkmcnt(4)
    v_mfma_f32_16x16x32_bf16 v[32:35], a[56:59], a[16:19], v[32:35]
    ds_read_b64_tr_b16 a[52:53], v8 offset:7424
    v_mfma_f32_16x16x32_bf16 v[36:39], a[56:59], a[20:23], v[36:39]
    ds_read_b64_tr_b16 a[54:55], v8 offset:9216
    v_mfma_f32_16x16x32_bf16 v[40:43], a[56:59], a[24:27], v[40:43]
    s_add_u32 s75, s75, 20480
    v_mfma_f32_16x16x32_bf16 v[44:47], a[56:59], a[28:31], v[44:47]
    s_cmp_ge_u32 s75, 102400
    s_cselect_b32 s76, 4294885376, s82
    s_cselect_b32 s75, 0, s75
    s_waitcnt lgkmcnt(4)
    v_mfma_f32_16x16x32_bf16 v[48:51], a[60:63], a[16:19], v[48:51]
    ds_read_b64_tr_b16 a[56:57], v8 offset:7680
    v_mfma_f32_16x16x32_bf16 v[52:55], a[60:63], a[20:23], v[52:55]
    ds_read_b64_tr_b16 a[58:59], v8 offset:9472
    v_mfma_f32_16x16x32_bf16 v[56:59], a[60:63], a[24:27], v[56:59]
    v_mfma_f32_16x16x32_bf16 v[60:63], a[60:63], a[28:31], v[60:63]
    s_waitcnt lgkmcnt(4)
    v_mfma_f32_16x16x32_bf16 v[64:67], a[48:51], a[16:19], v[64:67]
    ds_read_b64_tr_b16 a[60:61], v8 offset:13824
    v_mfma_f32_16x16x32_bf16 v[68:71], a[48:51], a[20:23], v[68:71]
    ds_read_b64_tr_b16 a[62:63], v8 offset:15616
    v_mfma_f32_16x16x32_bf16 v[72:75], a[48:51], a[24:27], v[72:75]
    v_mfma_f32_16x16x32_bf16 v[76:79], a[48:51], a[28:31], v[76:79]
    s_waitcnt lgkmcnt(4)
    v_mfma_f32_16x16x32_bf16 v[80:83], a[52:55], a[16:19], v[80:83]
    ds_read_b64_tr_b16 a[48:49], v8 offset:14080
    v_mfma_f32_16x16x32_bf16 v[84:87], a[52:55], a[20:23], v[84:87]
    ds_read_b64_tr_b16 a[50:51], v8 offset:15872
    v_mfma_f32_16x16x32_bf16 v[88:91], a[52:55], a[24:27], v[88:91]
    v_mfma_f32_16x16x32_bf16 v[92:95], a[52:55], a[28:31], v[92:95]
    s_waitcnt lgkmcnt(4)
    v_mfma_f32_16x16x32_bf16 v[96:99], a[56:59], a[16:19], v[96:99]
    ds_read_b64_tr_b16 a[52:53], v8 offset:14336
    v_mfma_f32_16x16x32_bf16 v[100:103], a[56:59], a[20:23], v[100:103]
    ds_read_b64_tr_b16 a[54:55], v8 offset:16128
    v_mfma_f32_16x16x32_bf16 v[104:107], a[56:59], a[24:27], v[104:107]
    v_mfma_f32_16x16x32_bf16 v[108:111], a[56:59], a[28:31], v[108:111]
    s_waitcnt lgkmcnt(4)
    v_mfma_f32_16x16x32_bf16 a[64:67], a[60:63], a[16:19], a[64:67]
    ds_read_b64_tr_b16 a[56:57], v8 offset:14592
    v_mfma_f32_16x16x32_bf16 a[68:71], a[60:63], a[20:23], a[68:71]
    ds_read_b64_tr_b16 a[58:59], v8 offset:16384
    v_mfma_f32_16x16x32_bf16 a[72:75], a[60:63], a[24:27], a[72:75]
    v_mfma_f32_16x16x32_bf16 a[76:79], a[60:63], a[28:31], a[76:79]
    s_waitcnt lgkmcnt(4)
    v_mfma_f32_16x16x32_bf16 a[80:83], a[48:51], a[16:19], a[80:83]
    ds_read_b64_tr_b16 a[60:61], v8 offset:14848
    v_mfma_f32_16x16x32_bf16 a[84:87], a[48:51], a[20:23], a[84:87]
    ds_read_b64_tr_b16 a[62:63], v8 offset:16640
    v_mfma_f32_16x16x32_bf16 a[88:91], a[48:51], a[24:27], a[88:91]
    v_add_u32 v8, s76, v8
    v_mfma_f32_16x16x32_bf16 a[92:95], a[48:51], a[28:31], a[92:95]
    s_waitcnt lgkmcnt(4)
    v_mfma_f32_16x16x32_bf16 a[96:99], a[52:55], a[16:19], a[96:99]
    s_barrier
    ds_read_b64_tr_b16 a[48:49], v8 offset:6656
    ds_read_b128 a[0:3], v9 offset:0
    v_mfma_f32_16x16x32_bf16 a[100:103], a[52:55], a[20:23], a[100:103]
    ds_read_b64_tr_b16 a[50:51], v8 offset:8448
    ds_read_b128 a[4:7], v9 offset:1024
    v_mfma_f32_16x16x32_bf16 a[104:107], a[52:55], a[24:27], a[104:107]
    ds_read_b128 a[8:11], v9 offset:2048
    ds_read_b128 a[12:15], v9 offset:3072
    v_mfma_f32_16x16x32_bf16 a[108:111], a[52:55], a[28:31], a[108:111]
    s_add_u32 s80, s80, 1
    s_cmp_ge_u32 s80, 3
    s_cselect_b32 s81, 4294934528, s83
    s_cselect_b32 s80, 0, s80
    v_add_u32 v9, s81, v9
    s_waitcnt lgkmcnt(8)
    v_mfma_f32_16x16x32_bf16 a[112:115], a[56:59], a[16:19], a[112:115]
    ds_read_b64_tr_b16 a[52:53], v8 offset:6912
    v_mfma_f32_16x16x32_bf16 a[116:119], a[56:59], a[20:23], a[116:119]
    ds_read_b64_tr_b16 a[54:55], v8 offset:8704
    v_mfma_f32_16x16x32_bf16 a[120:123], a[56:59], a[24:27], a[120:123]
    v_mfma_f32_16x16x32_bf16 a[124:127], a[56:59], a[28:31], a[124:127]
    s_waitcnt lgkmcnt(8)
    v_mfma_f32_16x16x32_bf16 v[112:115], a[60:63], a[16:19], v[112:115]
    ds_read_b64_tr_b16 a[56:57], v8 offset:7168
    v_mfma_f32_16x16x32_bf16 v[116:119], a[60:63], a[20:23], v[116:119]
    ds_read_b64_tr_b16 a[58:59], v8 offset:8960
    v_mfma_f32_16x16x32_bf16 v[120:123], a[60:63], a[24:27], v[120:123]
    v_mfma_f32_16x16x32_bf16 v[124:127], a[60:63], a[28:31], v[124:127]
    s_waitcnt lgkmcnt(4)
    v_mfma_f32_16x16x32_bf16 v[32:35], a[48:51], a[0:3], v[32:35]
    ds_read_b64_tr_b16 a[60:61], v8 offset:7424
    v_mfma_f32_16x16x32_bf16 v[36:39], a[48:51], a[4:7], v[36:39]
    ds_read_b64_tr_b16 a[62:63], v8 offset:9216
    v_mfma_f32_16x16x32_bf16 v[40:43], a[48:51], a[8:11], v[40:43]
    s_add_u32 s75, s75, 20480
    v_mfma_f32_16x16x32_bf16 v[44:47], a[48:51], a[12:15], v[44:47]
    s_cmp_ge_u32 s75, 102400
    s_cselect_b32 s76, 4294885376, s82
    s_cselect_b32 s75, 0, s75
    s_waitcnt lgkmcnt(4)
    v_mfma_f32_16x16x32_bf16 v[48:51], a[52:55], a[0:3], v[48:51]
    ds_read_b64_tr_b16 a[48:49], v8 offset:7680
    v_mfma_f32_16x16x32_bf16 v[52:55], a[52:55], a[4:7], v[52:55]
    ds_read_b64_tr_b16 a[50:51], v8 offset:9472
    v_mfma_f32_16x16x32_bf16 v[56:59], a[52:55], a[8:11], v[56:59]
    buffer_load_dword v10, v4, s[52:55], s65 offen
    v_mfma_f32_16x16x32_bf16 v[60:63], a[52:55], a[12:15], v[60:63]
    s_add_u32 s65, s65, s69
    s_waitcnt lgkmcnt(4)
    v_mfma_f32_16x16x32_bf16 v[64:67], a[56:59], a[0:3], v[64:67]
    ds_read_b64_tr_b16 a[52:53], v8 offset:13824
    v_mfma_f32_16x16x32_bf16 v[68:71], a[56:59], a[4:7], v[68:71]
    ds_read_b64_tr_b16 a[54:55], v8 offset:15616
    v_mfma_f32_16x16x32_bf16 v[72:75], a[56:59], a[8:11], v[72:75]
    v_mfma_f32_16x16x32_bf16 v[76:79], a[56:59], a[12:15], v[76:79]
    s_waitcnt lgkmcnt(4)
    v_mfma_f32_16x16x32_bf16 v[80:83], a[60:63], a[0:3], v[80:83]
    ds_read_b64_tr_b16 a[56:57], v8 offset:14080
    v_mfma_f32_16x16x32_bf16 v[84:87], a[60:63], a[4:7], v[84:87]
    ds_read_b64_tr_b16 a[58:59], v8 offset:15872
    v_mfma_f32_16x16x32_bf16 v[88:91], a[60:63], a[8:11], v[88:91]
    v_mfma_f32_16x16x32_bf16 v[92:95], a[60:63], a[12:15], v[92:95]
    s_waitcnt lgkmcnt(4)
    v_mfma_f32_16x16x32_bf16 v[96:99], a[48:51], a[0:3], v[96:99]
    ds_read_b64_tr_b16 a[60:61], v8 offset:14336
    v_mfma_f32_16x16x32_bf16 v[100:103], a[48:51], a[4:7], v[100:103]
    ds_read_b64_tr_b16 a[62:63], v8 offset:16128
    v_mfma_f32_16x16x32_bf16 v[104:107], a[48:51], a[8:11], v[104:107]
    v_mfma_f32_16x16x32_bf16 v[108:111], a[48:51], a[12:15], v[108:111]
    s_waitcnt lgkmcnt(4)
    v_mfma_f32_16x16x32_bf16 a[64:67], a[52:55], a[0:3], a[64:67]
    ds_read_b64_tr_b16 a[48:49], v8 offset:14592
    v_mfma_f32_16x16x32_bf16 a[68:71], a[52:55], a[4:7], a[68:71]
    ds_read_b64_tr_b16 a[50:51], v8 offset:16384
    v_mfma_f32_16x16x32_bf16 a[72:75], a[52:55], a[8:11], a[72:75]
    v_mfma_f32_16x16x32_bf16 a[76:79], a[52:55], a[12:15], a[76:79]
    s_waitcnt lgkmcnt(4)
    v_mfma_f32_16x16x32_bf16 a[80:83], a[56:59], a[0:3], a[80:83]
    ds_read_b64_tr_b16 a[52:53], v8 offset:14848
    v_mfma_f32_16x16x32_bf16 a[84:87], a[56:59], a[4:7], a[84:87]
    ds_read_b64_tr_b16 a[54:55], v8 offset:16640
    v_mfma_f32_16x16x32_bf16 a[88:91], a[56:59], a[8:11], a[88:91]
    v_add_u32 v8, s76, v8
    v_mfma_f32_16x16x32_bf16 a[92:95], a[56:59], a[12:15], a[92:95]
    s_waitcnt lgkmcnt(4)
    v_mfma_f32_16x16x32_bf16 a[96:99], a[60:63], a[0:3], a[96:99]
    s_barrier
    ds_read_b64_tr_b16 a[56:57], v8 offset:6656
    ds_read_b128 a[16:19], v9 offset:0
    v_mfma_f32_16x16x32_bf16 a[100:103], a[60:63], a[4:7], a[100:103]
    ds_read_b64_tr_b16 a[58:59], v8 offset:8448
    ds_read_b128 a[20:23], v9 offset:1024
    v_mfma_f32_16x16x32_bf16 a[104:107], a[60:63], a[8:11], a[104:107]
    ds_read_b128 a[24:27], v9 offset:2048
    ds_read_b128 a[28:31], v9 offset:3072
    v_mfma_f32_16x16x32_bf16 a[108:111], a[60:63], a[12:15], a[108:111]
    s_add_u32 s80, s80, 1
    s_cmp_ge_u32 s80, 3
    s_cselect_b32 s81, 4294934528, s83
    s_cselect_b32 s80, 0, s80
    v_add_u32 v9, s81, v9
    s_waitcnt lgkmcnt(8)
    v_mfma_f32_16x16x32_bf16 a[112:115], a[48:51], a[0:3], a[112:115]
    ds_read_b64_tr_b16 a[60:61], v8 offset:6912
    v_mfma_f32_16x16x32_bf16 a[116:119], a[48:51], a[4:7], a[116:119]
    ds_read_b64_tr_b16 a[62:63], v8 offset:8704
    v_mfma_f32_16x16x32_bf16 a[120:123], a[48:51], a[8:11], a[120:123]
    v_mfma_f32_16x16x32_bf16 a[124:127], a[48:51], a[12:15], a[124:127]
    s_waitcnt lgkmcnt(8)
    v_mfma_f32_16x16x32_bf16 v[112:115], a[52:55], a[0:3], v[112:115]
    ds_read_b64_tr_b16 a[48:49], v8 offset:7168
    v_mfma_f32_16x16x32_bf16 v[116:119], a[52:55], a[4:7], v[116:119]
    ds_read_b64_tr_b16 a[50:51], v8 offset:8960
    v_mfma_f32_16x16x32_bf16 v[120:123], a[52:55], a[8:11], v[120:123]
    v_mfma_f32_16x16x32_bf16 v[124:127], a[52:55], a[12:15], v[124:127]
    s_waitcnt lgkmcnt(4)
    v_mfma_f32_16x16x32_bf16 v[32:35], a[56:59], a[16:19], v[32:35]
    ds_read_b64_tr_b16 a[52:53], v8 offset:7424
    v_mfma_f32_16x16x32_bf16 v[36:39], a[56:59], a[20:23], v[36:39]
    ds_read_b64_tr_b16 a[54:55], v8 offset:9216
    v_mfma_f32_16x16x32_bf16 v[40:43], a[56:59], a[24:27], v[40:43]
    s_add_u32 s75, s75, 20480
    v_mfma_f32_16x16x32_bf16 v[44:47], a[56:59], a[28:31], v[44:47]
    s_cmp_ge_u32 s75, 102400
    s_cselect_b32 s76, 4294885376, s82
    s_cselect_b32 s75, 0, s75
    s_waitcnt lgkmcnt(4)
    v_mfma_f32_16x16x32_bf16 v[48:51], a[60:63], a[16:19], v[48:51]
    ds_read_b64_tr_b16 a[56:57], v8 offset:7680
    v_mfma_f32_16x16x32_bf16 v[52:55], a[60:63], a[20:23], v[52:55]
    ds_read_b64_tr_b16 a[58:59], v8 offset:9472
    v_mfma_f32_16x16x32_bf16 v[56:59], a[60:63], a[24:27], v[56:59]
    v_mfma_f32_16x16x32_bf16 v[60:63], a[60:63], a[28:31], v[60:63]
    s_waitcnt lgkmcnt(4)
    v_mfma_f32_16x16x32_bf16 v[64:67], a[48:51], a[16:19], v[64:67]
    ds_read_b64_tr_b16 a[60:61], v8 offset:13824
    v_mfma_f32_16x16x32_bf16 v[68:71], a[48:51], a[20:23], v[68:71]
    ds_read_b64_tr_b16 a[62:63], v8 offset:15616
    v_mfma_f32_16x16x32_bf16 v[72:75], a[48:51], a[24:27], v[72:75]
    v_mfma_f32_16x16x32_bf16 v[76:79], a[48:51], a[28:31], v[76:79]
    s_waitcnt lgkmcnt(4)
    v_mfma_f32_16x16x32_bf16 v[80:83], a[52:55], a[16:19], v[80:83]
    ds_read_b64_tr_b16 a[48:49], v8 offset:14080
    v_mfma_f32_16x16x32_bf16 v[84:87], a[52:55], a[20:23], v[84:87]
    ds_read_b64_tr_b16 a[50:51], v8 offset:15872
    v_mfma_f32_16x16x32_bf16 v[88:91], a[52:55], a[24:27], v[88:91]
    v_mfma_f32_16x16x32_bf16 v[92:95], a[52:55], a[28:31], v[92:95]
    s_waitcnt lgkmcnt(4)
    v_mfma_f32_16x16x32_bf16 v[96:99], a[56:59], a[16:19], v[96:99]
    ds_read_b64_tr_b16 a[52:53], v8 offset:14336
    v_mfma_f32_16x16x32_bf16 v[100:103], a[56:59], a[20:23], v[100:103]
    ds_read_b64_tr_b16 a[54:55], v8 offset:16128
    v_mfma_f32_16x16x32_bf16 v[104:107], a[56:59], a[24:27], v[104:107]
    v_mfma_f32_16x16x32_bf16 v[108:111], a[56:59], a[28:31], v[108:111]
    s_waitcnt lgkmcnt(4)
    v_mfma_f32_16x16x32_bf16 a[64:67], a[60:63], a[16:19], a[64:67]
    ds_read_b64_tr_b16 a[56:57], v8 offset:14592
    v_mfma_f32_16x16x32_bf16 a[68:71], a[60:63], a[20:23], a[68:71]
    ds_read_b64_tr_b16 a[58:59], v8 offset:16384
    v_mfma_f32_16x16x32_bf16 a[72:75], a[60:63], a[24:27], a[72:75]
    v_mfma_f32_16x16x32_bf16 a[76:79], a[60:63], a[28:31], a[76:79]
    s_waitcnt lgkmcnt(4)
    v_mfma_f32_16x16x32_bf16 a[80:83], a[48:51], a[16:19], a[80:83]
    ds_read_b64_tr_b16 a[60:61], v8 offset:14848
    v_mfma_f32_16x16x32_bf16 a[84:87], a[48:51], a[20:23], a[84:87]
    ds_read_b64_tr_b16 a[62:63], v8 offset:16640
    v_mfma_f32_16x16x32_bf16 a[88:91], a[48:51], a[24:27], a[88:91]
    v_add_u32 v8, s76, v8
    v_mfma_f32_16x16x32_bf16 a[92:95], a[48:51], a[28:31], a[92:95]
    s_waitcnt lgkmcnt(4)
    v_mfma_f32_16x16x32_bf16 a[96:99], a[52:55], a[16:19], a[96:99]
    s_barrier
    ds_read_b64_tr_b16 a[48:49], v8 offset:6656
    ds_read_b128 a[0:3], v9 offset:0
    v_mfma_f32_16x16x32_bf16 a[100:103], a[52:55], a[20:23], a[100:103]
    ds_read_b64_tr_b16 a[50:51], v8 offset:8448
    ds_read_b128 a[4:7], v9 offset:1024
    v_mfma_f32_16x16x32_bf16 a[104:107], a[52:55], a[24:27], a[104:107]
    ds_read_b128 a[8:11], v9 offset:2048
    ds_read_b128 a[12:15], v9 offset:3072
    v_mfma_f32_16x16x32_bf16 a[108:111], a[52:55], a[28:31], a[108:111]
    s_add_u32 s80, s80, 1
    s_cmp_ge_u32 s80, 3
    s_cselect_b32 s81, 4294934528, s83
    s_cselect_b32 s80, 0, s80
    v_add_u32 v9, s81, v9
    s_waitcnt lgkmcnt(8)
    v_mfma_f32_16x16x32_bf16 a[112:115], a[56:59], a[16:19], a[112:115]
    ds_read_b64_tr_b16 a[52:53], v8 offset:6912
    v_mfma_f32_16x16x32_bf16 a[116:119], a[56:59], a[20:23], a[116:119]
    ds_read_b64_tr_b16 a[54:55], v8 offset:8704
    v_mfma_f32_16x16x32_bf16 a[120:123], a[56:59], a[24:27], a[120:123]
    v_mfma_f32_16x16x32_bf16 a[124:127], a[56:59], a[28:31], a[124:127]
    s_waitcnt lgkmcnt(8)
    v_mfma_f32_16x16x32_bf16 v[112:115], a[60:63], a[16:19], v[112:115]
    ds_read_b64_tr_b16 a[56:57], v8 offset:7168
    v_mfma_f32_16x16x32_bf16 v[116:119], a[60:63], a[20:23], v[116:119]
    ds_read_b64_tr_b16 a[58:59], v8 offset:8960
    v_mfma_f32_16x16x32_bf16 v[120:123], a[60:63], a[24:27], v[120:123]
    v_mfma_f32_16x16x32_bf16 v[124:127], a[60:63], a[28:31], v[124:127]
    s_sub_u32 s78, s78, 1
    s_cmp_lg_u32 s78, 0
    s_cbranch_scc1 L_g1_loopHP
    s_branch L_g1_tail1
L_g1_H1:
    ds_read_b128 a[0:3], v9 offset:0
    ds_read_b128 a[4:7], v9 offset:1024
    ds_read_b128 a[8:11], v9 offset:2048
    ds_read_b128 a[12:15], v9 offset:3072
    s_add_u32 s80, s80, 1
    s_cmp_ge_u32 s80, 3
    s_cselect_b32 s81, 4294934528, s83
    s_cselect_b32 s80, 0, s80
    v_add_u32 v9, s81, v9
    ds_read_b64_tr_b16 a[48:49], v8 offset:6656
    ds_read_b64_tr_b16 a[50:51], v8 offset:8448
    ds_read_b64_tr_b16 a[52:53], v8 offset:6912
    ds_read_b64_tr_b16 a[54:55], v8 offset:8704
    ds_read_b64_tr_b16 a[56:57], v8 offset:7168
    ds_read_b64_tr_b16 a[58:59], v8 offset:8960
    s_waitcnt lgkmcnt(0)
    s_mov_b32 s78, 7
L_g1_loopH1:
    s_waitcnt lgkmcnt(4)
    v_mfma_f32_16x16x32_bf16 v[32:35], a[48:51], a[0:3], v[32:35]
    ds_read_b64_tr_b16 a[60:61], v8 offset:7424
    v_mfma_f32_16x16x32_bf16 v[36:39], a[48:51], a[4:7], v[36:39]
    ds_read_b64_tr_b16 a[62:63], v8 offset:9216
    v_mfma_f32_16x16x32_bf16 v[40:43], a[48:51], a[8:11], v[40:43]
    s_add_u32 s75, s75, 20480
    s_cmp_ge_u32 s75, 102400
    s_cselect_b32 s76, 4294885376, s82
    s_cselect_b32 s75, 0, s75
    v_mfma_f32_16x16x32_bf16 v[44:47], a[48:51], a[12:15], v[44:47]
    s_add_u32 m0, s72, 0
    s_nop 0
    buffer_load_dwordx4 v3, s[48:51], s64 offen lds
    s_waitcnt lgkmcnt(4)
    v_mfma_f32_16x16x32_bf16 v[48:51], a[52:55], a[0:3], v[48:51]
    ds_read_b64_tr_b16 a[48:49], v8 offset:7680
    v_mfma_f32_16x16x32_bf16 v[52:55], a[52:55], a[4:7], v[52:55]
    ds_read_b64_tr_b16 a[50:51], v8 offset:9472
    v_mfma_f32_16x16x32_bf16 v[56:59], a[52:55], a[8:11], v[56:59]
    s_add_u32 s64, s64, s68
    v_mfma_f32_16x16x32_bf16 v[60:63], a[52:55], a[12:15], v[60:63]
    s_add_u32 m0, s72, 1024
    s_waitcnt lgkmcnt(4)
    v_mfma_f32_16x16x32_bf16 v[64:67], a[56:59], a[0:3], v[64:67]
    ds_read_b64_tr_b16 a[52:53], v8 offset:13824
    v_mfma_f32_16x16x32_bf16 v[68:71], a[56:59], a[4:7], v[68:71]
    ds_read_b64_tr_b16 a[54:55], v8 offset:15616
    v_mfma_f32_16x16x32_bf16 v[72:75], a[56:59], a[8:11], v[72:75]
    buffer_load_dwordx4 v4, s[52:55], s65 offen lds
    v_mfma_f32_16x16x32_bf16 v[76:79], a[56:59], a[12:15], v[76:79]
    s_add_u32 s65, s65, s69
    s_waitcnt lgkmcnt(4)
    v_mfma_f32_16x16x32_bf16 v[80:83], a[60:63], a[0:3], v[80:83]
    ds_read_b64_tr_b16 a[56:57], v8 offset:14080
    v_mfma_f32_16x16x32_bf16 v[84:87], a[60:63], a[4:7], v[84:87]
    ds_read_b64_tr_b16 a[58:59], v8 offset:15872
    v_mfma_f32_16x16x32_bf16 v[88:91], a[60:63], a[8:11], v[88:91]
    s_add_u32 m0, s72, 2048
    v_mfma_f32_16x16x32_bf16 v[92:95], a[60:63], a[12:15], v[92:95]
    buffer_load_dwordx4 v5, s[56:59], s66 offen lds
    s_waitcnt lgkmcnt(4)
    v_mfma_f32_16x16x32_bf16 v[96:99], a[48:51], a[0:3], v[96:99]
    ds_read_b64_tr_b16 a[60:61], v8 offset:14336
    v_mfma_f32_16x16x32_bf16 v[100:103], a[48:51], a[4:7], v[100:103]
    ds_read_b64_tr_b16 a[62:63], v8 offset:16128
    v_mfma_f32_16x16x32_bf16 v[104:107], a[48:51], a[8:11], v[104:107]
    s_add_u32 s66, s66, s70
    v_mfma_f32_16x16x32_bf16 v[108:111], a[48:51], a[12:15], v[108:111]
    s_add_u32 m0, s72, 3072
    s_waitcnt lgkmcnt(4)
    v_mfma_f32_16x16x32_bf16 a[64:67], a[52:55], a[0:3], a[64:67]
    ds_read_b64_tr_b16 a[48:49], v8 offset:14592
    v_mfma_f32_16x16x32_bf16 a[68:71], a[52:55], a[4:7], a[68:71]
    ds_read_b64_tr_b16 a[50:51], v8 offset:16384
    v_mfma_f32_16x16x32_bf16 a[72:75], a[52:55], a[8:11], a[72:75]
    buffer_load_dwordx4 v6, s[60:63], s67 offen lds
    v_mfma_f32_16x16x32_bf16 a[76:79], a[52:55], a[12:15], a[76:79]
    s_add_u32 s67, s67, s71
    s_waitcnt lgkmcnt(4)
    v_mfma_f32_16x16x32_bf16 a[80:83], a[56:59], a[0:3], a[80:83]
    ds_read_b64_tr_b16 a[52:53], v8 offset:14848
    v_mfma_f32_16x16x32_bf16 a[84:87], a[56:59], a[4:7], a[84:87]
    ds_read_b64_tr_b16 a[54:55], v8 offset:16640
    v_mfma_f32_16x16x32_bf16 a[88:91], a[56:59], a[8:11], a[88:91]
    v_add_u32 v8, s76, v8
    s_add_u32 s72, s72, 20480
    v_mfma_f32_16x16x32_bf16 a[92:95], a[56:59], a[12:15], a[92:95]
    s_cmp_ge_u32 s72, s74
    s_cselect_b32 s72, s73, s72
    s_waitcnt lgkmcnt(4)
    v_mfma_f32_16x16x32_bf16 a[96:99], a[60:63], a[0:3], a[96:99]
    s_waitcnt vmcnt(8)
    s_barrier
    ds_read_b64_tr_b16 a[56:57], v8 offset:6656
    ds_read_b128 a[16:19], v9 offset:0
    v_mfma_f32_16x16x32_bf16 a[100:103], a[60:63], a[4:7], a[100:103]
    ds_read_b64_tr_b16 a[58:59], v8 offset:8448
    ds_read_b128 a[20:23], v9 offset:1024
    v_mfma_f32_16x16x32_bf16 a[104:107], a[60:63], a[8:11], a[104:107]
    ds_read_b128 a[24:27], v9 offset:2048
    ds_read_b128 a[28:31], v9 offset:3072
    v_mfma_f32_16x16x32_bf16 a[108:111], a[60:63], a[12:15], a[108:111]
    s_cmp_lg_u32 s78, 7
    s_cbranch_scc1 L_mega_kernel_fsw_87
    ds_write_b128 v28, a[32:35] offset:0
    ds_write_b128 v28, a[36:39] offset:1024
    ds_write_b128 v28, a[40:43] offset:2048
    ds_write_b128 v28, a[44:47] offset:3072
    L_mega_kernel_fsw_87:
    s_add_u32 s80, s80, 1
    s_cmp_ge_u32 s80, 3
    s_cselect_b32 s81, 4294934528, s83
    s_cselect_b32 s80, 0, s80
    s_waitcnt lgkmcnt(8)
    v_mfma_f32_16x16x32_bf16 a[112:115], a[48:51], a[0:3], a[112:115]
    ds_read_b64_tr_b16 a[60:61], v8 offset:6912
    v_add_u32 v9, s81, v9
    v_mfma_f32_16x16x32_bf16 a[116:119], a[48:51], a[4:7], a[116:119]
    ds_read_b64_tr_b16 a[62:63], v8 offset:8704
    v_mfma_f32_16x16x32_bf16 a[120:123], a[48:51], a[8:11], a[120:123]
    v_mfma_f32_16x16x32_bf16 a[124:127], a[48:51], a[12:15], a[124:127]
    s_waitcnt lgkmcnt(8)
    v_mfma_f32_16x16x32_bf16 v[112:115], a[52:55], a[0:3], v[112:115]
    ds_read_b64_tr_b16 a[48:49], v8 offset:7168
    v_mfma_f32_16x16x32_bf16 v[116:119], a[52:55], a[4:7], v[116:119]
    ds_read_b64_tr_b16 a[50:51], v8 offset:8960
    v_mfma_f32_16x16x32_bf16 v[120:123], a[52:55], a[8:11], v[120:123]
    v_mfma_f32_16x16x32_bf16 v[124:127], a[52:55], a[12:15], v[124:127]
    s_waitcnt lgkmcnt(4)
    v_mfma_f32_16x16x32_bf16 v[32:35], a[56:59], a[16:19], v[32:35]
    ds_read_b64_tr_b16 a[52:53], v8 offset:7424
    v_mfma_f32_16x16x32_bf16 v[36:39], a[56:59], a[20:23], v[36:39]
    ds_read_b64_tr_b16 a[54:55], v8 offset:9216
    v_mfma_f32_16x16x32_bf16 v[40:43], a[56:59], a[24:27], v[40:43]
    s_add_u32 s75, s75, 20480
    s_cmp_ge_u32 s75, 102400
    s_cselect_b32 s76, 4294885376, s82
    s_cselect_b32 s75, 0, s75
    v_mfma_f32_16x16x32_bf16 v[44:47], a[56:59], a[28:31], v[44:47]
    s_add_u32 m0, s72, 0
    s_nop 0
    buffer_load_dwordx4 v3, s[48:51], s64 offen lds
    s_waitcnt lgkmcnt(4)
    v_mfma_f32_16x16x32_bf16 v[48:51], a[60:63], a[16:19], v[48:51]
    ds_read_b64_tr_b16 a[56:57], v8 offset:7680
    v_mfma_f32_16x16x32_bf16 v[52:55], a[60:63], a[20:23], v[52:55]
    ds_read_b64_tr_b16 a[58:59], v8 offset:9472
    v_mfma_f32_16x16x32_bf16 v[56:59], a[60:63], a[24:27], v[56:59]
    s_add_u32 s64, s64, s68
    v_mfma_f32_16x16x32_bf16 v[60:63], a[60:63], a[28:31], v[60:63]
    s_add_u32 m0, s72, 1024
    s_waitcnt lgkmcnt(4)
    v_mfma_f32_16x16x32_bf16 v[64:67], a[48:51], a[16:19], v[64:67]
    ds_read_b64_tr_b16 a[60:61], v8 offset:13824
    v_mfma_f32_16x16x32_bf16 v[68:71], a[48:51], a[20:23], v[68:71]
    ds_read_b64_tr_b16 a[62:63], v8 offset:15616
    v_mfma_f32_16x16x32_bf16 v[72:75], a[48:51], a[24:27], v[72:75]
    buffer_load_dwordx4 v4, s[52:55], s65 offen lds
    v_mfma_f32_16x16x32_bf16 v[76:79], a[48:51], a[28:31], v[76:79]
    s_add_u32 s65, s65, s69
    s_waitcnt lgkmcnt(4)
    v_mfma_f32_16x16x32_bf16 v[80:83], a[52:55], a[16:19], v[80:83]
    ds_read_b64_tr_b16 a[48:49], v8 offset:14080
    v_mfma_f32_16x16x32_bf16 v[84:87], a[52:55], a[20:23], v[84:87]
    ds_read_b64_tr_b16 a[50:51], v8 offset:15872
    v_mfma_f32_16x16x32_bf16 v[88:91], a[52:55], a[24:27], v[88:91]
    s_add_u32 m0, s72, 2048
    v_mfma_f32_16x16x32_bf16 v[92:95], a[52:55], a[28:31], v[92:95]
    buffer_load_dwordx4 v5, s[56:59], s66 offen lds
    s_waitcnt lgkmcnt(4)
    v_mfma_f32_16x16x32_bf16 v[96:99], a[56:59], a[16:19], v[96:99]
    ds_read_b64_tr_b16 a[52:53], v8 offset:14336
    v_mfma_f32_16x16x32_bf16 v[100:103], a[56:59], a[20:23], v[100:103]
    ds_read_b64_tr_b16 a[54:55], v8 offset:16128
    v_mfma_f32_16x16x32_bf16 v[104:107], a[56:59], a[24:27], v[104:107]
    s_add_u32 s66, s66, s70
    v_mfma_f32_16x16x32_bf16 v[108:111], a[56:59], a[28:31], v[108:111]
    s_add_u32 m0, s72, 3072
    s_waitcnt lgkmcnt(4)
    v_mfma_f32_16x16x32_bf16 a[64:67], a[60:63], a[16:19], a[64:67]
    ds_read_b64_tr_b16 a[56:57], v8 offset:14592
    v_mfma_f32_16x16x32_bf16 a[68:71], a[60:63], a[20:23], a[68:71]
    ds_read_b64_tr_b16 a[58:59], v8 offset:16384
    v_mfma_f32_16x16x32_bf16 a[72:75], a[60:63], a[24:27], a[72:75]
    buffer_load_dwordx4 v6, s[60:63], s67 offen lds
    v_mfma_f32_16x16x32_bf16 a[76:79], a[60:63], a[28:31], a[76:79]
    s_add_u32 s67, s67, s71
    s_waitcnt lgkmcnt(4)
    v_mfma_f32_16x16x32_bf16 a[80:83], a[48:51], a[16:19], a[80:83]
    ds_read_b64_tr_b16 a[60:61], v8 offset:14848
    v_mfma_f32_16x16x32_bf16 a[84:87], a[48:51], a[20:23], a[84:87]
    ds_read_b64_tr_b16 a[62:63], v8 offset:16640
    v_mfma_f32_16x16x32_bf16 a[88:91], a[48:51], a[24:27], a[88:91]
    v_add_u32 v8, s76, v8
    s_add_u32 s72, s72, 20480
    v_mfma_f32_16x16x32_bf16 a[92:95], a[48:51], a[28:31], a[92:95]
    s_cmp_ge_u32 s72, s74
    s_cselect_b32 s72, s73, s72
    s_waitcnt lgkmcnt(4)
    v_mfma_f32_16x16x32_bf16 a[96:99], a[52:55], a[16:19], a[96:99]
    s_waitcnt vmcnt(8)
    s_barrier
    ds_read_b64_tr_b16 a[48:49], v8 offset:6656
    ds_read_b128 a[0:3], v9 offset:0
    v_mfma_f32_16x16x32_bf16 a[100:103], a[52:55], a[20:23], a[100:103]
    ds_read_b64_tr_b16 a[50:51], v8 offset:8448
    ds_read_b128 a[4:7], v9 offset:1024
    v_mfma_f32_16x16x32_bf16 a[104:107], a[52:55], a[24:27], a[104:107]
    ds_read_b128 a[8:11], v9 offset:2048
    ds_read_b128 a[12:15], v9 offset:3072
    v_mfma_f32_16x16x32_bf16 a[108:111], a[52:55], a[28:31], a[108:111]
    s_add_u32 s80, s80, 1
    s_cmp_ge_u32 s80, 3
    s_cselect_b32 s81, 4294934528, s83
    s_cselect_b32 s80, 0, s80
    v_add_u32 v9, s81, v9
    s_waitcnt lgkmcnt(8)
    v_mfma_f32_16x16x32_bf16 a[112:115], a[56:59], a[16:19], a[112:115]
    ds_read_b64_tr_b16 a[52:53], v8 offset:6912
    v_mfma_f32_16x16x32_bf16 a[116:119], a[56:59], a[20:23], a[116:119]
    ds_read_b64_tr_b16 a[54:55], v8 offset:8704
    v_mfma_f32_16x16x32_bf16 a[120:123], a[56:59], a[24:27], a[120:123]
    v_mfma_f32_16x16x32_bf16 a[124:127], a[56:59], a[28:31], a[124:127]
    s_waitcnt lgkmcnt(8)
    v_mfma_f32_16x16x32_bf16 v[112:115], a[60:63], a[16:19], v[112:115]
    ds_read_b64_tr_b16 a[56:57], v8 offset:7168
    v_mfma_f32_16x16x32_bf16 v[116:119], a[60:63], a[20:23], v[116:119]
    ds_read_b64_tr_b16 a[58:59], v8 offset:8960
    v_mfma_f32_16x16x32_bf16 v[120:123], a[60:63], a[24:27], v[120:123]
    v_mfma_f32_16x16x32_bf16 v[124:127], a[60:63], a[28:31], v[124:127]
    s_waitcnt lgkmcnt(4)
    v_mfma_f32_16x16x32_bf16 v[32:35], a[48:51], a[0:3], v[32:35]
    ds_read_b64_tr_b16 a[60:61], v8 offset:7424
    v_mfma_f32_16x16x32_bf16 v[36:39], a[48:51], a[4:7], v[36:39]
    ds_read_b64_tr_b16 a[62:63], v8 offset:9216
    v_mfma_f32_16x16x32_bf16 v[40:43], a[48:51], a[8:11], v[40:43]
    s_add_u32 s75, s75, 20480
    s_cmp_ge_u32 s75, 102400
    s_cselect_b32 s76, 4294885376, s82
    s_cselect_b32 s75, 0, s75
    v_mfma_f32_16x16x32_bf16 v[44:47], a[48:51], a[12:15], v[44:47]
    s_add_u32 m0, s72, 0
    s_nop 0
    buffer_load_dwordx4 v3, s[48:51], s64 offen lds
    s_waitcnt lgkmcnt(4)
    v_mfma_f32_16x16x32_bf16 v[48:51], a[52:55], a[0:3], v[48:51]
    ds_read_b64_tr_b16 a[48:49], v8 offset:7680
    v_mfma_f32_16x16x32_bf16 v[52:55], a[52:55], a[4:7], v[52:55]
    ds_read_b64_tr_b16 a[50:51], v8 offset:9472
    v_mfma_f32_16x16x32_bf16 v[56:59], a[52:55], a[8:11], v[56:59]
    s_add_u32 s64, s64, s68
    v_mfma_f32_16x16x32_bf16 v[60:63], a[52:55], a[12:15], v[60:63]
    s_add_u32 m0, s72, 1024
    s_waitcnt lgkmcnt(4)
    v_mfma_f32_16x16x32_bf16 v[64:67], a[56:59], a[0:3], v[64:67]
    ds_read_b64_tr_b16 a[52:53], v8 offset:13824
    v_mfma_f32_16x16x32_bf16 v[68:71], a[56:59], a[4:7], v[68:71]
    ds_read_b64_tr_b16 a[54:55], v8 offset:15616
    v_mfma_f32_16x16x32_bf16 v[72:75], a[56:59], a[8:11], v[72:75]
    buffer_load_dwordx4 v4, s[52:55], s65 offen lds
    v_mfma_f32_16x16x32_bf16 v[76:79], a[56:59], a[12:15], v[76:79]
    s_add_u32 s65, s65, s69
    s_waitcnt lgkmcnt(4)
    v_mfma_f32_16x16x32_bf16 v[80:83], a[60:63], a[0:3], v[80:83]
    ds_read_b64_tr_b16 a[56:57], v8 offset:14080
    v_mfma_f32_16x16x32_bf16 v[84:87], a[60:63], a[4:7], v[84:87]
    ds_read_b64_tr_b16 a[58:59], v8 offset:15872
    v_mfma_f32_16x16x32_bf16 v[88:91], a[60:63], a[8:11], v[88:91]
    s_add_u32 m0, s72, 2048
    v_mfma_f32_16x16x32_bf16 v[92:95], a[60:63], a[12:15], v[92:95]
    buffer_load_dwordx4 v5, s[56:59], s66 offen lds
    s_waitcnt lgkmcnt(4)
    v_mfma_f32_16x16x32_bf16 v[96:99], a[48:51], a[0:3], v[96:99]
    ds_read_b64_tr_b16 a[60:61], v8 offset:14336
    v_mfma_f32_16x16x32_bf16 v[100:103], a[48:51], a[4:7], v[100:103]
    ds_read_b64_tr_b16 a[62:63], v8 offset:16128
    v_mfma_f32_16x16x32_bf16 v[104:107], a[48:51], a[8:11], v[104:107]
    s_add_u32 s66, s66, s70
    v_mfma_f32_16x16x32_bf16 v[108:111], a[48:51], a[12:15], v[108:111]
    s_add_u32 m0, s72, 3072
    s_waitcnt lgkmcnt(4)
    v_mfma_f32_16x16x32_bf16 a[64:67], a[52:55], a[0:3], a[64:67]
    ds_read_b64_tr_b16 a[48:49], v8 offset:14592
    v_mfma_f32_16x16x32_bf16 a[68:71], a[52:55], a[4:7], a[68:71]
    ds_read_b64_tr_b16 a[50:51], v8 offset:16384
    v_mfma_f32_16x16x32_bf16 a[72:75], a[52:55], a[8:11], a[72:75]
    buffer_load_dwordx4 v6, s[60:63], s67 offen lds
    v_mfma_f32_16x16x32_bf16 a[76:79], a[52:55], a[12:15], a[76:79]
    s_add_u32 s67, s67, s71
    s_waitcnt lgkmcnt(4)
    v_mfma_f32_16x16x32_bf16 a[80:83], a[56:59], a[0:3], a[80:83]
    ds_read_b64_tr_b16 a[52:53], v8 offset:14848
    v_mfma_f32_16x16x32_bf16 a[84:87], a[56:59], a[4:7], a[84:87]
    ds_read_b64_tr_b16 a[54:55], v8 offset:16640
    v_mfma_f32_16x16x32_bf16 a[88:91], a[56:59], a[8:11], a[88:91]
    v_add_u32 v8, s76, v8
    s_add_u32 s72, s72, 20480
    v_mfma_f32_16x16x32_bf16 a[92:95], a[56:59], a[12:15], a[92:95]
    s_cmp_ge_u32 s72, s74
    s_cselect_b32 s72, s73, s72
    s_waitcnt lgkmcnt(4)
    v_mfma_f32_16x16x32_bf16 a[96:99], a[60:63], a[0:3], a[96:99]
    s_waitcnt vmcnt(8)
    s_barrier
    ds_read_b64_tr_b16 a[56:57], v8 offset:6656
    ds_read_b128 a[16:19], v9 offset:0
    v_mfma_f32_16x16x32_bf16 a[100:103], a[60:63], a[4:7], a[100:103]
    ds_read_b64_tr_b16 a[58:59], v8 offset:8448
    ds_read_b128 a[20:23], v9 offset:1024
    v_mfma_f32_16x16x32_bf16 a[104:107], a[60:63], a[8:11], a[104:107]
    ds_read_b128 a[24:27], v9 offset:2048
    ds_read_b128 a[28:31], v9 offset:3072
    v_mfma_f32_16x16x32_bf16 a[108:111], a[60:63], a[12:15], a[108:111]
    s_add_u32 s80, s80, 1
    s_cmp_ge_u32 s80, 3
    s_cselect_b32 s81, 4294934528, s83
    s_cselect_b32 s80, 0, s80
    v_add_u32 v9, s81, v9
    s_waitcnt lgkmcnt(8)
    v_mfma_f32_16x16x32_bf16 a[112:115], a[48:51], a[0:3], a[112:115]
    ds_read_b64_tr_b16 a[60:61], v8 offset:6912
    v_mfma_f32_16x16x32_bf16 a[116:119], a[48:51], a[4:7], a[116:119]
    ds_read_b64_tr_b16 a[62:63], v8 offset:8704
    v_mfma_f32_16x16x32_bf16 a[120:123], a[48:51], a[8:11], a[120:123]
    v_mfma_f32_16x16x32_bf16 a[124:127], a[48:51], a[12:15], a[124:127]
    s_waitcnt lgkmcnt(8)
    v_mfma_f32_16x16x32_bf16 v[112:115], a[52:55], a[0:3], v[112:115]
    ds_read_b64_tr_b16 a[48:49], v8 offset:7168
    v_mfma_f32_16x16x32_bf16 v[116:119], a[52:55], a[4:7], v[116:119]
    ds_read_b64_tr_b16 a[50:51], v8 offset:8960
    v_mfma_f32_16x16x32_bf16 v[120:123], a[52:55], a[8:11], v[120:123]
    v_mfma_f32_16x16x32_bf16 v[124:127], a[52:55], a[12:15], v[124:127]
    s_waitcnt lgkmcnt(4)
    v_mfma_f32_16x16x32_bf16 v[32:35], a[56:59], a[16:19], v[32:35]
    ds_read_b64_tr_b16 a[52:53], v8 offset:7424
    v_mfma_f32_16x16x32_bf16 v[36:39], a[56:59], a[20:23], v[36:39]
    ds_read_b64_tr_b16 a[54:55], v8 offset:9216
    v_mfma_f32_16x16x32_bf16 v[40:43], a[56:59], a[24:27], v[40:43]
    s_add_u32 s75, s75, 20480
    s_cmp_ge_u32 s75, 102400
    s_cselect_b32 s76, 4294885376, s82
    s_cselect_b32 s75, 0, s75
    v_mfma_f32_16x16x32_bf16 v[44:47], a[56:59], a[28:31], v[44:47]
    s_add_u32 m0, s72, 0
    s_nop 0
    buffer_load_dwordx4 v3, s[48:51], s64 offen lds
    s_waitcnt lgkmcnt(4)
    v_mfma_f32_16x16x32_bf16 v[48:51], a[60:63], a[16:19], v[48:51]
    ds_read_b64_tr_b16 a[56:57], v8 offset:7680
    v_mfma_f32_16x16x32_bf16 v[52:55], a[60:63], a[20:23], v[52:55]
    ds_read_b64_tr_b16 a[58:59], v8 offset:9472
    v_mfma_f32_16x16x32_bf16 v[56:59], a[60:63], a[24:27], v[56:59]
    s_add_u32 s64, s64, s68
    v_mfma_f32_16x16x32_bf16 v[60:63], a[60:63], a[28:31], v[60:63]
    s_add_u32 m0, s72, 1024
    s_waitcnt lgkmcnt(4)
    v_mfma_f32_16x16x32_bf16 v[64:67], a[48:51], a[16:19], v[64:67]
    ds_read_b64_tr_b16 a[60:61], v8 offset:13824
    v_mfma_f32_16x16x32_bf16 v[68:71], a[48:51], a[20:23], v[68:71]
    ds_read_b64_tr_b16 a[62:63], v8 offset:15616
    v_mfma_f32_16x16x32_bf16 v[72:75], a[48:51], a[24:27], v[72:75]
    buffer_load_dwordx4 v4, s[52:55], s65 offen lds
    v_mfma_f32_16x16x32_bf16 v[76:79], a[48:51], a[28:31], v[76:79]
    s_add_u32 s65, s65, s69
    s_waitcnt lgkmcnt(4)
    v_mfma_f32_16x16x32_bf16 v[80:83], a[52:55], a[16:19], v[80:83]
    ds_read_b64_tr_b16 a[48:49], v8 offset:14080
    v_mfma_f32_16x16x32_bf16 v[84:87], a[52:55], a[20:23], v[84:87]
    ds_read_b64_tr_b16 a[50:51], v8 offset:15872
    v_mfma_f32_16x16x32_bf16 v[88:91], a[52:55], a[24:27], v[88:91]
    s_add_u32 m0, s72, 2048
    v_mfma_f32_16x16x32_bf16 v[92:95], a[52:55], a[28:31], v[92:95]
    buffer_load_dwordx4 v5, s[56:59], s66 offen lds
    s_waitcnt lgkmcnt(4)
    v_mfma_f32_16x16x32_bf16 v[96:99], a[56:59], a[16:19], v[96:99]
    ds_read_b64_tr_b16 a[52:53], v8 offset:14336
    v_mfma_f32_16x16x32_bf16 v[100:103], a[56:59], a[20:23], v[100:103]
    ds_read_b64_tr_b16 a[54:55], v8 offset:16128
    v_mfma_f32_16x16x32_bf16 v[104:107], a[56:59], a[24:27], v[104:107]
    s_add_u32 s66, s66, s70
    v_mfma_f32_16x16x32_bf16 v[108:111], a[56:59], a[28:31], v[108:111]
    s_add_u32 m0, s72, 3072
    s_waitcnt lgkmcnt(4)
    v_mfma_f32_16x16x32_bf16 a[64:67], a[60:63], a[16:19], a[64:67]
    ds_read_b64_tr_b16 a[56:57], v8 offset:14592
    v_mfma_f32_16x16x32_bf16 a[68:71], a[60:63], a[20:23], a[68:71]
    ds_read_b64_tr_b16 a[58:59], v8 offset:16384
    v_mfma_f32_16x16x32_bf16 a[72:75], a[60:63], a[24:27], a[72:75]
    buffer_load_dwordx4 v6, s[60:63], s67 offen lds
    v_mfma_f32_16x16x32_bf16 a[76:79], a[60:63], a[28:31], a[76:79]
    s_add_u32 s67, s67, s71
    s_waitcnt lgkmcnt(4)
    v_mfma_f32_16x16x32_bf16 a[80:83], a[48:51], a[16:19], a[80:83]
    ds_read_b64_tr_b16 a[60:61], v8 offset:14848
    v_mfma_f32_16x16x32_bf16 a[84:87], a[48:51], a[20:23], a[84:87]
    ds_read_b64_tr_b16 a[62:63], v8 offset:16640
    v_mfma_f32_16x16x32_bf16 a[88:91], a[48:51], a[24:27], a[88:91]
    v_add_u32 v8, s76, v8
    s_add_u32 s72, s72, 20480
    v_mfma_f32_16x16x32_bf16 a[92:95], a[48:51], a[28:31], a[92:95]
    s_cmp_ge_u32 s72, s74
    s_cselect_b32 s72, s73, s72
    s_waitcnt lgkmcnt(4)
    v_mfma_f32_16x16x32_bf16 a[96:99], a[52:55], a[16:19], a[96:99]
    s_waitcnt vmcnt(8)
    s_barrier
    ds_read_b64_tr_b16 a[48:49], v8 offset:6656
    ds_read_b128 a[0:3], v9 offset:0
    v_mfma_f32_16x16x32_bf16 a[100:103], a[52:55], a[20:23], a[100:103]
    ds_read_b64_tr_b16 a[50:51], v8 offset:8448
    ds_read_b128 a[4:7], v9 offset:1024
    v_mfma_f32_16x16x32_bf16 a[104:107], a[52:55], a[24:27], a[104:107]
    ds_read_b128 a[8:11], v9 offset:2048
    ds_read_b128 a[12:15], v9 offset:3072
    v_mfma_f32_16x16x32_bf16 a[108:111], a[52:55], a[28:31], a[108:111]
    s_add_u32 s80, s80, 1
    s_cmp_ge_u32 s80, 3
    s_cselect_b32 s81, 4294934528, s83
    s_cselect_b32 s80, 0, s80
    v_add_u32 v9, s81, v9
    s_waitcnt lgkmcnt(8)
    v_mfma_f32_16x16x32_bf16 a[112:115], a[56:59], a[16:19], a[112:115]
    ds_read_b64_tr_b16 a[52:53], v8 offset:6912
    v_mfma_f32_16x16x32_bf16 a[116:119], a[56:59], a[20:23], a[116:119]
    ds_read_b64_tr_b16 a[54:55], v8 offset:8704
    v_mfma_f32_16x16x32_bf16 a[120:123], a[56:59], a[24:27], a[120:123]
    v_mfma_f32_16x16x32_bf16 a[124:127], a[56:59], a[28:31], a[124:127]
    s_waitcnt lgkmcnt(8)
    v_mfma_f32_16x16x32_bf16 v[112:115], a[60:63], a[16:19], v[112:115]
    ds_read_b64_tr_b16 a[56:57], v8 offset:7168
    v_mfma_f32_16x16x32_bf16 v[116:119], a[60:63], a[20:23], v[116:119]
    ds_read_b64_tr_b16 a[58:59], v8 offset:8960
    v_mfma_f32_16x16x32_bf16 v[120:123], a[60:63], a[24:27], v[120:123]
    v_mfma_f32_16x16x32_bf16 v[124:127], a[60:63], a[28:31], v[124:127]
    s_sub_u32 s78, s78, 1
    s_cmp_lg_u32 s78, 0
    s_cbranch_scc1 L_g1_loopH1
    s_add_u32 m0, s72, 0
    s_nop 0
    buffer_load_dwordx4 v3, s[48:51], s64 offen lds
    s_add_u32 s64, s64, s68
    s_add_u32 m0, s72, 1024
    s_nop 0
    buffer_load_dwordx4 v4, s[52:55], s65 offen lds
    s_add_u32 s65, s65, s69
    s_add_u32 m0, s72, 2048
    s_nop 0
    buffer_load_dwordx4 v5, s[56:59], s66 offen lds
    s_add_u32 s66, s66, s70
    s_add_u32 m0, s72, 3072
    s_nop 0
    buffer_load_dwordx4 v6, s[60:63], s67 offen lds
    s_add_u32 s67, s67, s71
    s_add_u32 s72, s72, 20480
    s_cmp_ge_u32 s72, s74
    s_cselect_b32 s72, s73, s72
L_g1_tail1:
    s_waitcnt lgkmcnt(4)
    v_mfma_f32_16x16x32_bf16 v[32:35], a[48:51], a[0:3], v[32:35]
    ds_read_b64_tr_b16 a[60:61], v8 offset:7424
    v_mfma_f32_16x16x32_bf16 v[36:39], a[48:51], a[4:7], v[36:39]
    ds_read_b64_tr_b16 a[62:63], v8 offset:9216
    v_mfma_f32_16x16x32_bf16 v[40:43], a[48:51], a[8:11], v[40:43]
    s_add_u32 s75, s75, 20480
    v_mfma_f32_16x16x32_bf16 v[44:47], a[48:51], a[12:15], v[44:47]
    s_cmp_ge_u32 s75, 102400
    s_cselect_b32 s76, 4294885376, s82
    s_cselect_b32 s75, 0, s75
    s_waitcnt lgkmcnt(4)
    v_mfma_f32_16x16x32_bf16 v[48:51], a[52:55], a[0:3], v[48:51]
    ds_read_b64_tr_b16 a[48:49], v8 offset:7680
    v_mfma_f32_16x16x32_bf16 v[52:55], a[52:55], a[4:7], v[52:55]
    ds_read_b64_tr_b16 a[50:51], v8 offset:9472
    v_mfma_f32_16x16x32_bf16 v[56:59], a[52:55], a[8:11], v[56:59]
    v_mfma_f32_16x16x32_bf16 v[60:63], a[52:55], a[12:15], v[60:63]
    s_waitcnt lgkmcnt(4)
    v_mfma_f32_16x16x32_bf16 v[64:67], a[56:59], a[0:3], v[64:67]
    ds_read_b64_tr_b16 a[52:53], v8 offset:13824
    v_mfma_f32_16x16x32_bf16 v[68:71], a[56:59], a[4:7], v[68:71]
    ds_read_b64_tr_b16 a[54:55], v8 offset:15616
    v_mfma_f32_16x16x32_bf16 v[72:75], a[56:59], a[8:11], v[72:75]
    v_mfma_f32_16x16x32_bf16 v[76:79], a[56:59], a[12:15], v[76:79]
    s_waitcnt lgkmcnt(4)
    v_mfma_f32_16x16x32_bf16 v[80:83], a[60:63], a[0:3], v[80:83]
    ds_read_b64_tr_b16 a[56:57], v8 offset:14080
    v_mfma_f32_16x16x32_bf16 v[84:87], a[60:63], a[4:7], v[84:87]
    ds_read_b64_tr_b16 a[58:59], v8 offset:15872
    v_mfma_f32_16x16x32_bf16 v[88:91], a[60:63], a[8:11], v[88:91]
    v_mfma_f32_16x16x32_bf16 v[92:95], a[60:63], a[12:15], v[92:95]
    s_waitcnt lgkmcnt(4)
    v_mfma_f32_16x16x32_bf16 v[96:99], a[48:51], a[0:3], v[96:99]
    ds_read_b64_tr_b16 a[60:61], v8 offset:14336
    v_mfma_f32_16x16x32_bf16 v[100:103], a[48:51], a[4:7], v[100:103]
    ds_read_b64_tr_b16 a[62:63], v8 offset:16128
    v_mfma_f32_16x16x32_bf16 v[104:107], a[48:51], a[8:11], v[104:107]
    v_mfma_f32_16x16x32_bf16 v[108:111], a[48:51], a[12:15], v[108:111]
    s_waitcnt lgkmcnt(4)
    v_mfma_f32_16x16x32_bf16 a[64:67], a[52:55], a[0:3], a[64:67]
    ds_read_b64_tr_b16 a[48:49], v8 offset:14592
    v_mfma_f32_16x16x32_bf16 a[68:71], a[52:55], a[4:7], a[68:71]
    ds_read_b64_tr_b16 a[50:51], v8 offset:16384
    v_mfma_f32_16x16x32_bf16 a[72:75], a[52:55], a[8:11], a[72:75]
    v_mfma_f32_16x16x32_bf16 a[76:79], a[52:55], a[12:15], a[76:79]
    s_waitcnt lgkmcnt(4)
    v_mfma_f32_16x16x32_bf16 a[80:83], a[56:59], a[0:3], a[80:83]
    ds_read_b64_tr_b16 a[52:53], v8 offset:14848
    v_mfma_f32_16x16x32_bf16 a[84:87], a[56:59], a[4:7], a[84:87]
    ds_read_b64_tr_b16 a[54:55], v8 offset:16640
    v_mfma_f32_16x16x32_bf16 a[88:91], a[56:59], a[8:11], a[88:91]
    v_add_u32 v8, s76, v8
    v_mfma_f32_16x16x32_bf16 a[92:95], a[56:59], a[12:15], a[92:95]
    s_waitcnt lgkmcnt(4)
    v_mfma_f32_16x16x32_bf16 a[96:99], a[60:63], a[0:3], a[96:99]
    s_waitcnt vmcnt(8)
    s_barrier
    ds_read_b64_tr_b16 a[56:57], v8 offset:6656
    ds_read_b128 a[16:19], v9 offset:0
    v_mfma_f32_16x16x32_bf16 a[100:103], a[60:63], a[4:7], a[100:103]
    ds_read_b64_tr_b16 a[58:59], v8 offset:8448
    ds_read_b128 a[20:23], v9 offset:1024
    v_mfma_f32_16x16x32_bf16 a[104:107], a[60:63], a[8:11], a[104:107]
    ds_read_b128 a[24:27], v9 offset:2048
    ds_read_b128 a[28:31], v9 offset:3072
    v_mfma_f32_16x16x32_bf16 a[108:111], a[60:63], a[12:15], a[108:111]
    s_add_u32 s80, s80, 1
    s_cmp_ge_u32 s80, 3
    s_cselect_b32 s81, 4294934528, s83
    s_cselect_b32 s80, 0, s80
    v_add_u32 v9, s81, v9
    s_waitcnt lgkmcnt(8)
    v_mfma_f32_16x16x32_bf16 a[112:115], a[48:51], a[0:3], a[112:115]
    ds_read_b64_tr_b16 a[60:61], v8 offset:6912
    s_mov_b32 s77, 126976
    v_mfma_f32_16x16x32_bf16 a[116:119], a[48:51], a[4:7], a[116:119]
    ds_read_b64_tr_b16 a[62:63], v8 offset:8704
    buffer_load_dwordx4 a[32:35], v2, s[40:43], s77 offen offset:0 sc1
    v_mfma_f32_16x16x32_bf16 a[120:123], a[48:51], a[8:11], a[120:123]
    buffer_load_dwordx4 a[36:39], v2, s[40:43], s77 offen offset:1024 sc1
    buffer_load_dwordx4 a[40:43], v2, s[40:43], s77 offen offset:2048 sc1
    v_mfma_f32_16x16x32_bf16 a[124:127], a[48:51], a[12:15], a[124:127]
    buffer_load_dwordx4 a[44:47], v2, s[40:43], s77 offen offset:3072 sc1
    s_waitcnt lgkmcnt(8)
    v_mfma_f32_16x16x32_bf16 v[112:115], a[52:55], a[0:3], v[112:115]
    ds_read_b64_tr_b16 a[48:49], v8 offset:7168
    v_mfma_f32_16x16x32_bf16 v[116:119], a[52:55], a[4:7], v[116:119]
    ds_read_b64_tr_b16 a[50:51], v8 offset:8960
    v_mfma_f32_16x16x32_bf16 v[120:123], a[52:55], a[8:11], v[120:123]
    v_mfma_f32_16x16x32_bf16 v[124:127], a[52:55], a[12:15], v[124:127]
    s_waitcnt lgkmcnt(4)
    v_mfma_f32_16x16x32_bf16 v[32:35], a[56:59], a[16:19], v[32:35]
    ds_read_b64_tr_b16 a[52:53], v8 offset:7424
    v_mfma_f32_16x16x32_bf16 v[36:39], a[56:59], a[20:23], v[36:39]
    ds_read_b64_tr_b16 a[54:55], v8 offset:9216
    v_mfma_f32_16x16x32_bf16 v[40:43], a[56:59], a[24:27], v[40:43]
    s_add_u32 s75, s75, 20480
    s_cmp_ge_u32 s75, 102400
    s_cselect_b32 s76, 4294885376, s82
    s_cselect_b32 s75, 0, s75
    v_mfma_f32_16x16x32_bf16 v[44:47], a[56:59], a[28:31], v[44:47]
    s_and_b32 s38, s28, 3
    s_waitcnt lgkmcnt(4)
    v_mfma_f32_16x16x32_bf16 v[48:51], a[60:63], a[16:19], v[48:51]
    ds_read_b64_tr_b16 a[56:57], v8 offset:7680
    v_mfma_f32_16x16x32_bf16 v[52:55], a[60:63], a[20:23], v[52:55]
    ds_read_b64_tr_b16 a[58:59], v8 offset:9472
    v_mfma_f32_16x16x32_bf16 v[56:59], a[60:63], a[24:27], v[56:59]
    s_lshl_b32 s38, s38, 1
    v_mfma_f32_16x16x32_bf16 v[60:63], a[60:63], a[28:31], v[60:63]
    s_lshl_b32 s34, s29, 3
    s_waitcnt lgkmcnt(4)
    v_mfma_f32_16x16x32_bf16 v[64:67], a[48:51], a[16:19], v[64:67]
    ds_read_b64_tr_b16 a[60:61], v8 offset:13824
    v_mfma_f32_16x16x32_bf16 v[68:71], a[48:51], a[20:23], v[68:71]
    ds_read_b64_tr_b16 a[62:63], v8 offset:15616
    v_mfma_f32_16x16x32_bf16 v[72:75], a[48:51], a[24:27], v[72:75]
    s_add_u32 s38, s38, s34
    v_mfma_f32_16x16x32_bf16 v[76:79], a[48:51], a[28:31], v[76:79]
    s_mul_i32 s64, s38, 294912
    s_waitcnt lgkmcnt(4)
    v_mfma_f32_16x16x32_bf16 v[80:83], a[52:55], a[16:19], v[80:83]
    ds_read_b64_tr_b16 a[48:49], v8 offset:14080
    v_mfma_f32_16x16x32_bf16 v[84:87], a[52:55], a[20:23], v[84:87]
    ds_read_b64_tr_b16 a[50:51], v8 offset:15872
    v_mfma_f32_16x16x32_bf16 v[88:91], a[52:55], a[24:27], v[88:91]
    s_add_u32 s64, s64, 20971520
    v_mfma_f32_16x16x32_bf16 v[92:95], a[52:55], a[28:31], v[92:95]
    s_mov_b32 s69, s64
    s_waitcnt lgkmcnt(4)
    v_mfma_f32_16x16x32_bf16 v[96:99], a[56:59], a[16:19], v[96:99]
    ds_read_b64_tr_b16 a[52:53], v8 offset:14336
    v_mfma_f32_16x16x32_bf16 v[100:103], a[56:59], a[20:23], v[100:103]
    ds_read_b64_tr_b16 a[54:55], v8 offset:16128
    v_mfma_f32_16x16x32_bf16 v[104:107], a[56:59], a[24:27], v[104:107]
    s_mul_i32 s34, s30, 7168
    v_mfma_f32_16x16x32_bf16 v[108:111], a[56:59], a[28:31], v[108:111]
    s_add_u32 s64, s64, s34
    s_waitcnt lgkmcnt(4)
    v_mfma_f32_16x16x32_bf16 a[64:67], a[60:63], a[16:19], a[64:67]
    ds_read_b64_tr_b16 a[56:57], v8 offset:14592
    v_mfma_f32_16x16x32_bf16 a[68:71], a[60:63], a[20:23], a[68:71]
    ds_read_b64_tr_b16 a[58:59], v8 offset:16384
    v_mfma_f32_16x16x32_bf16 a[72:75], a[60:63], a[24:27], a[72:75]
    s_add_u32 s64, s64, 2048
    v_mfma_f32_16x16x32_bf16 a[76:79], a[60:63], a[28:31], a[76:79]
    s_add_u32 s65, s64, 294912
    s_waitcnt lgkmcnt(4)
    v_mfma_f32_16x16x32_bf16 a[80:83], a[48:51], a[16:19], a[80:83]
    ds_read_b64_tr_b16 a[60:61], v8 offset:14848
    v_mfma_f32_16x16x32_bf16 a[84:87], a[48:51], a[20:23], a[84:87]
    ds_read_b64_tr_b16 a[62:63], v8 offset:16640
    v_mfma_f32_16x16x32_bf16 a[88:91], a[48:51], a[24:27], a[88:91]
    v_add_u32 v8, s76, v8
    s_add_u32 s66, s64, 4096
    v_mfma_f32_16x16x32_bf16 a[92:95], a[48:51], a[28:31], a[92:95]
    s_add_u32 s67, s65, 4096
    s_waitcnt lgkmcnt(4)
    v_mfma_f32_16x16x32_bf16 a[96:99], a[52:55], a[16:19], a[96:99]
    s_waitcnt vmcnt(0)
    s_barrier
    ds_read_b64_tr_b16 a[48:49], v8 offset:6656
    ds_read_b128 a[0:3], v9 offset:0
    v_mfma_f32_16x16x32_bf16 a[100:103], a[52:55], a[20:23], a[100:103]
    ds_read_b64_tr_b16 a[50:51], v8 offset:8448
    ds_read_b128 a[4:7], v9 offset:1024
    v_mfma_f32_16x16x32_bf16 a[104:107], a[52:55], a[24:27], a[104:107]
    ds_read_b128 a[8:11], v9 offset:2048
    ds_read_b128 a[12:15], v9 offset:3072
    v_mfma_f32_16x16x32_bf16 a[108:111], a[52:55], a[28:31], a[108:111]
    s_waitcnt lgkmcnt(8)
    v_mfma_f32_16x16x32_bf16 a[112:115], a[56:59], a[16:19], a[112:115]
    ds_read_b64_tr_b16 a[52:53], v8 offset:27136
    v_mfma_f32_16x16x32_bf16 a[116:119], a[56:59], a[20:23], a[116:119]
    ds_read_b64_tr_b16 a[54:55], v8 offset:28928
    v_mfma_f32_16x16x32_bf16 a[120:123], a[56:59], a[24:27], a[120:123]
    v_mfma_f32_16x16x32_bf16 a[124:127], a[56:59], a[28:31], a[124:127]
    s_waitcnt lgkmcnt(8)
    v_mfma_f32_16x16x32_bf16 v[112:115], a[60:63], a[16:19], v[112:115]
    ds_read_b64_tr_b16 a[56:57], v8 offset:13824
    v_mfma_f32_16x16x32_bf16 v[116:119], a[60:63], a[20:23], v[116:119]
    ds_read_b64_tr_b16 a[58:59], v8 offset:15616
    v_mfma_f32_16x16x32_bf16 v[120:123], a[60:63], a[24:27], v[120:123]
    v_mfma_f32_16x16x32_bf16 v[124:127], a[60:63], a[28:31], v[124:127]
    s_waitcnt lgkmcnt(4)
    v_mfma_f32_16x16x32_bf16 v[32:35], a[48:51], a[0:3], v[32:35]
    ds_read_b64_tr_b16 a[60:61], v8 offset:34304
    v_mfma_f32_16x16x32_bf16 v[36:39], a[48:51], a[4:7], v[36:39]
    ds_read_b64_tr_b16 a[62:63], v8 offset:36096
    v_mfma_f32_16x16x32_bf16 v[40:43], a[48:51], a[8:11], v[40:43]
    v_mfma_f32_16x16x32_bf16 v[44:47], a[48:51], a[12:15], v[44:47]
    s_waitcnt lgkmcnt(4)
    v_mfma_f32_16x16x32_bf16 v[32:35], a[52:55], a[32:35], v[32:35]
    ds_read_b64_tr_b16 a[48:49], v8 offset:6912
    v_mfma_f32_16x16x32_bf16 v[36:39], a[52:55], a[36:39], v[36:39]
    ds_read_b64_tr_b16 a[50:51], v8 offset:8704
    v_mfma_f32_16x16x32_bf16 v[40:43], a[52:55], a[40:43], v[40:43]
    v_mfma_f32_16x16x32_bf16 v[44:47], a[52:55], a[44:47], v[44:47]
    s_waitcnt lgkmcnt(4)
    v_mfma_f32_16x16x32_bf16 a[64:67], a[56:59], a[0:3], a[64:67]
    ds_read_b64_tr_b16 a[52:53], v8 offset:27392
    v_mfma_f32_16x16x32_bf16 a[68:71], a[56:59], a[4:7], a[68:71]
    ds_read_b64_tr_b16 a[54:55], v8 offset:29184
    v_mfma_f32_16x16x32_bf16 a[72:75], a[56:59], a[8:11], a[72:75]
    v_mfma_f32_16x16x32_bf16 a[76:79], a[56:59], a[12:15], a[76:79]
    s_waitcnt lgkmcnt(4)
    v_mfma_f32_16x16x32_bf16 a[64:67], a[60:63], a[32:35], a[64:67]
    ds_read_b64_tr_b16 a[56:57], v8 offset:14080
    v_mfma_f32_16x16x32_bf16 a[68:71], a[60:63], a[36:39], a[68:71]
    ds_read_b64_tr_b16 a[58:59], v8 offset:15872
    v_mfma_f32_16x16x32_bf16 a[72:75], a[60:63], a[40:43], a[72:75]
    v_mfma_f32_16x16x32_bf16 a[76:79], a[60:63], a[44:47], a[76:79]
    s_waitcnt lgkmcnt(4)
    v_mfma_f32_16x16x32_bf16 v[48:51], a[48:51], a[0:3], v[48:51]
    ds_read_b64_tr_b16 a[60:61], v8 offset:34560
    v_mfma_f32_16x16x32_bf16 v[52:55], a[48:51], a[4:7], v[52:55]
    ds_read_b64_tr_b16 a[62:63], v8 offset:36352
    v_mfma_f32_16x16x32_bf16 v[56:59], a[48:51], a[8:11], v[56:59]
    s_nop 4
    v_mfma_f32_16x16x32_bf16 v[60:63], a[48:51], a[12:15], v[60:63]
    v_mul_f32 v32, 0xbfb8aa3b, v32
    v_mul_f32 v33, 0xbfb8aa3b, v33
    v_mul_f32 v34, 0xbfb8aa3b, v34
    s_waitcnt lgkmcnt(4)
    v_mfma_f32_16x16x32_bf16 v[48:51], a[52:55], a[32:35], v[48:51]
    ds_read_b64_tr_b16 a[48:49], v8 offset:7168
    v_mul_f32 v35, 0xbfb8aa3b, v35
    v_mul_f32 v36, 0xbfb8aa3b, v36
    v_mul_f32 v37, 0xbfb8aa3b, v37
    v_mfma_f32_16x16x32_bf16 v[52:55], a[52:55], a[36:39], v[52:55]
    ds_read_b64_tr_b16 a[50:51], v8 offset:8960
    v_mul_f32 v38, 0xbfb8aa3b, v38
    v_mul_f32 v39, 0xbfb8aa3b, v39
    v_exp_f32 v32, v32
    v_mfma_f32_16x16x32_bf16 v[56:59], a[52:55], a[40:43], v[56:59]
    v_exp_f32 v33, v33
    v_exp_f32 v34, v34
    v_exp_f32 v35, v35
    v_mfma_f32_16x16x32_bf16 v[60:63], a[52:55], a[44:47], v[60:63]
    v_exp_f32 v36, v36
    v_exp_f32 v37, v37
    v_exp_f32 v38, v38
    s_waitcnt lgkmcnt(4)
    v_mfma_f32_16x16x32_bf16 a[80:83], a[56:59], a[0:3], a[80:83]
    ds_read_b64_tr_b16 a[52:53], v8 offset:27648
    v_exp_f32 v39, v39
    v_add_f32 v32, 1.0, v32
    v_add_f32 v33, 1.0, v33
    v_mfma_f32_16x16x32_bf16 a[84:87], a[56:59], a[4:7], a[84:87]
    ds_read_b64_tr_b16 a[54:55], v8 offset:29440
    v_add_f32 v34, 1.0, v34
    v_add_f32 v35, 1.0, v35
    v_add_f32 v36, 1.0, v36
    v_mfma_f32_16x16x32_bf16 a[88:91], a[56:59], a[8:11], a[88:91]
    v_add_f32 v37, 1.0, v37
    v_add_f32 v38, 1.0, v38
    v_add_f32 v39, 1.0, v39
    v_mfma_f32_16x16x32_bf16 a[92:95], a[56:59], a[12:15], a[92:95]
    v_rcp_f32 v32, v32
    v_rcp_f32 v33, v33
    v_rcp_f32 v34, v34
    s_waitcnt lgkmcnt(4)
    v_mfma_f32_16x16x32_bf16 a[80:83], a[60:63], a[32:35], a[80:83]
    ds_read_b64_tr_b16 a[56:57], v8 offset:14336
    v_rcp_f32 v35, v35
    v_rcp_f32 v36, v36
    v_rcp_f32 v37, v37
    v_mfma_f32_16x16x32_bf16 a[84:87], a[60:63], a[36:39], a[84:87]
    ds_read_b64_tr_b16 a[58:59], v8 offset:16128
    v_rcp_f32 v38, v38
    v_rcp_f32 v39, v39
    v_accvgpr_read_b32 v20, a64
    v_mfma_f32_16x16x32_bf16 a[88:91], a[60:63], a[40:43], a[88:91]
    v_accvgpr_read_b32 v21, a65
    v_accvgpr_read_b32 v22, a66
    v_accvgpr_read_b32 v23, a67
    v_mfma_f32_16x16x32_bf16 a[92:95], a[60:63], a[44:47], a[92:95]
    v_accvgpr_read_b32 v24, a68
    v_accvgpr_read_b32 v25, a69
    v_accvgpr_read_b32 v26, a70
    s_waitcnt lgkmcnt(4)
    v_mfma_f32_16x16x32_bf16 v[64:67], a[48:51], a[0:3], v[64:67]
    ds_read_b64_tr_b16 a[60:61], v8 offset:34816
    v_accvgpr_read_b32 v27, a71
    v_mul_f32 v32, v32, v20
    v_mul_f32 v33, v33, v21
    v_mfma_f32_16x16x32_bf16 v[68:71], a[48:51], a[4:7], v[68:71]
    ds_read_b64_tr_b16 a[62:63], v8 offset:36608
    v_mul_f32 v34, v34, v22
    v_mul_f32 v35, v35, v23
    v_mul_f32 v36, v36, v24
    v_mfma_f32_16x16x32_bf16 v[72:75], a[48:51], a[8:11], v[72:75]
    v_mul_f32 v37, v37, v25
    v_mul_f32 v38, v38, v26
    v_mul_f32 v39, v39, v27
    s_nop 4
    v_mfma_f32_16x16x32_bf16 v[76:79], a[48:51], a[12:15], v[76:79]
    v_cvt_pk_bf16_f32 v32, v32, v33
    v_cvt_pk_bf16_f32 v33, v34, v35
    v_cvt_pk_bf16_f32 v34, v36, v37
    s_waitcnt lgkmcnt(4)
    v_mfma_f32_16x16x32_bf16 v[64:67], a[52:55], a[32:35], v[64:67]
    ds_read_b64_tr_b16 a[48:49], v8 offset:7424
    v_cvt_pk_bf16_f32 v35, v38, v39
    s_nop 1
    v_permlane16_swap_b32 v32, v34
    v_mfma_f32_16x16x32_bf16 v[68:71], a[52:55], a[36:39], v[68:71]
    ds_read_b64_tr_b16 a[50:51], v8 offset:9216
    v_permlane16_swap_b32 v33, v35
    buffer_store_dwordx4 v[32:35], v2, s[24:27], s64 offen offset:0 sc1
    v_mul_f32 v40, 0xbfb8aa3b, v40
    v_mfma_f32_16x16x32_bf16 v[72:75], a[52:55], a[40:43], v[72:75]
    v_mul_f32 v41, 0xbfb8aa3b, v41
    v_mul_f32 v42, 0xbfb8aa3b, v42
    v_mul_f32 v43, 0xbfb8aa3b, v43
    v_mfma_f32_16x16x32_bf16 v[76:79], a[52:55], a[44:47], v[76:79]
    v_mul_f32 v44, 0xbfb8aa3b, v44
    v_mul_f32 v45, 0xbfb8aa3b, v45
    v_mul_f32 v46, 0xbfb8aa3b, v46
    s_waitcnt lgkmcnt(4)
    v_mfma_f32_16x16x32_bf16 a[96:99], a[56:59], a[0:3], a[96:99]
    ds_read_b64_tr_b16 a[52:53], v8 offset:27904
    v_mul_f32 v47, 0xbfb8aa3b, v47
    v_exp_f32 v40, v40
    v_exp_f32 v41, v41
    v_mfma_f32_16x16x32_bf16 a[100:103], a[56:59], a[4:7], a[100:103]
    ds_read_b64_tr_b16 a[54:55], v8 offset:29696
    v_exp_f32 v42, v42
    v_exp_f32 v43, v43
    v_exp_f32 v44, v44
    v_mfma_f32_16x16x32_bf16 a[104:107], a[56:59], a[8:11], a[104:107]
    v_exp_f32 v45, v45
    v_exp_f32 v46, v46
    v_exp_f32 v47, v47
    v_mfma_f32_16x16x32_bf16 a[108:111], a[56:59], a[12:15], a[108:111]
    v_add_f32 v40, 1.0, v40
    v_add_f32 v41, 1.0, v41
    v_add_f32 v42, 1.0, v42
    s_waitcnt lgkmcnt(4)
    v_mfma_f32_16x16x32_bf16 a[96:99], a[60:63], a[32:35], a[96:99]
    ds_read_b64_tr_b16 a[56:57], v8 offset:14592
    v_add_f32 v43, 1.0, v43
    v_add_f32 v44, 1.0, v44
    v_add_f32 v45, 1.0, v45
    v_mfma_f32_16x16x32_bf16 a[100:103], a[60:63], a[36:39], a[100:103]
    ds_read_b64_tr_b16 a[58:59], v8 offset:16384
    v_add_f32 v46, 1.0, v46
    v_add_f32 v47, 1.0, v47
    v_rcp_f32 v40, v40
    v_mfma_f32_16x16x32_bf16 a[104:107], a[60:63], a[40:43], a[104:107]
    v_rcp_f32 v41, v41
    v_rcp_f32 v42, v42
    v_rcp_f32 v43, v43
    v_mfma_f32_16x16x32_bf16 a[108:111], a[60:63], a[44:47], a[108:111]
    v_rcp_f32 v44, v44
    v_rcp_f32 v45, v45
    v_rcp_f32 v46, v46
    s_waitcnt lgkmcnt(4)
    v_mfma_f32_16x16x32_bf16 v[80:83], a[48:51], a[0:3], v[80:83]
    ds_read_b64_tr_b16 a[60:61], v8 offset:35072
    v_rcp_f32 v47, v47
    v_accvgpr_read_b32 v20, a72
    v_accvgpr_read_b32 v21, a73
    v_mfma_f32_16x16x32_bf16 v[84:87], a[48:51], a[4:7], v[84:87]
    ds_read_b64_tr_b16 a[62:63], v8 offset:36864
    v_accvgpr_read_b32 v22, a74
    v_accvgpr_read_b32 v23, a75
    v_accvgpr_read_b32 v24, a76
    v_mfma_f32_16x16x32_bf16 v[88:91], a[48:51], a[8:11], v[88:91]
    v_accvgpr_read_b32 v25, a77
    v_accvgpr_read_b32 v26, a78
    v_accvgpr_read_b32 v27, a79
    s_nop 4
    v_mfma_f32_16x16x32_bf16 v[92:95], a[48:51], a[12:15], v[92:95]
    v_mul_f32 v40, v40, v20
    v_mul_f32 v41, v41, v21
    v_mul_f32 v42, v42, v22
    s_waitcnt lgkmcnt(4)
    v_mfma_f32_16x16x32_bf16 v[80:83], a[52:55], a[32:35], v[80:83]
    ds_read_b64_tr_b16 a[48:49], v8 offset:7680
    v_mul_f32 v43, v43, v23
    v_mul_f32 v44, v44, v24
    v_mul_f32 v45, v45, v25
    v_mfma_f32_16x16x32_bf16 v[84:87], a[52:55], a[36:39], v[84:87]
    ds_read_b64_tr_b16 a[50:51], v8 offset:9472
    v_mul_f32 v46, v46, v26
    v_mul_f32 v47, v47, v27
    v_cvt_pk_bf16_f32 v40, v40, v41
    v_mfma_f32_16x16x32_bf16 v[88:91], a[52:55], a[40:43], v[88:91]
    v_cvt_pk_bf16_f32 v41, v42, v43
    v_cvt_pk_bf16_f32 v42, v44, v45
    v_cvt_pk_bf16_f32 v43, v46, v47
    v_mfma_f32_16x16x32_bf16 v[92:95], a[52:55], a[44:47], v[92:95]
    s_nop 1
    v_permlane16_swap_b32 v40, v42
    v_permlane16_swap_b32 v41, v43
    s_waitcnt lgkmcnt(4)
    v_mfma_f32_16x16x32_bf16 a[112:115], a[56:59], a[0:3], a[112:115]
    ds_read_b64_tr_b16 a[52:53], v8 offset:28160
    buffer_store_dwordx4 v[40:43], v2, s[24:27], s65 offen offset:0 sc1
    v_mul_f32 v48, 0xbfb8aa3b, v48
    v_mul_f32 v49, 0xbfb8aa3b, v49
    v_mfma_f32_16x16x32_bf16 a[116:119], a[56:59], a[4:7], a[116:119]
    ds_read_b64_tr_b16 a[54:55], v8 offset:29952
    v_mul_f32 v50, 0xbfb8aa3b, v50
    v_mul_f32 v51, 0xbfb8aa3b, v51
    v_mul_f32 v52, 0xbfb8aa3b, v52
    v_mfma_f32_16x16x32_bf16 a[120:123], a[56:59], a[8:11], a[120:123]
    v_mul_f32 v53, 0xbfb8aa3b, v53
    v_mul_f32 v54, 0xbfb8aa3b, v54
    v_mul_f32 v55, 0xbfb8aa3b, v55
    v_mfma_f32_16x16x32_bf16 a[124:127], a[56:59], a[12:15], a[124:127]
    v_exp_f32 v48, v48
    v_exp_f32 v49, v49
    v_exp_f32 v50, v50
    s_waitcnt lgkmcnt(4)
    v_mfma_f32_16x16x32_bf16 a[112:115], a[60:63], a[32:35], a[112:115]
    ds_read_b64_tr_b16 a[56:57], v8 offset:14848
    v_exp_f32 v51, v51
    v_exp_f32 v52, v52
    v_exp_f32 v53, v53
    v_mfma_f32_16x16x32_bf16 a[116:119], a[60:63], a[36:39], a[116:119]
    ds_read_b64_tr_b16 a[58:59], v8 offset:16640
    v_exp_f32 v54, v54
    v_exp_f32 v55, v55
    v_add_f32 v48, 1.0, v48
    v_mfma_f32_16x16x32_bf16 a[120:123], a[60:63], a[40:43], a[120:123]
    v_add_f32 v49, 1.0, v49
    v_add_f32 v50, 1.0, v50
    v_add_f32 v51, 1.0, v51
    v_mfma_f32_16x16x32_bf16 a[124:127], a[60:63], a[44:47], a[124:127]
    v_add_f32 v52, 1.0, v52
    v_add_f32 v53, 1.0, v53
    v_add_f32 v54, 1.0, v54
    s_waitcnt lgkmcnt(4)
    v_mfma_f32_16x16x32_bf16 v[96:99], a[48:51], a[0:3], v[96:99]
    ds_read_b64_tr_b16 a[60:61], v8 offset:35328
    v_add_f32 v55, 1.0, v55
    v_rcp_f32 v48, v48
    v_rcp_f32 v49, v49
    v_mfma_f32_16x16x32_bf16 v[100:103], a[48:51], a[4:7], v[100:103]
    ds_read_b64_tr_b16 a[62:63], v8 offset:37120
    v_rcp_f32 v50, v50
    v_rcp_f32 v51, v51
    v_rcp_f32 v52, v52
    v_mfma_f32_16x16x32_bf16 v[104:107], a[48:51], a[8:11], v[104:107]
    v_rcp_f32 v53, v53
    v_rcp_f32 v54, v54
    v_rcp_f32 v55, v55
    s_nop 4
    v_mfma_f32_16x16x32_bf16 v[108:111], a[48:51], a[12:15], v[108:111]
    v_accvgpr_read_b32 v20, a80
    v_accvgpr_read_b32 v21, a81
    v_accvgpr_read_b32 v22, a82
    s_waitcnt lgkmcnt(4)
    v_mfma_f32_16x16x32_bf16 v[96:99], a[52:55], a[32:35], v[96:99]
    v_accvgpr_read_b32 v23, a83
    v_accvgpr_read_b32 v24, a84
    v_accvgpr_read_b32 v25, a85
    v_mfma_f32_16x16x32_bf16 v[100:103], a[52:55], a[36:39], v[100:103]
    v_accvgpr_read_b32 v26, a86
    v_accvgpr_read_b32 v27, a87
    v_mul_f32 v48, v48, v20
    v_mfma_f32_16x16x32_bf16 v[104:107], a[52:55], a[40:43], v[104:107]
    v_mul_f32 v49, v49, v21
    v_mul_f32 v50, v50, v22
    v_mul_f32 v51, v51, v23
    v_mfma_f32_16x16x32_bf16 v[108:111], a[52:55], a[44:47], v[108:111]
    v_mul_f32 v52, v52, v24
    v_mul_f32 v53, v53, v25
    v_mul_f32 v54, v54, v26
    s_waitcnt lgkmcnt(2)
    v_mfma_f32_16x16x32_bf16 v[112:115], a[56:59], a[0:3], v[112:115]
    v_mul_f32 v55, v55, v27
    v_cvt_pk_bf16_f32 v48, v48, v49
    v_cvt_pk_bf16_f32 v49, v50, v51
    v_mfma_f32_16x16x32_bf16 v[116:119], a[56:59], a[4:7], v[116:119]
    v_cvt_pk_bf16_f32 v50, v52, v53
    v_cvt_pk_bf16_f32 v51, v54, v55
    s_nop 1
    v_mfma_f32_16x16x32_bf16 v[120:123], a[56:59], a[8:11], v[120:123]
    v_permlane16_swap_b32 v48, v50
    v_permlane16_swap_b32 v49, v51
    buffer_store_dwordx4 v[48:51], v2, s[24:27], s64 offen offset:1024 sc1
    v_mfma_f32_16x16x32_bf16 v[124:127], a[56:59], a[12:15], v[124:127]
    v_mul_f32 v56, 0xbfb8aa3b, v56
    v_mul_f32 v57, 0xbfb8aa3b, v57
    v_mul_f32 v58, 0xbfb8aa3b, v58
    s_waitcnt lgkmcnt(0)
    v_mfma_f32_16x16x32_bf16 v[112:115], a[60:63], a[32:35], v[112:115]
    v_mul_f32 v59, 0xbfb8aa3b, v59
    v_mul_f32 v60, 0xbfb8aa3b, v60
    v_mul_f32 v61, 0xbfb8aa3b, v61
    v_mfma_f32_16x16x32_bf16 v[116:119], a[60:63], a[36:39], v[116:119]
    v_mul_f32 v62, 0xbfb8aa3b, v62
    v_mul_f32 v63, 0xbfb8aa3b, v63
    v_exp_f32 v56, v56
    v_mfma_f32_16x16x32_bf16 v[120:123], a[60:63], a[40:43], v[120:123]
    v_exp_f32 v57, v57
    v_exp_f32 v58, v58
    v_exp_f32 v59, v59
    v_mfma_f32_16x16x32_bf16 v[124:127], a[60:63], a[44:47], v[124:127]
    v_exp_f32 v60, v60
    v_exp_f32 v61, v61
    v_exp_f32 v62, v62
    s_barrier
    s_sub_u32 s75, s28, 4
    s_and_b32 s34, s2, 7
    s_lshr_b32 s35, s2, 3
    s_lshr_b32 s73, s34, 1
    s_lshl_b32 s73, s73, 2
    s_and_b32 s36, s35, 3
    s_add_u32 s73, s73, s36
    s_and_b32 s74, s34, 1
    s_lshl_b32 s74, s74, 3
    s_lshr_b32 s36, s35, 2
    s_add_u32 s74, s74, s36
    s_lshl_b32 s34, s74, 7
    s_add_u32 s48, s16, s34
    s_addc_u32 s49, s17, 0
    s_and_b32 s49, s49, 0xffff
    s_sub_u32 s50, 7340032, s34
    s_mov_b32 s51, 0x00020000
    s_add_u32 s52, s8, s34
    s_addc_u32 s53, s9, 0
    s_and_b32 s53, s53, 0xffff
    s_sub_u32 s54, 2097152, s34
    s_mov_b32 s55, 0x00020000
    v_bfe_u32 v13, v1, 3, 2
    v_lshrrev_b32 v12, 5, v1
    v_lshl_add_u32 v13, v12, 3, v13
    s_lshl_b32 s36, s75, 5
    v_add_u32 v13, s36, v13
    v_lshlrev_b32 v3, 11, v13
    v_lshrrev_b32 v13, 3, v1
    v_xor_b32 v13, v13, v1
    v_bfe_u32 v13, v13, 1, 2
    v_lshl_add_u32 v3, v13, 5, v3
    v_and_b32 v13, 1, v1
    v_lshl_add_u32 v3, v13, 4, v3
    s_lshl_b32 s77, s75, 12
    s_add_u32 s77, s77, 40960
    s_mov_b32 s62, s77
    s_add_u32 s78, s77, 114688
    s_mov_b32 s60, 0
    v_exp_f32 v63, v63
    v_add_f32 v56, 1.0, v56
    v_add_f32 v57, 1.0, v57
    v_add_f32 v58, 1.0, v58
    v_add_f32 v59, 1.0, v59
    v_add_f32 v60, 1.0, v60
    v_add_f32 v61, 1.0, v61
    v_add_f32 v62, 1.0, v62
    v_add_f32 v63, 1.0, v63
    v_rcp_f32 v56, v56
    v_rcp_f32 v57, v57
    v_rcp_f32 v58, v58
    v_rcp_f32 v59, v59
    v_rcp_f32 v60, v60
    v_rcp_f32 v61, v61
    v_rcp_f32 v62, v62
    v_rcp_f32 v63, v63
    v_accvgpr_read_b32 v20, a88
    v_accvgpr_read_b32 v21, a89
    v_accvgpr_read_b32 v22, a90
    v_accvgpr_read_b32 v23, a91
    v_accvgpr_read_b32 v24, a92
    v_accvgpr_read_b32 v25, a93
    v_accvgpr_read_b32 v26, a94
    v_accvgpr_read_b32 v27, a95
    v_mul_f32 v56, v56, v20
    v_mul_f32 v57, v57, v21
    v_mul_f32 v58, v58, v22
    v_mul_f32 v59, v59, v23
    v_mul_f32 v60, v60, v24
    v_mul_f32 v61, v61, v25
    v_mul_f32 v62, v62, v26
    v_mul_f32 v63, v63, v27
    v_cvt_pk_bf16_f32 v56, v56, v57
    v_cvt_pk_bf16_f32 v57, v58, v59
    v_cvt_pk_bf16_f32 v58, v60, v61
    v_cvt_pk_bf16_f32 v59, v62, v63
    s_nop 1
    v_permlane16_swap_b32 v56, v58
    v_permlane16_swap_b32 v57, v59
    buffer_store_dwordx4 v[56:59], v2, s[24:27], s65 offen offset:1024 sc1
    v_mul_f32 v64, 0xbfb8aa3b, v64
    v_mul_f32 v65, 0xbfb8aa3b, v65
    v_mul_f32 v66, 0xbfb8aa3b, v66
    v_mul_f32 v67, 0xbfb8aa3b, v67
    v_mul_f32 v68, 0xbfb8aa3b, v68
    v_mul_f32 v69, 0xbfb8aa3b, v69
    v_mul_f32 v70, 0xbfb8aa3b, v70
    v_mul_f32 v71, 0xbfb8aa3b, v71
    v_exp_f32 v64, v64
    v_exp_f32 v65, v65
    v_exp_f32 v66, v66
    v_exp_f32 v67, v67
    v_exp_f32 v68, v68
    v_exp_f32 v69, v69
    v_exp_f32 v70, v70
    v_exp_f32 v71, v71
    v_add_f32 v64, 1.0, v64
    v_add_f32 v65, 1.0, v65
    v_add_f32 v66, 1.0, v66
    v_add_f32 v67, 1.0, v67
    v_add_f32 v68, 1.0, v68
    v_add_f32 v69, 1.0, v69
    v_add_f32 v70, 1.0, v70
    v_add_f32 v71, 1.0, v71
    v_rcp_f32 v64, v64
    v_rcp_f32 v65, v65
    v_rcp_f32 v66, v66
    v_rcp_f32 v67, v67
    v_rcp_f32 v68, v68
    v_rcp_f32 v69, v69
    v_rcp_f32 v70, v70
    v_rcp_f32 v71, v71
    v_accvgpr_read_b32 v20, a96
    v_accvgpr_read_b32 v21, a97
    v_accvgpr_read_b32 v22, a98
    v_accvgpr_read_b32 v23, a99
    v_accvgpr_read_b32 v24, a100
    v_accvgpr_read_b32 v25, a101
    v_accvgpr_read_b32 v26, a102
    v_accvgpr_read_b32 v27, a103
    v_mul_f32 v64, v64, v20
    v_mul_f32 v65, v65, v21
    v_mul_f32 v66, v66, v22
    v_mul_f32 v67, v67, v23
    v_mul_f32 v68, v68, v24
    v_mul_f32 v69, v69, v25
    v_mul_f32 v70, v70, v26
    v_mul_f32 v71, v71, v27
    v_cvt_pk_bf16_f32 v64, v64, v65
    v_cvt_pk_bf16_f32 v65, v66, v67
    v_cvt_pk_bf16_f32 v66, v68, v69
    v_cvt_pk_bf16_f32 v67, v70, v71
    s_nop 1
    v_permlane16_swap_b32 v64, v66
    v_permlane16_swap_b32 v65, v67
    buffer_store_dwordx4 v[64:67], v2, s[24:27], s64 offen offset:2048 sc1
    v_mul_f32 v72, 0xbfb8aa3b, v72
    v_mul_f32 v73, 0xbfb8aa3b, v73
    v_mul_f32 v74, 0xbfb8aa3b, v74
    v_mul_f32 v75, 0xbfb8aa3b, v75
    v_mul_f32 v76, 0xbfb8aa3b, v76
    v_mul_f32 v77, 0xbfb8aa3b, v77
    v_mul_f32 v78, 0xbfb8aa3b, v78
    v_mul_f32 v79, 0xbfb8aa3b, v79
    v_exp_f32 v72, v72
    v_exp_f32 v73, v73
    v_exp_f32 v74, v74
    v_exp_f32 v75, v75
    v_exp_f32 v76, v76
    v_exp_f32 v77, v77
    v_exp_f32 v78, v78
    v_exp_f32 v79, v79
    v_add_f32 v72, 1.0, v72
    v_add_f32 v73, 1.0, v73
    v_add_f32 v74, 1.0, v74
    v_add_f32 v75, 1.0, v75
    v_add_f32 v76, 1.0, v76
    v_add_f32 v77, 1.0, v77
    v_add_f32 v78, 1.0, v78
    v_add_f32 v79, 1.0, v79
    v_rcp_f32 v72, v72
    v_rcp_f32 v73, v73
    v_rcp_f32 v74, v74
    v_rcp_f32 v75, v75
    v_rcp_f32 v76, v76
    v_rcp_f32 v77, v77
    v_rcp_f32 v78, v78
    v_rcp_f32 v79, v79
    v_accvgpr_read_b32 v20, a104
    v_accvgpr_read_b32 v21, a105
    v_accvgpr_read_b32 v22, a106
    v_accvgpr_read_b32 v23, a107
    v_accvgpr_read_b32 v24, a108
    v_accvgpr_read_b32 v25, a109
    v_accvgpr_read_b32 v26, a110
    v_accvgpr_read_b32 v27, a111
    v_mul_f32 v72, v72, v20
    v_mul_f32 v73, v73, v21
    v_mul_f32 v74, v74, v22
    v_mul_f32 v75, v75, v23
    v_mul_f32 v76, v76, v24
    v_mul_f32 v77, v77, v25
    v_mul_f32 v78, v78, v26
    v_mul_f32 v79, v79, v27
    v_cvt_pk_bf16_f32 v72, v72, v73
    v_cvt_pk_bf16_f32 v73, v74, v75
    v_cvt_pk_bf16_f32 v74, v76, v77
    v_cvt_pk_bf16_f32 v75, v78, v79
    s_nop 1
    v_permlane16_swap_b32 v72, v74
    v_permlane16_swap_b32 v73, v75
    buffer_store_dwordx4 v[72:75], v2, s[24:27], s65 offen offset:2048 sc1
    v_mul_f32 v80, 0xbfb8aa3b, v80
    v_mul_f32 v81, 0xbfb8aa3b, v81
    v_mul_f32 v82, 0xbfb8aa3b, v82
    v_mul_f32 v83, 0xbfb8aa3b, v83
    v_mul_f32 v84, 0xbfb8aa3b, v84
    v_mul_f32 v85, 0xbfb8aa3b, v85
    v_mul_f32 v86, 0xbfb8aa3b, v86
    v_mul_f32 v87, 0xbfb8aa3b, v87
    v_exp_f32 v80, v80
    v_exp_f32 v81, v81
    v_exp_f32 v82, v82
    v_exp_f32 v83, v83
    v_exp_f32 v84, v84
    v_exp_f32 v85, v85
    v_exp_f32 v86, v86
    v_exp_f32 v87, v87
    v_add_f32 v80, 1.0, v80
    v_add_f32 v81, 1.0, v81
    v_add_f32 v82, 1.0, v82
    v_add_f32 v83, 1.0, v83
    v_add_f32 v84, 1.0, v84
    v_add_f32 v85, 1.0, v85
    v_add_f32 v86, 1.0, v86
    v_add_f32 v87, 1.0, v87
    v_rcp_f32 v80, v80
    v_rcp_f32 v81, v81
    v_rcp_f32 v82, v82
    v_rcp_f32 v83, v83
    v_rcp_f32 v84, v84
    v_rcp_f32 v85, v85
    v_rcp_f32 v86, v86
    v_rcp_f32 v87, v87
    v_accvgpr_read_b32 v20, a112
    v_accvgpr_read_b32 v21, a113
    v_accvgpr_read_b32 v22, a114
    v_accvgpr_read_b32 v23, a115
    v_accvgpr_read_b32 v24, a116
    v_accvgpr_read_b32 v25, a117
    v_accvgpr_read_b32 v26, a118
    v_accvgpr_read_b32 v27, a119
    v_mul_f32 v80, v80, v20
    v_mul_f32 v81, v81, v21
    v_mul_f32 v82, v82, v22
    v_mul_f32 v83, v83, v23
    v_mul_f32 v84, v84, v24
    v_mul_f32 v85, v85, v25
    v_mul_f32 v86, v86, v26
    v_mul_f32 v87, v87, v27
    v_cvt_pk_bf16_f32 v80, v80, v81
    v_cvt_pk_bf16_f32 v81, v82, v83
    v_cvt_pk_bf16_f32 v82, v84, v85
    v_cvt_pk_bf16_f32 v83, v86, v87
    s_nop 1
    v_permlane16_swap_b32 v80, v82
    v_permlane16_swap_b32 v81, v83
    buffer_store_dwordx4 v[80:83], v2, s[24:27], s64 offen offset:3072 sc1
    v_mul_f32 v88, 0xbfb8aa3b, v88
    v_mul_f32 v89, 0xbfb8aa3b, v89
    v_mul_f32 v90, 0xbfb8aa3b, v90
    v_mul_f32 v91, 0xbfb8aa3b, v91
    v_mul_f32 v92, 0xbfb8aa3b, v92
    v_mul_f32 v93, 0xbfb8aa3b, v93
    v_mul_f32 v94, 0xbfb8aa3b, v94
    v_mul_f32 v95, 0xbfb8aa3b, v95
    v_exp_f32 v88, v88
    v_exp_f32 v89, v89
    v_exp_f32 v90, v90
    v_exp_f32 v91, v91
    v_exp_f32 v92, v92
    v_exp_f32 v93, v93
    v_exp_f32 v94, v94
    v_exp_f32 v95, v95
    v_add_f32 v88, 1.0, v88
    v_add_f32 v89, 1.0, v89
    v_add_f32 v90, 1.0, v90
    v_add_f32 v91, 1.0, v91
    v_add_f32 v92, 1.0, v92
    v_add_f32 v93, 1.0, v93
    v_add_f32 v94, 1.0, v94
    v_add_f32 v95, 1.0, v95
    v_rcp_f32 v88, v88
    v_rcp_f32 v89, v89
    v_rcp_f32 v90, v90
    v_rcp_f32 v91, v91
    v_rcp_f32 v92, v92
    v_rcp_f32 v93, v93
    v_rcp_f32 v94, v94
    v_rcp_f32 v95, v95
    v_accvgpr_read_b32 v20, a120
    v_accvgpr_read_b32 v21, a121
    v_accvgpr_read_b32 v22, a122
    v_accvgpr_read_b32 v23, a123
    v_accvgpr_read_b32 v24, a124
    v_accvgpr_read_b32 v25, a125
    v_accvgpr_read_b32 v26, a126
    v_accvgpr_read_b32 v27, a127
    v_mul_f32 v88, v88, v20
    v_mul_f32 v89, v89, v21
    v_mul_f32 v90, v90, v22
    v_mul_f32 v91, v91, v23
    v_mul_f32 v92, v92, v24
    v_mul_f32 v93, v93, v25
    v_mul_f32 v94, v94, v26
    v_mul_f32 v95, v95, v27
    v_cvt_pk_bf16_f32 v88, v88, v89
    v_cvt_pk_bf16_f32 v89, v90, v91
    v_cvt_pk_bf16_f32 v90, v92, v93
    v_cvt_pk_bf16_f32 v91, v94, v95
    s_nop 1
    v_permlane16_swap_b32 v88, v90
    v_permlane16_swap_b32 v89, v91
    buffer_store_dwordx4 v[88:91], v2, s[24:27], s65 offen offset:3072 sc1
    v_mul_f32 v96, 0xbfb8aa3b, v96
    v_mul_f32 v97, 0xbfb8aa3b, v97
    v_mul_f32 v98, 0xbfb8aa3b, v98
    v_mul_f32 v99, 0xbfb8aa3b, v99
    v_mul_f32 v100, 0xbfb8aa3b, v100
    v_mul_f32 v101, 0xbfb8aa3b, v101
    v_mul_f32 v102, 0xbfb8aa3b, v102
    v_mul_f32 v103, 0xbfb8aa3b, v103
    v_exp_f32 v96, v96
    v_exp_f32 v97, v97
    v_exp_f32 v98, v98
    v_exp_f32 v99, v99
    v_exp_f32 v100, v100
    v_exp_f32 v101, v101
    v_exp_f32 v102, v102
    v_exp_f32 v103, v103
    v_add_f32 v96, 1.0, v96
    v_add_f32 v97, 1.0, v97
    v_add_f32 v98, 1.0, v98
    v_add_f32 v99, 1.0, v99
    v_add_f32 v100, 1.0, v100
    v_add_f32 v101, 1.0, v101
    v_add_f32 v102, 1.0, v102
    v_add_f32 v103, 1.0, v103
    v_rcp_f32 v96, v96
    v_rcp_f32 v97, v97
    v_rcp_f32 v98, v98
    v_rcp_f32 v99, v99
    v_rcp_f32 v100, v100
    v_rcp_f32 v101, v101
    v_rcp_f32 v102, v102
    v_rcp_f32 v103, v103
    v_mul_f32 v96, v96, v112
    v_mul_f32 v97, v97, v113
    v_mul_f32 v98, v98, v114
    v_mul_f32 v99, v99, v115
    v_mul_f32 v100, v100, v116
    v_mul_f32 v101, v101, v117
    v_mul_f32 v102, v102, v118
    v_mul_f32 v103, v103, v119
    v_cvt_pk_bf16_f32 v96, v96, v97
    v_cvt_pk_bf16_f32 v97, v98, v99
    v_cvt_pk_bf16_f32 v98, v100, v101
    v_cvt_pk_bf16_f32 v99, v102, v103
    s_nop 1
    v_permlane16_swap_b32 v96, v98
    v_permlane16_swap_b32 v97, v99
    buffer_store_dwordx4 v[96:99], v2, s[24:27], s66 offen offset:0 sc1
    v_mul_f32 v104, 0xbfb8aa3b, v104
    v_mul_f32 v105, 0xbfb8aa3b, v105
    v_mul_f32 v106, 0xbfb8aa3b, v106
    v_mul_f32 v107, 0xbfb8aa3b, v107
    v_mul_f32 v108, 0xbfb8aa3b, v108
    v_mul_f32 v109, 0xbfb8aa3b, v109
    v_mul_f32 v110, 0xbfb8aa3b, v110
    v_mul_f32 v111, 0xbfb8aa3b, v111
    v_exp_f32 v104, v104
    v_exp_f32 v105, v105
    v_exp_f32 v106, v106
    v_exp_f32 v107, v107
    v_exp_f32 v108, v108
    v_exp_f32 v109, v109
    v_exp_f32 v110, v110
    v_exp_f32 v111, v111
    v_add_f32 v104, 1.0, v104
    v_add_f32 v105, 1.0, v105
    v_add_f32 v106, 1.0, v106
    v_add_f32 v107, 1.0, v107
    v_add_f32 v108, 1.0, v108
    v_add_f32 v109, 1.0, v109
    v_add_f32 v110, 1.0, v110
    v_add_f32 v111, 1.0, v111
    v_rcp_f32 v104, v104
    v_rcp_f32 v105, v105
    v_rcp_f32 v106, v106
    v_rcp_f32 v107, v107
    v_rcp_f32 v108, v108
    v_rcp_f32 v109, v109
    v_rcp_f32 v110, v110
    v_rcp_f32 v111, v111
    v_mul_f32 v104, v104, v120
    v_mul_f32 v105, v105, v121
    v_mul_f32 v106, v106, v122
    v_mul_f32 v107, v107, v123
    v_mul_f32 v108, v108, v124
    v_mul_f32 v109, v109, v125
    v_mul_f32 v110, v110, v126
    v_mul_f32 v111, v111, v127
    v_cvt_pk_bf16_f32 v104, v104, v105
    v_cvt_pk_bf16_f32 v105, v106, v107
    v_cvt_pk_bf16_f32 v106, v108, v109
    v_cvt_pk_bf16_f32 v107, v110, v111
    s_nop 1
    v_permlane16_swap_b32 v104, v106
    v_permlane16_swap_b32 v105, v107
    buffer_store_dwordx4 v[104:107], v2, s[24:27], s67 offen offset:0 sc1
    s_waitcnt vmcnt(0)
    v_mov_b32 v12, 156676
    v_mov_b32 v13, 1
    s_mov_b64 exec, 1
    ds_add_rtn_u32 v14, v12, v13
    s_mov_b64 exec, -1
    s_lshl_b32 s34, s29, 5
    s_add_u32 s34, s34, s30
    s_lshl_b32 s34, s34, 3
    s_add_u32 s34, s34, 41951232
    s_waitcnt lgkmcnt(0)
    v_readfirstlane_b32 s35, v14
    s_cmp_lg_u32 s35, 7
    s_cbranch_scc1 L_mega_kernel_na_88
    v_mov_b32 v12, s32
    v_mov_b32 v13, s33
    v_mov_b32 v14, 0
    s_mov_b64 exec, 1
    buffer_store_dwordx2 v[12:13], v14, s[24:27], s34 offen sc1
    s_mov_b64 exec, -1
L_mega_kernel_na_88:
    s_add_u32 m0, s62, 0
    s_nop 0
    buffer_load_dwordx4 v3, s[48:51], s60 offen lds
    s_add_u32 s60, s60, 8192
    s_add_u32 m0, s62, 1024
    s_nop 0
    buffer_load_dwordx4 v3, s[48:51], s60 offen lds
    s_add_u32 s60, s60, 24576
    s_add_u32 m0, s62, 2048
    s_nop 0
    buffer_load_dwordx4 v3, s[48:51], s60 offen lds
    s_add_u32 s60, s60, 8192
    s_add_u32 m0, s62, 3072
    s_nop 0
    buffer_load_dwordx4 v3, s[48:51], s60 offen lds
    s_add_u32 s60, s60, 221184
    s_add_u32 s62, s62, 16384
    s_cmp_ge_u32 s62, s78
    s_cselect_b32 s62, s77, s62
    s_add_u32 m0, s62, 0
    s_nop 0
    buffer_load_dwordx4 v3, s[48:51], s60 offen lds
    s_add_u32 s60, s60, 8192
    s_add_u32 m0, s62, 1024
    s_nop 0
    buffer_load_dwordx4 v3, s[48:51], s60 offen lds
    s_add_u32 s60, s60, 24576
    s_add_u32 m0, s62, 2048
    s_nop 0
    buffer_load_dwordx4 v3, s[48:51], s60 offen lds
    s_add_u32 s60, s60, 8192
    s_add_u32 m0, s62, 3072
    s_nop 0
    buffer_load_dwordx4 v3, s[48:51], s60 offen lds
    s_add_u32 s60, s60, 221184
    s_add_u32 s62, s62, 16384
    s_cmp_ge_u32 s62, s78
    s_cselect_b32 s62, s77, s62
    s_add_u32 m0, s62, 0
    s_nop 0
    buffer_load_dwordx4 v3, s[48:51], s60 offen lds
    s_add_u32 s60, s60, 8192
    s_add_u32 m0, s62, 1024
    s_nop 0
    buffer_load_dwordx4 v3, s[48:51], s60 offen lds
    s_add_u32 s60, s60, 24576
    s_add_u32 m0, s62, 2048
    s_nop 0
    buffer_load_dwordx4 v3, s[48:51], s60 offen lds
    s_add_u32 s60, s60, 8192
    s_add_u32 m0, s62, 3072
    s_nop 0
    buffer_load_dwordx4 v3, s[48:51], s60 offen lds
    s_add_u32 s60, s60, 221184
    s_add_u32 s62, s62, 16384
    s_cmp_ge_u32 s62, s78
    s_cselect_b32 s62, s77, s62
    s_add_u32 m0, s62, 0
    s_nop 0
    buffer_load_dwordx4 v3, s[48:51], s60 offen lds
    s_add_u32 s60, s60, 8192
    s_add_u32 m0, s62, 1024
    s_nop 0
    buffer_load_dwordx4 v3, s[48:51], s60 offen lds
    s_add_u32 s60, s60, 24576
    s_add_u32 m0, s62, 2048
    s_nop 0
    buffer_load_dwordx4 v3, s[48:51], s60 offen lds
    s_add_u32 s60, s60, 8192
    s_add_u32 m0, s62, 3072
    s_nop 0
    buffer_load_dwordx4 v3, s[48:51], s60 offen lds
    s_add_u32 s60, s60, 221184
    s_add_u32 s62, s62, 16384
    s_cmp_ge_u32 s62, s78
    s_cselect_b32 s62, s77, s62
    s_add_u32 m0, s62, 0
    s_nop 0
    buffer_load_dwordx4 v3, s[48:51], s60 offen lds
    s_add_u32 s60, s60, 8192
    s_add_u32 m0, s62, 1024
    s_nop 0
    buffer_load_dwordx4 v3, s[48:51], s60 offen lds
    s_add_u32 s60, s60, 24576
    s_add_u32 m0, s62, 2048
    s_nop 0
    buffer_load_dwordx4 v3, s[48:51], s60 offen lds
    s_add_u32 s60, s60, 8192
    s_add_u32 m0, s62, 3072
    s_nop 0
    buffer_load_dwordx4 v3, s[48:51], s60 offen lds
    s_add_u32 s60, s60, 221184
    s_add_u32 s62, s62, 16384
    s_cmp_ge_u32 s62, s78
    s_cselect_b32 s62, s77, s62
    s_lshl_b32 s35, s73, 2
    s_add_u32 s35, s35, s75
    s_mul_i32 s36, s35, 294912
    s_add_u32 s36, s36, 20971520
    s_add_u32 s56, s22, s36
    s_addc_u32 s57, s23, 0
    s_and_b32 s57, s57, 0xffff
    s_mov_b32 s58, 229376
    s_mov_b32 s59, 0x00020000
    s_mov_b32 s61, 0
    s_mov_b32 s63, 0
    s_mov_b32 s76, 0
    s_mov_b32 s80, 4294868992
    s_mov_b32 s81, 16384
    v_lshrrev_b32 v12, 5, v1
    v_lshlrev_b32 v104, 11, v12
    v_add_u32 v104, 40960, v104
    v_bfe_u32 v13, v1, 2, 3
    v_lshl_add_u32 v104, v13, 7, v104
    v_bfe_u32 v13, v1, 3, 2
    v_lshl_add_u32 v104, v13, 5, v104
    v_and_b32 v13, 3, v1
    v_lshl_add_u32 v104, v13, 3, v104
    v_xor_b32 v105, 32, v104
    v_xor_b32 v106, 64, v104
    v_xor_b32 v107, 0x60, v104
    v_and_b32 v13, 31, v1
    v_lshlrev_b32 v6, 3, v13
    v_lshrrev_b32 v12, 4, v1
    v_and_b32 v13, 15, v1
    v_lshlrev_b32 v4, 9, v12
    v_lshl_add_u32 v4, v13, 4, v4
    v_mul_u32_u24 v5, 272, v13
    v_lshl_add_u32 v5, v12, 4, v5
    s_mul_i32 s34, s75, 8704
    s_add_u32 s34, s34, 40960
    v_add_u32 v5, s34, v5
    v_and_b32 v13, 3, v1
    v_lshlrev_b32 v13, 2, v13
    v_add_u32 v9, 156720, v13
    s_lshl_b32 s35, s75, 2
    s_add_u32 s35, s35, 156720
    v_mov_b32 v10, s35
    v_mov_b32 v11, 2
    v_mov_b32 v16, 0
    v_mov_b32 v17, 0
    v_mov_b32 v18, 0
    v_mov_b32 v19, 0
    v_mov_b32 v20, 0
    v_mov_b32 v21, 0
    v_mov_b32 v22, 0
    v_mov_b32 v23, 0
    v_mov_b32 v24, 0
    v_mov_b32 v25, 0
    v_mov_b32 v26, 0
    v_mov_b32 v27, 0
    v_mov_b32 v28, 0
    v_mov_b32 v29, 0
    v_mov_b32 v30, 0
    v_mov_b32 v31, 0
    v_mov_b32 v32, 0
    v_mov_b32 v33, 0
    v_mov_b32 v34, 0
    v_mov_b32 v35, 0
    v_mov_b32 v36, 0
    v_mov_b32 v37, 0
    v_mov_b32 v38, 0
    v_mov_b32 v39, 0
    v_mov_b32 v40, 0
    v_mov_b32 v41, 0
    v_mov_b32 v42, 0
    v_mov_b32 v43, 0
    v_mov_b32 v44, 0
    v_mov_b32 v45, 0
    v_mov_b32 v46, 0
    v_mov_b32 v47, 0
    s_lshr_b32 s34, s73, 1
    s_lshl_b32 s34, s34, 8
    s_add_u32 s34, s34, 41951232
    v_add_u32 v6, s34, v6
    s_lshr_b32 s36, s75, 1
    s_lshl_b32 s36, s36, 2
    s_add_u32 s36, s36, 156680
    v_mov_b32 v100, s36
    s_mov_b32 s40, s4
    s_and_b32 s41, s5, 0xffff
    s_mov_b32 s42, 4194304
    s_mov_b32 s43, 0x00020000
    s_mov_b32 s44, s18
    s_and_b32 s45, s19, 0xffff
    s_mov_b32 s46, 4194304
    s_mov_b32 s47, 0x00020000
    s_mov_b32 s64, 0x32232223
    s_mov_b32 s65, 0x00000022
    s_mov_b32 s68, 9
    v_and_b32 v12, 3, v1
    v_lshlrev_b32 v12, 2, v12
    v_add_u32 v12, 156704, v12
    s_mov_b32 s31, 1048576
    L_qw:
    ds_read_b32 v13, v12
    s_waitcnt lgkmcnt(0)
    v_cmp_eq_u32 vcc, 0, v13
    s_sub_u32 s31, s31, 1
    s_cbranch_scc1 L_qwd
    s_cbranch_vccnz L_qw
    L_qwd:
    s_mov_b32 s66, 0x0000007f
    s_mov_b32 s67, 0x00000000
    s_mov_b32 s31, 131072
L_mega_kernel_fretry_90:
    buffer_load_dwordx2 v[96:97], v6, s[24:27], 0 offen sc1
    s_waitcnt vmcnt(0)
    v_cmp_ne_u64 vcc, s[32:33], v[96:97]
    v_mov_b32 v98, v96
    v_mov_b32 v99, v97
    s_sub_u32 s31, s31, 1
    s_cbranch_scc1 L_mega_kernel_fok_89
    s_and_b32 s69, vcc_lo, s66
    s_cbranch_scc1 L_mega_kernel_fretry_90
L_mega_kernel_fok_89:
    ds_write_b32 v10, v11
    buffer_load_dwordx4 a[0:3], v4, s[56:59], s61 offen offset:0 sc1
    buffer_load_dwordx4 a[4:7], v4, s[56:59], s61 offen offset:256 sc1
    s_add_u32 s61, s61, 2048
    buffer_load_dwordx4 a[8:11], v4, s[56:59], s61 offen offset:0 sc1
    buffer_load_dwordx4 a[12:15], v4, s[56:59], s61 offen offset:256 sc1
    s_add_u32 s61, s61, 2048
    buffer_load_dwordx4 a[16:19], v4, s[56:59], s61 offen offset:0 sc1
    buffer_load_dwordx4 a[20:23], v4, s[56:59], s61 offen offset:256 sc1
    s_add_u32 s61, s61, 2048
    buffer_load_dwordx4 a[24:27], v4, s[56:59], s61 offen offset:0 sc1
    buffer_load_dwordx4 a[28:31], v4, s[56:59], s61 offen offset:256 sc1
    s_add_u32 s61, s61, 2048
    buffer_load_dwordx4 a[32:35], v4, s[56:59], s61 offen offset:0 sc1
    buffer_load_dwordx4 a[36:39], v4, s[56:59], s61 offen offset:256 sc1
    s_add_u32 s61, s61, 2048
    buffer_load_dwordx4 a[40:43], v4, s[56:59], s61 offen offset:0 sc1
    buffer_load_dwordx4 a[44:47], v4, s[56:59], s61 offen offset:256 sc1
    s_add_u32 s61, s61, 2048
    buffer_load_dwordx4 a[48:51], v4, s[56:59], s61 offen offset:0 sc1
    buffer_load_dwordx4 a[52:55], v4, s[56:59], s61 offen offset:256 sc1
    s_add_u32 s61, s61, 2048
    buffer_load_dwordx4 a[56:59], v4, s[56:59], s61 offen offset:0 sc1
    buffer_load_dwordx4 a[60:63], v4, s[56:59], s61 offen offset:256 sc1
    s_add_u32 s61, s61, 2048
    buffer_load_dwordx4 a[64:67], v4, s[56:59], s61 offen offset:0 sc1
    buffer_load_dwordx4 a[68:71], v4, s[56:59], s61 offen offset:256 sc1
    s_add_u32 s61, s61, 2048
    buffer_load_dwordx4 a[72:75], v4, s[56:59], s61 offen offset:0 sc1
    buffer_load_dwordx4 a[76:79], v4, s[56:59], s61 offen offset:256 sc1
    s_add_u32 s61, s61, 2048
    buffer_load_dwordx4 a[80:83], v4, s[56:59], s61 offen offset:0 sc1
    buffer_load_dwordx4 a[84:87], v4, s[56:59], s61 offen offset:256 sc1
    s_add_u32 s61, s61, 2048
    buffer_load_dwordx4 a[88:91], v4, s[56:59], s61 offen offset:0 sc1
    buffer_load_dwordx4 a[92:95], v4, s[56:59], s61 offen offset:256 sc1
    s_add_u32 s61, s61, 2048
    buffer_load_dwordx4 a[96:99], v4, s[56:59], s61 offen offset:0 sc1
    buffer_load_dwordx4 a[100:103], v4, s[56:59], s61 offen offset:256 sc1
    s_add_u32 s61, s61, 2048
    buffer_load_dwordx4 a[104:107], v4, s[56:59], s61 offen offset:0 sc1
    buffer_load_dwordx4 a[108:111], v4, s[56:59], s61 offen offset:256 sc1
    s_add_u32 s61, s61, 2048
    buffer_load_dwordx4 a[112:115], v4, s[56:59], s61 offen offset:0 sc1
    buffer_load_dwordx4 a[116:119], v4, s[56:59], s61 offen offset:256 sc1
    s_add_u32 s61, s61, 2048
    s_add_u32 s76, s76, 1
    s_mov_b32 s31, 1048576
L_mega_kernel_gretry_92:
    ds_read_b32 v15, v9
    s_waitcnt lgkmcnt(0)
    v_cmp_gt_u32 vcc, s76, v15
    s_sub_u32 s31, s31, 1
    s_cbranch_scc1 L_mega_kernel_gok_91
    s_cbranch_vccnz L_mega_kernel_gretry_92
L_mega_kernel_gok_91:
    ds_read_b64_tr_b16 v[48:49], v104 offset:0
    ds_read_b64_tr_b16 v[50:51], v104 offset:1024
    ds_read_b64_tr_b16 v[52:53], v105 offset:0
    ds_read_b64_tr_b16 v[54:55], v105 offset:1024
    ds_read_b64_tr_b16 v[56:57], v106 offset:0
    ds_read_b64_tr_b16 v[58:59], v106 offset:1024
    ds_read_b64_tr_b16 v[60:61], v107 offset:0
    ds_read_b64_tr_b16 v[62:63], v107 offset:1024
    s_waitcnt vmcnt(28)
    s_waitcnt lgkmcnt(6)
    v_mfma_f32_16x16x32_bf16 v[16:19], v[48:51], a[0:3], v[16:19]
    ds_read_b64_tr_b16 v[64:65], v104 offset:4096
    s_add_u32 m0, s62, 0
    v_mfma_f32_16x16x32_bf16 v[20:23], v[48:51], a[4:7], v[20:23]
    ds_read_b64_tr_b16 v[66:67], v104 offset:5120
    buffer_load_dwordx4 a[120:123], v4, s[56:59], s61 offen offset:0 sc1
    s_waitcnt lgkmcnt(6)
    v_mfma_f32_16x16x32_bf16 v[24:27], v[52:55], a[0:3], v[24:27]
    ds_read_b64_tr_b16 v[68:69], v105 offset:4096
    buffer_load_dwordx4 a[124:127], v4, s[56:59], s61 offen offset:256 sc1
    v_mfma_f32_16x16x32_bf16 v[28:31], v[52:55], a[4:7], v[28:31]
    ds_read_b64_tr_b16 v[70:71], v105 offset:5120
    s_add_u32 s61, s61, 2048
    s_waitcnt lgkmcnt(6)
    v_mfma_f32_16x16x32_bf16 v[32:35], v[56:59], a[0:3], v[32:35]
    ds_read_b64_tr_b16 v[72:73], v106 offset:4096
    buffer_load_dwordx4 v3, s[48:51], s60 offen lds
    v_mfma_f32_16x16x32_bf16 v[36:39], v[56:59], a[4:7], v[36:39]
    ds_read_b64_tr_b16 v[74:75], v106 offset:5120
    s_add_u32 s60, s60, 8192
    s_waitcnt lgkmcnt(6)
    v_mfma_f32_16x16x32_bf16 v[40:43], v[60:63], a[0:3], v[40:43]
    ds_read_b64_tr_b16 v[76:77], v107 offset:4096
    v_mfma_f32_16x16x32_bf16 v[44:47], v[60:63], a[4:7], v[44:47]
    ds_read_b64_tr_b16 v[78:79], v107 offset:5120
    s_waitcnt vmcnt(29)
    s_waitcnt lgkmcnt(6)
    v_mfma_f32_16x16x32_bf16 v[16:19], v[64:67], a[8:11], v[16:19]
    ds_read_b64_tr_b16 v[48:49], v104 offset:8192
    s_add_u32 m0, s62, 1024
    buffer_load_dwordx4 a[0:3], v4, s[56:59], s61 offen offset:0 sc1
    v_mfma_f32_16x16x32_bf16 v[20:23], v[64:67], a[12:15], v[20:23]
    ds_read_b64_tr_b16 v[50:51], v104 offset:9216
    buffer_load_dwordx4 a[4:7], v4, s[56:59], s61 offen offset:256 sc1
    s_waitcnt lgkmcnt(6)
    v_mfma_f32_16x16x32_bf16 v[24:27], v[68:71], a[8:11], v[24:27]
    ds_read_b64_tr_b16 v[52:53], v105 offset:8192
    s_add_u32 s61, s61, 2048
    v_mfma_f32_16x16x32_bf16 v[28:31], v[68:71], a[12:15], v[28:31]
    ds_read_b64_tr_b16 v[54:55], v105 offset:9216
    buffer_load_dwordx4 v3, s[48:51], s60 offen lds
    s_waitcnt lgkmcnt(6)
    v_mfma_f32_16x16x32_bf16 v[32:35], v[72:75], a[8:11], v[32:35]
    ds_read_b64_tr_b16 v[56:57], v106 offset:8192
    s_add_u32 s60, s60, 24576
    v_mfma_f32_16x16x32_bf16 v[36:39], v[72:75], a[12:15], v[36:39]
    ds_read_b64_tr_b16 v[58:59], v106 offset:9216
    buffer_load_dwordx2 v[96:97], v6, s[24:27], 0 offen sc1
    s_waitcnt lgkmcnt(6)
    v_mfma_f32_16x16x32_bf16 v[40:43], v[76:79], a[8:11], v[40:43]
    ds_read_b64_tr_b16 v[60:61], v107 offset:8192
    v_mfma_f32_16x16x32_bf16 v[44:47], v[76:79], a[12:15], v[44:47]
    ds_read_b64_tr_b16 v[62:63], v107 offset:9216
    s_waitcnt vmcnt(31)
    ds_read_b32 v15, v9
    s_waitcnt lgkmcnt(7)
    v_mfma_f32_16x16x32_bf16 v[16:19], v[48:51], a[16:19], v[16:19]
    ds_read_b64_tr_b16 v[64:65], v104 offset:12288
    s_add_u32 m0, s62, 2048
    v_mfma_f32_16x16x32_bf16 v[20:23], v[48:51], a[20:23], v[20:23]
    ds_read_b64_tr_b16 v[66:67], v104 offset:13312
    buffer_load_dwordx4 a[8:11], v4, s[56:59], s61 offen offset:0 sc1
    s_waitcnt lgkmcnt(7)
    v_mfma_f32_16x16x32_bf16 v[24:27], v[52:55], a[16:19], v[24:27]
    ds_read_b64_tr_b16 v[68:69], v105 offset:12288
    buffer_load_dwordx4 a[12:15], v4, s[56:59], s61 offen offset:256 sc1
    v_mfma_f32_16x16x32_bf16 v[28:31], v[52:55], a[20:23], v[28:31]
    ds_read_b64_tr_b16 v[70:71], v105 offset:13312
    s_add_u32 s61, s61, 2048
    s_waitcnt lgkmcnt(7)
    v_mfma_f32_16x16x32_bf16 v[32:35], v[56:59], a[16:19], v[32:35]
    ds_read_b64_tr_b16 v[72:73], v106 offset:12288
    buffer_load_dwordx4 v3, s[48:51], s60 offen lds
    v_mfma_f32_16x16x32_bf16 v[36:39], v[56:59], a[20:23], v[36:39]
    ds_read_b64_tr_b16 v[74:75], v106 offset:13312
    s_add_u32 s60, s60, 8192
    s_waitcnt lgkmcnt(7)
    v_mfma_f32_16x16x32_bf16 v[40:43], v[60:63], a[16:19], v[40:43]
    ds_read_b64_tr_b16 v[76:77], v107 offset:12288
    v_mfma_f32_16x16x32_bf16 v[44:47], v[60:63], a[20:23], v[44:47]
    ds_read_b64_tr_b16 v[78:79], v107 offset:13312
    s_waitcnt vmcnt(32)
    v_add_u32 v11, 1, v11
    ds_write_b32 v10, v11
    s_add_u32 s76, s76, 1
    s_waitcnt lgkmcnt(9)
    v_cmp_gt_u32 vcc, s76, v15
    s_cbranch_vccz L_mega_kernel_gok_93
    s_mov_b32 s31, 1048576
L_mega_kernel_gretry_94:
    ds_read_b32 v15, v9
    s_waitcnt lgkmcnt(0)
    v_cmp_gt_u32 vcc, s76, v15
    s_sub_u32 s31, s31, 1
    s_cbranch_scc1 L_mega_kernel_gok_93
    s_cbranch_vccnz L_mega_kernel_gretry_94
L_mega_kernel_gok_93:
    s_add_u32 s63, s63, 16384
    s_cmp_ge_u32 s63, 114688
    s_cselect_b32 s79, s80, s81
    s_cselect_b32 s63, 0, s63
    v_add_u32 v104, s79, v104
    v_add_u32 v105, s79, v105
    v_add_u32 v106, s79, v106
    v_add_u32 v107, s79, v107
    s_waitcnt lgkmcnt(7)
    v_mfma_f32_16x16x32_bf16 v[16:19], v[64:67], a[24:27], v[16:19]
    ds_read_b64_tr_b16 v[48:49], v104 offset:0
    s_add_u32 m0, s62, 3072
    buffer_load_dwordx4 a[16:19], v4, s[56:59], s61 offen offset:0 sc1
    v_mfma_f32_16x16x32_bf16 v[20:23], v[64:67], a[28:31], v[20:23]
    ds_read_b64_tr_b16 v[50:51], v104 offset:1024
    buffer_load_dwordx4 a[20:23], v4, s[56:59], s61 offen offset:256 sc1
    s_waitcnt lgkmcnt(7)
    v_mfma_f32_16x16x32_bf16 v[24:27], v[68:71], a[24:27], v[24:27]
    ds_read_b64_tr_b16 v[52:53], v105 offset:0
    s_add_u32 s61, s61, 2048
    v_mfma_f32_16x16x32_bf16 v[28:31], v[68:71], a[28:31], v[28:31]
    ds_read_b64_tr_b16 v[54:55], v105 offset:1024
    buffer_load_dwordx4 v3, s[48:51], s60 offen lds
    s_waitcnt lgkmcnt(7)
    v_mfma_f32_16x16x32_bf16 v[32:35], v[72:75], a[24:27], v[32:35]
    ds_read_b64_tr_b16 v[56:57], v106 offset:0
    s_add_u32 s60, s60, 221184
    v_mfma_f32_16x16x32_bf16 v[36:39], v[72:75], a[28:31], v[36:39]
    ds_read_b64_tr_b16 v[58:59], v106 offset:1024
    s_add_u32 s62, s62, 16384
    s_waitcnt lgkmcnt(7)
    v_mfma_f32_16x16x32_bf16 v[40:43], v[76:79], a[24:27], v[40:43]
    ds_read_b64_tr_b16 v[60:61], v107 offset:0
    s_cmp_ge_u32 s62, s78
    s_cselect_b32 s62, s77, s62
    v_mfma_f32_16x16x32_bf16 v[44:47], v[76:79], a[28:31], v[44:47]
    ds_read_b64_tr_b16 v[62:63], v107 offset:1024
    s_waitcnt vmcnt(33)
    s_waitcnt lgkmcnt(6)
    v_mfma_f32_16x16x32_bf16 v[16:19], v[48:51], a[32:35], v[16:19]
    ds_read_b64_tr_b16 v[64:65], v104 offset:4096
    s_add_u32 m0, s62, 0
    v_mfma_f32_16x16x32_bf16 v[20:23], v[48:51], a[36:39], v[20:23]
    ds_read_b64_tr_b16 v[66:67], v104 offset:5120
    buffer_load_dwordx4 a[24:27], v4, s[56:59], s61 offen offset:0 sc1
    s_waitcnt lgkmcnt(6)
    v_mfma_f32_16x16x32_bf16 v[24:27], v[52:55], a[32:35], v[24:27]
    ds_read_b64_tr_b16 v[68:69], v105 offset:4096
    buffer_load_dwordx4 a[28:31], v4, s[56:59], s61 offen offset:256 sc1
    v_mfma_f32_16x16x32_bf16 v[28:31], v[52:55], a[36:39], v[28:31]
    ds_read_b64_tr_b16 v[70:71], v105 offset:5120
    s_add_u32 s61, s61, 2048
    s_waitcnt lgkmcnt(6)
    v_mfma_f32_16x16x32_bf16 v[32:35], v[56:59], a[32:35], v[32:35]
    ds_read_b64_tr_b16 v[72:73], v106 offset:4096
    buffer_load_dwordx4 v3, s[48:51], s60 offen lds
    v_mfma_f32_16x16x32_bf16 v[36:39], v[56:59], a[36:39], v[36:39]
    ds_read_b64_tr_b16 v[74:75], v106 offset:5120
    s_add_u32 s60, s60, 8192
    s_waitcnt lgkmcnt(6)
    v_mfma_f32_16x16x32_bf16 v[40:43], v[60:63], a[32:35], v[40:43]
    ds_read_b64_tr_b16 v[76:77], v107 offset:4096
    v_mfma_f32_16x16x32_bf16 v[44:47], v[60:63], a[36:39], v[44:47]
    ds_read_b64_tr_b16 v[78:79], v107 offset:5120
    s_waitcnt vmcnt(34)
    s_waitcnt lgkmcnt(6)
    v_mfma_f32_16x16x32_bf16 v[16:19], v[64:67], a[40:43], v[16:19]
    ds_read_b64_tr_b16 v[48:49], v104 offset:8192
    s_add_u32 m0, s62, 1024
    v_mfma_f32_16x16x32_bf16 v[20:23], v[64:67], a[44:47], v[20:23]
    ds_read_b64_tr_b16 v[50:51], v104 offset:9216
    buffer_load_dwordx4 a[32:35], v4, s[56:59], s61 offen offset:0 sc1
    s_waitcnt lgkmcnt(6)
    v_mfma_f32_16x16x32_bf16 v[24:27], v[68:71], a[40:43], v[24:27]
    ds_read_b64_tr_b16 v[52:53], v105 offset:8192
    buffer_load_dwordx4 a[36:39], v4, s[56:59], s61 offen offset:256 sc1
    v_mfma_f32_16x16x32_bf16 v[28:31], v[68:71], a[44:47], v[28:31]
    ds_read_b64_tr_b16 v[54:55], v105 offset:9216
    s_add_u32 s61, s61, 2048
    s_waitcnt lgkmcnt(6)
    v_mfma_f32_16x16x32_bf16 v[32:35], v[72:75], a[40:43], v[32:35]
    ds_read_b64_tr_b16 v[56:57], v106 offset:8192
    buffer_load_dwordx4 v3, s[48:51], s60 offen lds
    v_mfma_f32_16x16x32_bf16 v[36:39], v[72:75], a[44:47], v[36:39]
    ds_read_b64_tr_b16 v[58:59], v106 offset:9216
    s_add_u32 s60, s60, 24576
    s_waitcnt lgkmcnt(6)
    v_mfma_f32_16x16x32_bf16 v[40:43], v[76:79], a[40:43], v[40:43]
    ds_read_b64_tr_b16 v[60:61], v107 offset:8192
    v_mfma_f32_16x16x32_bf16 v[44:47], v[76:79], a[44:47], v[44:47]
    ds_read_b64_tr_b16 v[62:63], v107 offset:9216
    s_waitcnt vmcnt(35)
    ds_read_b32 v15, v9
    s_waitcnt lgkmcnt(7)
    v_mfma_f32_16x16x32_bf16 v[16:19], v[48:51], a[48:51], v[16:19]
    ds_read_b64_tr_b16 v[64:65], v104 offset:12288
    s_add_u32 m0, s62, 2048
    v_mfma_f32_16x16x32_bf16 v[20:23], v[48:51], a[52:55], v[20:23]
    ds_read_b64_tr_b16 v[66:67], v104 offset:13312
    buffer_load_dwordx4 a[40:43], v4, s[56:59], s61 offen offset:0 sc1
    s_waitcnt lgkmcnt(7)
    v_mfma_f32_16x16x32_bf16 v[24:27], v[52:55], a[48:51], v[24:27]
    ds_read_b64_tr_b16 v[68:69], v105 offset:12288
    buffer_load_dwordx4 a[44:47], v4, s[56:59], s61 offen offset:256 sc1
    v_mfma_f32_16x16x32_bf16 v[28:31], v[52:55], a[52:55], v[28:31]
    ds_read_b64_tr_b16 v[70:71], v105 offset:13312
    s_add_u32 s61, s61, 2048
    s_waitcnt lgkmcnt(7)
    v_mfma_f32_16x16x32_bf16 v[32:35], v[56:59], a[48:51], v[32:35]
    ds_read_b64_tr_b16 v[72:73], v106 offset:12288
    buffer_load_dwordx4 v3, s[48:51], s60 offen lds
    v_mfma_f32_16x16x32_bf16 v[36:39], v[56:59], a[52:55], v[36:39]
    ds_read_b64_tr_b16 v[74:75], v106 offset:13312
    s_add_u32 s60, s60, 8192
    s_waitcnt lgkmcnt(7)
    v_mfma_f32_16x16x32_bf16 v[40:43], v[60:63], a[48:51], v[40:43]
    ds_read_b64_tr_b16 v[76:77], v107 offset:12288
    v_mfma_f32_16x16x32_bf16 v[44:47], v[60:63], a[52:55], v[44:47]
    ds_read_b64_tr_b16 v[78:79], v107 offset:13312
    s_waitcnt vmcnt(36)
    v_add_u32 v11, 1, v11
    ds_write_b32 v10, v11
    s_add_u32 s76, s76, 1
    s_waitcnt lgkmcnt(9)
    v_cmp_gt_u32 vcc, s76, v15
    s_cbranch_vccz L_mega_kernel_gok_95
    s_mov_b32 s31, 1048576
L_mega_kernel_gretry_96:
    ds_read_b32 v15, v9
    s_waitcnt lgkmcnt(0)
    v_cmp_gt_u32 vcc, s76, v15
    s_sub_u32 s31, s31, 1
    s_cbranch_scc1 L_mega_kernel_gok_95
    s_cbranch_vccnz L_mega_kernel_gretry_96
L_mega_kernel_gok_95:
    s_add_u32 s63, s63, 16384
    s_cmp_ge_u32 s63, 114688
    s_cselect_b32 s79, s80, s81
    s_cselect_b32 s63, 0, s63
    v_add_u32 v104, s79, v104
    v_add_u32 v105, s79, v105
    v_add_u32 v106, s79, v106
    v_add_u32 v107, s79, v107
    s_waitcnt lgkmcnt(7)
    v_mfma_f32_16x16x32_bf16 v[16:19], v[64:67], a[56:59], v[16:19]
    ds_read_b64_tr_b16 v[48:49], v104 offset:0
    s_add_u32 m0, s62, 3072
    buffer_load_dwordx4 a[48:51], v4, s[56:59], s61 offen offset:0 sc1
    v_mfma_f32_16x16x32_bf16 v[20:23], v[64:67], a[60:63], v[20:23]
    ds_read_b64_tr_b16 v[50:51], v104 offset:1024
    buffer_load_dwordx4 a[52:55], v4, s[56:59], s61 offen offset:256 sc1
    s_waitcnt lgkmcnt(7)
    v_mfma_f32_16x16x32_bf16 v[24:27], v[68:71], a[56:59], v[24:27]
    ds_read_b64_tr_b16 v[52:53], v105 offset:0
    s_add_u32 s61, s61, 2048
    v_mfma_f32_16x16x32_bf16 v[28:31], v[68:71], a[60:63], v[28:31]
    ds_read_b64_tr_b16 v[54:55], v105 offset:1024
    buffer_load_dwordx4 v3, s[48:51], s60 offen lds
    s_waitcnt lgkmcnt(7)
    v_mfma_f32_16x16x32_bf16 v[32:35], v[72:75], a[56:59], v[32:35]
    ds_read_b64_tr_b16 v[56:57], v106 offset:0
    s_add_u32 s60, s60, 221184
    v_mfma_f32_16x16x32_bf16 v[36:39], v[72:75], a[60:63], v[36:39]
    ds_read_b64_tr_b16 v[58:59], v106 offset:1024
    s_add_u32 s62, s62, 16384
    s_waitcnt lgkmcnt(7)
    v_mfma_f32_16x16x32_bf16 v[40:43], v[76:79], a[56:59], v[40:43]
    ds_read_b64_tr_b16 v[60:61], v107 offset:0
    s_cmp_ge_u32 s62, s78
    s_cselect_b32 s62, s77, s62
    v_mfma_f32_16x16x32_bf16 v[44:47], v[76:79], a[60:63], v[44:47]
    ds_read_b64_tr_b16 v[62:63], v107 offset:1024
    s_mov_b32 s66, 0x000001ff
    s_mov_b32 s67, 0x00000000
    v_cmp_ne_u64 vcc, s[32:33], v[98:99]
    s_and_b32 s69, vcc_lo, s66
    s_cbranch_scc0 L_mega_kernel_fok_97
    s_mov_b32 s31, 131072
L_mega_kernel_fretry_98:
    buffer_load_dwordx2 v[98:99], v6, s[24:27], 0 offen sc1
    s_waitcnt vmcnt(0)
    v_cmp_ne_u64 vcc, s[32:33], v[98:99]
    v_mov_b32 v96, v98
    v_mov_b32 v97, v99
    s_sub_u32 s31, s31, 1
    s_cbranch_scc1 L_mega_kernel_fok_97
    s_and_b32 s69, vcc_lo, s66
    s_cbranch_scc1 L_mega_kernel_fretry_98
L_mega_kernel_fok_97:
    s_waitcnt vmcnt(37)
    s_waitcnt lgkmcnt(6)
    v_mfma_f32_16x16x32_bf16 v[16:19], v[48:51], a[64:67], v[16:19]
    ds_read_b64_tr_b16 v[64:65], v104 offset:4096
    s_add_u32 m0, s62, 0
    v_mfma_f32_16x16x32_bf16 v[20:23], v[48:51], a[68:71], v[20:23]
    ds_read_b64_tr_b16 v[66:67], v104 offset:5120
    buffer_load_dwordx4 a[56:59], v4, s[56:59], s61 offen offset:0 sc1
    s_waitcnt lgkmcnt(6)
    v_mfma_f32_16x16x32_bf16 v[24:27], v[52:55], a[64:67], v[24:27]
    ds_read_b64_tr_b16 v[68:69], v105 offset:4096
    buffer_load_dwordx4 a[60:63], v4, s[56:59], s61 offen offset:256 sc1
    v_mfma_f32_16x16x32_bf16 v[28:31], v[52:55], a[68:71], v[28:31]
    ds_read_b64_tr_b16 v[70:71], v105 offset:5120
    s_add_u32 s61, s61, 2048
    s_waitcnt lgkmcnt(6)
    v_mfma_f32_16x16x32_bf16 v[32:35], v[56:59], a[64:67], v[32:35]
    ds_read_b64_tr_b16 v[72:73], v106 offset:4096
    buffer_load_dwordx4 v3, s[48:51], s60 offen lds
    v_mfma_f32_16x16x32_bf16 v[36:39], v[56:59], a[68:71], v[36:39]
    ds_read_b64_tr_b16 v[74:75], v106 offset:5120
    s_add_u32 s60, s60, 8192
    s_waitcnt lgkmcnt(6)
    v_mfma_f32_16x16x32_bf16 v[40:43], v[60:63], a[64:67], v[40:43]
    ds_read_b64_tr_b16 v[76:77], v107 offset:4096
    v_mfma_f32_16x16x32_bf16 v[44:47], v[60:63], a[68:71], v[44:47]
    ds_read_b64_tr_b16 v[78:79], v107 offset:5120
    s_waitcnt vmcnt(38)
    s_waitcnt lgkmcnt(6)
    v_mfma_f32_16x16x32_bf16 v[16:19], v[64:67], a[72:75], v[16:19]
    ds_read_b64_tr_b16 v[48:49], v104 offset:8192
    s_add_u32 m0, s62, 1024
    buffer_load_dwordx4 a[64:67], v4, s[56:59], s61 offen offset:0 sc1
    v_mfma_f32_16x16x32_bf16 v[20:23], v[64:67], a[76:79], v[20:23]
    ds_read_b64_tr_b16 v[50:51], v104 offset:9216
    buffer_load_dwordx4 a[68:71], v4, s[56:59], s61 offen offset:256 sc1
    s_waitcnt lgkmcnt(6)
    v_mfma_f32_16x16x32_bf16 v[24:27], v[68:71], a[72:75], v[24:27]
    ds_read_b64_tr_b16 v[52:53], v105 offset:8192
    s_add_u32 s61, s61, 2048
    v_mfma_f32_16x16x32_bf16 v[28:31], v[68:71], a[76:79], v[28:31]
    ds_read_b64_tr_b16 v[54:55], v105 offset:9216
    buffer_load_dwordx4 v3, s[48:51], s60 offen lds
    s_waitcnt lgkmcnt(6)
    v_mfma_f32_16x16x32_bf16 v[32:35], v[72:75], a[72:75], v[32:35]
    ds_read_b64_tr_b16 v[56:57], v106 offset:8192
    s_add_u32 s60, s60, 24576
    v_mfma_f32_16x16x32_bf16 v[36:39], v[72:75], a[76:79], v[36:39]
    ds_read_b64_tr_b16 v[58:59], v106 offset:9216
    buffer_load_dwordx2 v[98:99], v6, s[24:27], 0 offen sc1
    s_waitcnt lgkmcnt(6)
    v_mfma_f32_16x16x32_bf16 v[40:43], v[76:79], a[72:75], v[40:43]
    ds_read_b64_tr_b16 v[60:61], v107 offset:8192
    v_mfma_f32_16x16x32_bf16 v[44:47], v[76:79], a[76:79], v[44:47]
    ds_read_b64_tr_b16 v[62:63], v107 offset:9216
    s_waitcnt vmcnt(40)
    ds_read_b32 v15, v9
    s_waitcnt lgkmcnt(7)
    v_mfma_f32_16x16x32_bf16 v[16:19], v[48:51], a[80:83], v[16:19]
    ds_read_b64_tr_b16 v[64:65], v104 offset:12288
    s_add_u32 m0, s62, 2048
    v_mfma_f32_16x16x32_bf16 v[20:23], v[48:51], a[84:87], v[20:23]
    ds_read_b64_tr_b16 v[66:67], v104 offset:13312
    buffer_load_dwordx4 a[72:75], v4, s[56:59], s61 offen offset:0 sc1
    s_waitcnt lgkmcnt(7)
    v_mfma_f32_16x16x32_bf16 v[24:27], v[52:55], a[80:83], v[24:27]
    ds_read_b64_tr_b16 v[68:69], v105 offset:12288
    buffer_load_dwordx4 a[76:79], v4, s[56:59], s61 offen offset:256 sc1
    v_mfma_f32_16x16x32_bf16 v[28:31], v[52:55], a[84:87], v[28:31]
    ds_read_b64_tr_b16 v[70:71], v105 offset:13312
    s_add_u32 s61, s61, 2048
    s_waitcnt lgkmcnt(7)
    v_mfma_f32_16x16x32_bf16 v[32:35], v[56:59], a[80:83], v[32:35]
    ds_read_b64_tr_b16 v[72:73], v106 offset:12288
    buffer_load_dwordx4 v3, s[48:51], s60 offen lds
    v_mfma_f32_16x16x32_bf16 v[36:39], v[56:59], a[84:87], v[36:39]
    ds_read_b64_tr_b16 v[74:75], v106 offset:13312
    s_add_u32 s60, s60, 8192
    s_waitcnt lgkmcnt(7)
    v_mfma_f32_16x16x32_bf16 v[40:43], v[60:63], a[80:83], v[40:43]
    ds_read_b64_tr_b16 v[76:77], v107 offset:12288
    v_mfma_f32_16x16x32_bf16 v[44:47], v[60:63], a[84:87], v[44:47]
    ds_read_b64_tr_b16 v[78:79], v107 offset:13312
    s_waitcnt vmcnt(41)
    v_add_u32 v11, 1, v11
    ds_write_b32 v10, v11
    s_add_u32 s76, s76, 1
    s_waitcnt lgkmcnt(9)
    v_cmp_gt_u32 vcc, s76, v15
    s_cbranch_vccz L_mega_kernel_gok_99
    s_mov_b32 s31, 1048576
L_mega_kernel_gretry_100:
    ds_read_b32 v15, v9
    s_waitcnt lgkmcnt(0)
    v_cmp_gt_u32 vcc, s76, v15
    s_sub_u32 s31, s31, 1
    s_cbranch_scc1 L_mega_kernel_gok_99
    s_cbranch_vccnz L_mega_kernel_gretry_100
L_mega_kernel_gok_99:
    s_add_u32 s63, s63, 16384
    s_cmp_ge_u32 s63, 114688
    s_cselect_b32 s79, s80, s81
    s_cselect_b32 s63, 0, s63
    v_add_u32 v104, s79, v104
    v_add_u32 v105, s79, v105
    v_add_u32 v106, s79, v106
    v_add_u32 v107, s79, v107
    s_waitcnt lgkmcnt(7)
    v_mfma_f32_16x16x32_bf16 v[16:19], v[64:67], a[88:91], v[16:19]
    ds_read_b64_tr_b16 v[48:49], v104 offset:0
    s_add_u32 m0, s62, 3072
    buffer_load_dwordx4 a[80:83], v4, s[56:59], s61 offen offset:0 sc1
    v_mfma_f32_16x16x32_bf16 v[20:23], v[64:67], a[92:95], v[20:23]
    ds_read_b64_tr_b16 v[50:51], v104 offset:1024
    buffer_load_dwordx4 a[84:87], v4, s[56:59], s61 offen offset:256 sc1
    s_waitcnt lgkmcnt(7)
    v_mfma_f32_16x16x32_bf16 v[24:27], v[68:71], a[88:91], v[24:27]
    ds_read_b64_tr_b16 v[52:53], v105 offset:0
    s_add_u32 s61, s61, 2048
    v_mfma_f32_16x16x32_bf16 v[28:31], v[68:71], a[92:95], v[28:31]
    ds_read_b64_tr_b16 v[54:55], v105 offset:1024
    buffer_load_dwordx4 v3, s[48:51], s60 offen lds
    s_waitcnt lgkmcnt(7)
    v_mfma_f32_16x16x32_bf16 v[32:35], v[72:75], a[88:91], v[32:35]
    ds_read_b64_tr_b16 v[56:57], v106 offset:0
    s_add_u32 s60, s60, 221184
    v_mfma_f32_16x16x32_bf16 v[36:39], v[72:75], a[92:95], v[36:39]
    ds_read_b64_tr_b16 v[58:59], v106 offset:1024
    s_add_u32 s62, s62, 16384
    s_waitcnt lgkmcnt(7)
    v_mfma_f32_16x16x32_bf16 v[40:43], v[76:79], a[88:91], v[40:43]
    ds_read_b64_tr_b16 v[60:61], v107 offset:0
    s_cmp_ge_u32 s62, s78
    s_cselect_b32 s62, s77, s62
    v_mfma_f32_16x16x32_bf16 v[44:47], v[76:79], a[92:95], v[44:47]
    ds_read_b64_tr_b16 v[62:63], v107 offset:1024
    s_waitcnt vmcnt(42)
    s_waitcnt lgkmcnt(6)
    v_mfma_f32_16x16x32_bf16 v[16:19], v[48:51], a[96:99], v[16:19]
    ds_read_b64_tr_b16 v[64:65], v104 offset:4096
    s_add_u32 m0, s62, 0
    v_mfma_f32_16x16x32_bf16 v[20:23], v[48:51], a[100:103], v[20:23]
    ds_read_b64_tr_b16 v[66:67], v104 offset:5120
    buffer_load_dwordx4 a[88:91], v4, s[56:59], s61 offen offset:0 sc1
    s_waitcnt lgkmcnt(6)
    v_mfma_f32_16x16x32_bf16 v[24:27], v[52:55], a[96:99], v[24:27]
    ds_read_b64_tr_b16 v[68:69], v105 offset:4096
    buffer_load_dwordx4 a[92:95], v4, s[56:59], s61 offen offset:256 sc1
    v_mfma_f32_16x16x32_bf16 v[28:31], v[52:55], a[100:103], v[28:31]
    ds_read_b64_tr_b16 v[70:71], v105 offset:5120
    s_add_u32 s61, s61, 2048
    s_waitcnt lgkmcnt(6)
    v_mfma_f32_16x16x32_bf16 v[32:35], v[56:59], a[96:99], v[32:35]
    ds_read_b64_tr_b16 v[72:73], v106 offset:4096
    buffer_load_dwordx4 v3, s[48:51], s60 offen lds
    v_mfma_f32_16x16x32_bf16 v[36:39], v[56:59], a[100:103], v[36:39]
    ds_read_b64_tr_b16 v[74:75], v106 offset:5120
    s_add_u32 s60, s60, 8192
    s_waitcnt lgkmcnt(6)
    v_mfma_f32_16x16x32_bf16 v[40:43], v[60:63], a[96:99], v[40:43]
    ds_read_b64_tr_b16 v[76:77], v107 offset:4096
    v_mfma_f32_16x16x32_bf16 v[44:47], v[60:63], a[100:103], v[44:47]
    ds_read_b64_tr_b16 v[78:79], v107 offset:5120
    s_waitcnt vmcnt(43)
    s_waitcnt lgkmcnt(6)
    v_mfma_f32_16x16x32_bf16 v[16:19], v[64:67], a[104:107], v[16:19]
    ds_read_b64_tr_b16 v[48:49], v104 offset:8192
    s_add_u32 m0, s62, 1024
    v_mfma_f32_16x16x32_bf16 v[20:23], v[64:67], a[108:111], v[20:23]
    ds_read_b64_tr_b16 v[50:51], v104 offset:9216
    buffer_load_dwordx4 a[96:99], v4, s[56:59], s61 offen offset:0 sc1
    s_waitcnt lgkmcnt(6)
    v_mfma_f32_16x16x32_bf16 v[24:27], v[68:71], a[104:107], v[24:27]
    ds_read_b64_tr_b16 v[52:53], v105 offset:8192
    buffer_load_dwordx4 a[100:103], v4, s[56:59], s61 offen offset:256 sc1
    v_mfma_f32_16x16x32_bf16 v[28:31], v[68:71], a[108:111], v[28:31]
    ds_read_b64_tr_b16 v[54:55], v105 offset:9216
    s_add_u32 s61, s61, 2048
    s_waitcnt lgkmcnt(6)
    v_mfma_f32_16x16x32_bf16 v[32:35], v[72:75], a[104:107], v[32:35]
    ds_read_b64_tr_b16 v[56:57], v106 offset:8192
    buffer_load_dwordx4 v3, s[48:51], s60 offen lds
    v_mfma_f32_16x16x32_bf16 v[36:39], v[72:75], a[108:111], v[36:39]
    ds_read_b64_tr_b16 v[58:59], v106 offset:9216
    s_add_u32 s60, s60, 24576
    s_waitcnt lgkmcnt(6)
    v_mfma_f32_16x16x32_bf16 v[40:43], v[76:79], a[104:107], v[40:43]
    ds_read_b64_tr_b16 v[60:61], v107 offset:8192
    v_mfma_f32_16x16x32_bf16 v[44:47], v[76:79], a[108:111], v[44:47]
    ds_read_b64_tr_b16 v[62:63], v107 offset:9216
    s_waitcnt vmcnt(44)
    ds_read_b32 v15, v9
    s_waitcnt lgkmcnt(7)
    v_mfma_f32_16x16x32_bf16 v[16:19], v[48:51], a[112:115], v[16:19]
    ds_read_b64_tr_b16 v[64:65], v104 offset:12288
    s_add_u32 m0, s62, 2048
    v_mfma_f32_16x16x32_bf16 v[20:23], v[48:51], a[116:119], v[20:23]
    ds_read_b64_tr_b16 v[66:67], v104 offset:13312
    buffer_load_dwordx4 a[104:107], v4, s[56:59], s61 offen offset:0 sc1
    s_waitcnt lgkmcnt(7)
    v_mfma_f32_16x16x32_bf16 v[24:27], v[52:55], a[112:115], v[24:27]
    ds_read_b64_tr_b16 v[68:69], v105 offset:12288
    buffer_load_dwordx4 a[108:111], v4, s[56:59], s61 offen offset:256 sc1
    v_mfma_f32_16x16x32_bf16 v[28:31], v[52:55], a[116:119], v[28:31]
    ds_read_b64_tr_b16 v[70:71], v105 offset:13312
    s_add_u32 s61, s61, 2048
    s_waitcnt lgkmcnt(7)
    v_mfma_f32_16x16x32_bf16 v[32:35], v[56:59], a[112:115], v[32:35]
    ds_read_b64_tr_b16 v[72:73], v106 offset:12288
    buffer_load_dwordx4 v3, s[48:51], s60 offen lds
    v_mfma_f32_16x16x32_bf16 v[36:39], v[56:59], a[116:119], v[36:39]
    ds_read_b64_tr_b16 v[74:75], v106 offset:13312
    s_add_u32 s60, s60, 8192
    s_waitcnt lgkmcnt(7)
    v_mfma_f32_16x16x32_bf16 v[40:43], v[60:63], a[112:115], v[40:43]
    ds_read_b64_tr_b16 v[76:77], v107 offset:12288
    v_mfma_f32_16x16x32_bf16 v[44:47], v[60:63], a[116:119], v[44:47]
    ds_read_b64_tr_b16 v[78:79], v107 offset:13312
    s_waitcnt vmcnt(45)
    s_waitcnt vmcnt(34)
    v_add_u32 v11, 1, v11
    ds_write_b32 v10, v11
    s_add_u32 s76, s76, 1
    s_waitcnt lgkmcnt(9)
    v_cmp_gt_u32 vcc, s76, v15
    s_cbranch_vccz L_mega_kernel_gok_101
    s_mov_b32 s31, 1048576
L_mega_kernel_gretry_102:
    ds_read_b32 v15, v9
    s_waitcnt lgkmcnt(0)
    v_cmp_gt_u32 vcc, s76, v15
    s_sub_u32 s31, s31, 1
    s_cbranch_scc1 L_mega_kernel_gok_101
    s_cbranch_vccnz L_mega_kernel_gretry_102
L_mega_kernel_gok_101:
    s_add_u32 s63, s63, 16384
    s_cmp_ge_u32 s63, 114688
    s_cselect_b32 s79, s80, s81
    s_cselect_b32 s63, 0, s63
    v_add_u32 v104, s79, v104
    v_add_u32 v105, s79, v105
    v_add_u32 v106, s79, v106
    v_add_u32 v107, s79, v107
    s_waitcnt lgkmcnt(7)
    v_mfma_f32_16x16x32_bf16 v[16:19], v[64:67], a[120:123], v[16:19]
    ds_read_b64_tr_b16 v[48:49], v104 offset:0
    s_add_u32 m0, s62, 3072
    buffer_load_dwordx4 a[112:115], v4, s[56:59], s61 offen offset:0 sc1
    v_mfma_f32_16x16x32_bf16 v[20:23], v[64:67], a[124:127], v[20:23]
    ds_read_b64_tr_b16 v[50:51], v104 offset:1024
    buffer_load_dwordx4 a[116:119], v4, s[56:59], s61 offen offset:256 sc1
    s_waitcnt lgkmcnt(7)
    v_mfma_f32_16x16x32_bf16 v[24:27], v[68:71], a[120:123], v[24:27]
    ds_read_b64_tr_b16 v[52:53], v105 offset:0
    s_add_u32 s61, s61, 2048
    v_mfma_f32_16x16x32_bf16 v[28:31], v[68:71], a[124:127], v[28:31]
    ds_read_b64_tr_b16 v[54:55], v105 offset:1024
    buffer_load_dwordx4 v3, s[48:51], s60 offen lds
    s_waitcnt lgkmcnt(7)
    v_mfma_f32_16x16x32_bf16 v[32:35], v[72:75], a[120:123], v[32:35]
    ds_read_b64_tr_b16 v[56:57], v106 offset:0
    s_add_u32 s60, s60, 221184
    v_mfma_f32_16x16x32_bf16 v[36:39], v[72:75], a[124:127], v[36:39]
    ds_read_b64_tr_b16 v[58:59], v106 offset:1024
    s_add_u32 s62, s62, 16384
    s_waitcnt lgkmcnt(7)
    v_mfma_f32_16x16x32_bf16 v[40:43], v[76:79], a[120:123], v[40:43]
    ds_read_b64_tr_b16 v[60:61], v107 offset:0
    s_cmp_ge_u32 s62, s78
    s_cselect_b32 s62, s77, s62
    v_mfma_f32_16x16x32_bf16 v[44:47], v[76:79], a[124:127], v[44:47]
    ds_read_b64_tr_b16 v[62:63], v107 offset:1024
    s_mov_b32 s72, 6
L_g2_loop:
    s_and_b32 s69, s64, 15
    s_lshr_b64 s[64:65], s[64:65], 4
    s_add_u32 s68, s68, s69
    s_sub_u32 s69, 64, s68
    s_lshr_b64 s[66:67], -1, s69
    v_cmp_ne_u64 vcc, s[32:33], v[96:97]
    s_and_b32 s69, vcc_lo, s66
    s_cbranch_scc0 L_mega_kernel_fok_103
    s_mov_b32 s31, 131072
L_mega_kernel_fretry_104:
    buffer_load_dwordx2 v[96:97], v6, s[24:27], 0 offen sc1
    s_waitcnt vmcnt(0)
    v_cmp_ne_u64 vcc, s[32:33], v[96:97]
    v_mov_b32 v98, v96
    v_mov_b32 v99, v97
    s_sub_u32 s31, s31, 1
    s_cbranch_scc1 L_mega_kernel_fok_103
    s_and_b32 s69, vcc_lo, s66
    s_cbranch_scc1 L_mega_kernel_fretry_104
L_mega_kernel_fok_103:
    s_waitcnt lgkmcnt(6)
    v_mfma_f32_16x16x32_bf16 v[16:19], v[48:51], a[0:3], v[16:19]
    ds_read_b64_tr_b16 v[64:65], v104 offset:4096
    s_add_u32 m0, s62, 0
    v_mfma_f32_16x16x32_bf16 v[20:23], v[48:51], a[4:7], v[20:23]
    ds_read_b64_tr_b16 v[66:67], v104 offset:5120
    buffer_load_dwordx4 a[120:123], v4, s[56:59], s61 offen offset:0 sc1
    s_waitcnt lgkmcnt(6)
    v_mfma_f32_16x16x32_bf16 v[24:27], v[52:55], a[0:3], v[24:27]
    ds_read_b64_tr_b16 v[68:69], v105 offset:4096
    buffer_load_dwordx4 a[124:127], v4, s[56:59], s61 offen offset:256 sc1
    v_mfma_f32_16x16x32_bf16 v[28:31], v[52:55], a[4:7], v[28:31]
    ds_read_b64_tr_b16 v[70:71], v105 offset:5120
    s_add_u32 s61, s61, 2048
    s_waitcnt lgkmcnt(6)
    v_mfma_f32_16x16x32_bf16 v[32:35], v[56:59], a[0:3], v[32:35]
    ds_read_b64_tr_b16 v[72:73], v106 offset:4096
    buffer_load_dwordx4 v3, s[48:51], s60 offen lds
    v_mfma_f32_16x16x32_bf16 v[36:39], v[56:59], a[4:7], v[36:39]
    ds_read_b64_tr_b16 v[74:75], v106 offset:5120
    s_add_u32 s60, s60, 8192
    s_waitcnt lgkmcnt(6)
    v_mfma_f32_16x16x32_bf16 v[40:43], v[60:63], a[0:3], v[40:43]
    ds_read_b64_tr_b16 v[76:77], v107 offset:4096
    v_mfma_f32_16x16x32_bf16 v[44:47], v[60:63], a[4:7], v[44:47]
    ds_read_b64_tr_b16 v[78:79], v107 offset:5120
    s_waitcnt lgkmcnt(6)
    v_mfma_f32_16x16x32_bf16 v[16:19], v[64:67], a[8:11], v[16:19]
    ds_read_b64_tr_b16 v[48:49], v104 offset:8192
    s_add_u32 m0, s62, 1024
    buffer_load_dwordx4 a[0:3], v4, s[56:59], s61 offen offset:0 sc1
    v_mfma_f32_16x16x32_bf16 v[20:23], v[64:67], a[12:15], v[20:23]
    ds_read_b64_tr_b16 v[50:51], v104 offset:9216
    buffer_load_dwordx4 a[4:7], v4, s[56:59], s61 offen offset:256 sc1
    s_waitcnt lgkmcnt(6)
    v_mfma_f32_16x16x32_bf16 v[24:27], v[68:71], a[8:11], v[24:27]
    ds_read_b64_tr_b16 v[52:53], v105 offset:8192
    s_add_u32 s61, s61, 2048
    v_mfma_f32_16x16x32_bf16 v[28:31], v[68:71], a[12:15], v[28:31]
    ds_read_b64_tr_b16 v[54:55], v105 offset:9216
    buffer_load_dwordx4 v3, s[48:51], s60 offen lds
    s_waitcnt lgkmcnt(6)
    v_mfma_f32_16x16x32_bf16 v[32:35], v[72:75], a[8:11], v[32:35]
    ds_read_b64_tr_b16 v[56:57], v106 offset:8192
    s_add_u32 s60, s60, 24576
    v_mfma_f32_16x16x32_bf16 v[36:39], v[72:75], a[12:15], v[36:39]
    ds_read_b64_tr_b16 v[58:59], v106 offset:9216
    buffer_load_dwordx2 v[96:97], v6, s[24:27], 0 offen sc1
    s_waitcnt lgkmcnt(6)
    v_mfma_f32_16x16x32_bf16 v[40:43], v[76:79], a[8:11], v[40:43]
    ds_read_b64_tr_b16 v[60:61], v107 offset:8192
    v_mfma_f32_16x16x32_bf16 v[44:47], v[76:79], a[12:15], v[44:47]
    ds_read_b64_tr_b16 v[62:63], v107 offset:9216
    ds_read_b32 v15, v9
    s_waitcnt lgkmcnt(7)
    v_mfma_f32_16x16x32_bf16 v[16:19], v[48:51], a[16:19], v[16:19]
    ds_read_b64_tr_b16 v[64:65], v104 offset:12288
    s_add_u32 m0, s62, 2048
    v_mfma_f32_16x16x32_bf16 v[20:23], v[48:51], a[20:23], v[20:23]
    ds_read_b64_tr_b16 v[66:67], v104 offset:13312
    buffer_load_dwordx4 a[8:11], v4, s[56:59], s61 offen offset:0 sc1
    s_waitcnt lgkmcnt(7)
    v_mfma_f32_16x16x32_bf16 v[24:27], v[52:55], a[16:19], v[24:27]
    ds_read_b64_tr_b16 v[68:69], v105 offset:12288
    buffer_load_dwordx4 a[12:15], v4, s[56:59], s61 offen offset:256 sc1
    v_mfma_f32_16x16x32_bf16 v[28:31], v[52:55], a[20:23], v[28:31]
    ds_read_b64_tr_b16 v[70:71], v105 offset:13312
    s_add_u32 s61, s61, 2048
    s_waitcnt lgkmcnt(7)
    v_mfma_f32_16x16x32_bf16 v[32:35], v[56:59], a[16:19], v[32:35]
    ds_read_b64_tr_b16 v[72:73], v106 offset:12288
    buffer_load_dwordx4 v3, s[48:51], s60 offen lds
    v_mfma_f32_16x16x32_bf16 v[36:39], v[56:59], a[20:23], v[36:39]
    ds_read_b64_tr_b16 v[74:75], v106 offset:13312
    s_add_u32 s60, s60, 8192
    s_waitcnt lgkmcnt(7)
    v_mfma_f32_16x16x32_bf16 v[40:43], v[60:63], a[16:19], v[40:43]
    ds_read_b64_tr_b16 v[76:77], v107 offset:12288
    v_mfma_f32_16x16x32_bf16 v[44:47], v[60:63], a[20:23], v[44:47]
    ds_read_b64_tr_b16 v[78:79], v107 offset:13312
    s_waitcnt vmcnt(45)
    s_waitcnt vmcnt(35)
    v_add_u32 v11, 1, v11
    ds_write_b32 v10, v11
    s_add_u32 s76, s76, 1
    s_waitcnt lgkmcnt(9)
    v_cmp_gt_u32 vcc, s76, v15
    s_cbranch_vccz L_mega_kernel_gok_105
    s_mov_b32 s31, 1048576
L_mega_kernel_gretry_106:
    ds_read_b32 v15, v9
    s_waitcnt lgkmcnt(0)
    v_cmp_gt_u32 vcc, s76, v15
    s_sub_u32 s31, s31, 1
    s_cbranch_scc1 L_mega_kernel_gok_105
    s_cbranch_vccnz L_mega_kernel_gretry_106
L_mega_kernel_gok_105:
    s_add_u32 s63, s63, 16384
    s_cmp_ge_u32 s63, 114688
    s_cselect_b32 s79, s80, s81
    s_cselect_b32 s63, 0, s63
    v_add_u32 v104, s79, v104
    v_add_u32 v105, s79, v105
    v_add_u32 v106, s79, v106
    v_add_u32 v107, s79, v107
    s_waitcnt lgkmcnt(7)
    v_mfma_f32_16x16x32_bf16 v[16:19], v[64:67], a[24:27], v[16:19]
    ds_read_b64_tr_b16 v[48:49], v104 offset:0
    s_add_u32 m0, s62, 3072
    buffer_load_dwordx4 a[16:19], v4, s[56:59], s61 offen offset:0 sc1
    v_mfma_f32_16x16x32_bf16 v[20:23], v[64:67], a[28:31], v[20:23]
    ds_read_b64_tr_b16 v[50:51], v104 offset:1024
    buffer_load_dwordx4 a[20:23], v4, s[56:59], s61 offen offset:256 sc1
    s_waitcnt lgkmcnt(7)
    v_mfma_f32_16x16x32_bf16 v[24:27], v[68:71], a[24:27], v[24:27]
    ds_read_b64_tr_b16 v[52:53], v105 offset:0
    s_add_u32 s61, s61, 2048
    v_mfma_f32_16x16x32_bf16 v[28:31], v[68:71], a[28:31], v[28:31]
    ds_read_b64_tr_b16 v[54:55], v105 offset:1024
    buffer_load_dwordx4 v3, s[48:51], s60 offen lds
    s_waitcnt lgkmcnt(7)
    v_mfma_f32_16x16x32_bf16 v[32:35], v[72:75], a[24:27], v[32:35]
    ds_read_b64_tr_b16 v[56:57], v106 offset:0
    s_add_u32 s60, s60, 221184
    v_mfma_f32_16x16x32_bf16 v[36:39], v[72:75], a[28:31], v[36:39]
    ds_read_b64_tr_b16 v[58:59], v106 offset:1024
    s_add_u32 s62, s62, 16384
    s_waitcnt lgkmcnt(7)
    v_mfma_f32_16x16x32_bf16 v[40:43], v[76:79], a[24:27], v[40:43]
    ds_read_b64_tr_b16 v[60:61], v107 offset:0
    s_cmp_ge_u32 s62, s78
    s_cselect_b32 s62, s77, s62
    v_mfma_f32_16x16x32_bf16 v[44:47], v[76:79], a[28:31], v[44:47]
    ds_read_b64_tr_b16 v[62:63], v107 offset:1024
    s_waitcnt lgkmcnt(6)
    v_mfma_f32_16x16x32_bf16 v[16:19], v[48:51], a[32:35], v[16:19]
    ds_read_b64_tr_b16 v[64:65], v104 offset:4096
    s_add_u32 m0, s62, 0
    v_mfma_f32_16x16x32_bf16 v[20:23], v[48:51], a[36:39], v[20:23]
    ds_read_b64_tr_b16 v[66:67], v104 offset:5120
    buffer_load_dwordx4 a[24:27], v4, s[56:59], s61 offen offset:0 sc1
    s_waitcnt lgkmcnt(6)
    v_mfma_f32_16x16x32_bf16 v[24:27], v[52:55], a[32:35], v[24:27]
    ds_read_b64_tr_b16 v[68:69], v105 offset:4096
    buffer_load_dwordx4 a[28:31], v4, s[56:59], s61 offen offset:256 sc1
    v_mfma_f32_16x16x32_bf16 v[28:31], v[52:55], a[36:39], v[28:31]
    ds_read_b64_tr_b16 v[70:71], v105 offset:5120
    s_add_u32 s61, s61, 2048
    s_waitcnt lgkmcnt(6)
    v_mfma_f32_16x16x32_bf16 v[32:35], v[56:59], a[32:35], v[32:35]
    ds_read_b64_tr_b16 v[72:73], v106 offset:4096
    buffer_load_dwordx4 v3, s[48:51], s60 offen lds
    v_mfma_f32_16x16x32_bf16 v[36:39], v[56:59], a[36:39], v[36:39]
    ds_read_b64_tr_b16 v[74:75], v106 offset:5120
    s_add_u32 s60, s60, 8192
    s_waitcnt lgkmcnt(6)
    v_mfma_f32_16x16x32_bf16 v[40:43], v[60:63], a[32:35], v[40:43]
    ds_read_b64_tr_b16 v[76:77], v107 offset:4096
    v_mfma_f32_16x16x32_bf16 v[44:47], v[60:63], a[36:39], v[44:47]
    ds_read_b64_tr_b16 v[78:79], v107 offset:5120
    s_waitcnt lgkmcnt(6)
    v_mfma_f32_16x16x32_bf16 v[16:19], v[64:67], a[40:43], v[16:19]
    ds_read_b64_tr_b16 v[48:49], v104 offset:8192
    s_add_u32 m0, s62, 1024
    v_mfma_f32_16x16x32_bf16 v[20:23], v[64:67], a[44:47], v[20:23]
    ds_read_b64_tr_b16 v[50:51], v104 offset:9216
    buffer_load_dwordx4 a[32:35], v4, s[56:59], s61 offen offset:0 sc1
    s_waitcnt lgkmcnt(6)
    v_mfma_f32_16x16x32_bf16 v[24:27], v[68:71], a[40:43], v[24:27]
    ds_read_b64_tr_b16 v[52:53], v105 offset:8192
    buffer_load_dwordx4 a[36:39], v4, s[56:59], s61 offen offset:256 sc1
    v_mfma_f32_16x16x32_bf16 v[28:31], v[68:71], a[44:47], v[28:31]
    ds_read_b64_tr_b16 v[54:55], v105 offset:9216
    s_add_u32 s61, s61, 2048
    s_waitcnt lgkmcnt(6)
    v_mfma_f32_16x16x32_bf16 v[32:35], v[72:75], a[40:43], v[32:35]
    ds_read_b64_tr_b16 v[56:57], v106 offset:8192
    buffer_load_dwordx4 v3, s[48:51], s60 offen lds
    v_mfma_f32_16x16x32_bf16 v[36:39], v[72:75], a[44:47], v[36:39]
    ds_read_b64_tr_b16 v[58:59], v106 offset:9216
    s_add_u32 s60, s60, 24576
    s_waitcnt lgkmcnt(6)
    v_mfma_f32_16x16x32_bf16 v[40:43], v[76:79], a[40:43], v[40:43]
    ds_read_b64_tr_b16 v[60:61], v107 offset:8192
    v_mfma_f32_16x16x32_bf16 v[44:47], v[76:79], a[44:47], v[44:47]
    ds_read_b64_tr_b16 v[62:63], v107 offset:9216
    ds_read_b32 v15, v9
    s_waitcnt lgkmcnt(7)
    v_mfma_f32_16x16x32_bf16 v[16:19], v[48:51], a[48:51], v[16:19]
    ds_read_b64_tr_b16 v[64:65], v104 offset:12288
    s_add_u32 m0, s62, 2048
    v_mfma_f32_16x16x32_bf16 v[20:23], v[48:51], a[52:55], v[20:23]
    ds_read_b64_tr_b16 v[66:67], v104 offset:13312
    buffer_load_dwordx4 a[40:43], v4, s[56:59], s61 offen offset:0 sc1
    s_waitcnt lgkmcnt(7)
    v_mfma_f32_16x16x32_bf16 v[24:27], v[52:55], a[48:51], v[24:27]
    ds_read_b64_tr_b16 v[68:69], v105 offset:12288
    buffer_load_dwordx4 a[44:47], v4, s[56:59], s61 offen offset:256 sc1
    v_mfma_f32_16x16x32_bf16 v[28:31], v[52:55], a[52:55], v[28:31]
    ds_read_b64_tr_b16 v[70:71], v105 offset:13312
    s_add_u32 s61, s61, 2048
    s_waitcnt lgkmcnt(7)
    v_mfma_f32_16x16x32_bf16 v[32:35], v[56:59], a[48:51], v[32:35]
    ds_read_b64_tr_b16 v[72:73], v106 offset:12288
    buffer_load_dwordx4 v3, s[48:51], s60 offen lds
    v_mfma_f32_16x16x32_bf16 v[36:39], v[56:59], a[52:55], v[36:39]
    ds_read_b64_tr_b16 v[74:75], v106 offset:13312
    s_add_u32 s60, s60, 8192
    s_waitcnt lgkmcnt(7)
    v_mfma_f32_16x16x32_bf16 v[40:43], v[60:63], a[48:51], v[40:43]
    ds_read_b64_tr_b16 v[76:77], v107 offset:12288
    v_mfma_f32_16x16x32_bf16 v[44:47], v[60:63], a[52:55], v[44:47]
    ds_read_b64_tr_b16 v[78:79], v107 offset:13312
    s_waitcnt vmcnt(45)
    s_waitcnt vmcnt(34)
    v_add_u32 v11, 1, v11
    ds_write_b32 v10, v11
    s_add_u32 s76, s76, 1
    s_waitcnt lgkmcnt(9)
    v_cmp_gt_u32 vcc, s76, v15
    s_cbranch_vccz L_mega_kernel_gok_107
    s_mov_b32 s31, 1048576
L_mega_kernel_gretry_108:
    ds_read_b32 v15, v9
    s_waitcnt lgkmcnt(0)
    v_cmp_gt_u32 vcc, s76, v15
    s_sub_u32 s31, s31, 1
    s_cbranch_scc1 L_mega_kernel_gok_107
    s_cbranch_vccnz L_mega_kernel_gretry_108
L_mega_kernel_gok_107:
    s_add_u32 s63, s63, 16384
    s_cmp_ge_u32 s63, 114688
    s_cselect_b32 s79, s80, s81
    s_cselect_b32 s63, 0, s63
    v_add_u32 v104, s79, v104
    v_add_u32 v105, s79, v105
    v_add_u32 v106, s79, v106
    v_add_u32 v107, s79, v107
    s_waitcnt lgkmcnt(7)
    v_mfma_f32_16x16x32_bf16 v[16:19], v[64:67], a[56:59], v[16:19]
    ds_read_b64_tr_b16 v[48:49], v104 offset:0
    s_add_u32 m0, s62, 3072
    buffer_load_dwordx4 a[48:51], v4, s[56:59], s61 offen offset:0 sc1
    v_mfma_f32_16x16x32_bf16 v[20:23], v[64:67], a[60:63], v[20:23]
    ds_read_b64_tr_b16 v[50:51], v104 offset:1024
    buffer_load_dwordx4 a[52:55], v4, s[56:59], s61 offen offset:256 sc1
    s_waitcnt lgkmcnt(7)
    v_mfma_f32_16x16x32_bf16 v[24:27], v[68:71], a[56:59], v[24:27]
    ds_read_b64_tr_b16 v[52:53], v105 offset:0
    s_add_u32 s61, s61, 2048
    v_mfma_f32_16x16x32_bf16 v[28:31], v[68:71], a[60:63], v[28:31]
    ds_read_b64_tr_b16 v[54:55], v105 offset:1024
    buffer_load_dwordx4 v3, s[48:51], s60 offen lds
    s_waitcnt lgkmcnt(7)
    v_mfma_f32_16x16x32_bf16 v[32:35], v[72:75], a[56:59], v[32:35]
    ds_read_b64_tr_b16 v[56:57], v106 offset:0
    s_add_u32 s60, s60, 221184
    v_mfma_f32_16x16x32_bf16 v[36:39], v[72:75], a[60:63], v[36:39]
    ds_read_b64_tr_b16 v[58:59], v106 offset:1024
    s_add_u32 s62, s62, 16384
    s_waitcnt lgkmcnt(7)
    v_mfma_f32_16x16x32_bf16 v[40:43], v[76:79], a[56:59], v[40:43]
    ds_read_b64_tr_b16 v[60:61], v107 offset:0
    s_cmp_ge_u32 s62, s78
    s_cselect_b32 s62, s77, s62
    v_mfma_f32_16x16x32_bf16 v[44:47], v[76:79], a[60:63], v[44:47]
    ds_read_b64_tr_b16 v[62:63], v107 offset:1024
    s_and_b32 s69, s64, 15
    s_lshr_b64 s[64:65], s[64:65], 4
    s_add_u32 s68, s68, s69
    s_sub_u32 s69, 64, s68
    s_lshr_b64 s[66:67], -1, s69
    v_cmp_ne_u64 vcc, s[32:33], v[98:99]
    s_and_b32 s69, vcc_lo, s66
    s_cbranch_scc0 L_mega_kernel_fok_109
    s_mov_b32 s31, 131072
L_mega_kernel_fretry_110:
    buffer_load_dwordx2 v[98:99], v6, s[24:27], 0 offen sc1
    s_waitcnt vmcnt(0)
    v_cmp_ne_u64 vcc, s[32:33], v[98:99]
    v_mov_b32 v96, v98
    v_mov_b32 v97, v99
    s_sub_u32 s31, s31, 1
    s_cbranch_scc1 L_mega_kernel_fok_109
    s_and_b32 s69, vcc_lo, s66
    s_cbranch_scc1 L_mega_kernel_fretry_110
L_mega_kernel_fok_109:
    s_waitcnt lgkmcnt(6)
    v_mfma_f32_16x16x32_bf16 v[16:19], v[48:51], a[64:67], v[16:19]
    ds_read_b64_tr_b16 v[64:65], v104 offset:4096
    s_add_u32 m0, s62, 0
    v_mfma_f32_16x16x32_bf16 v[20:23], v[48:51], a[68:71], v[20:23]
    ds_read_b64_tr_b16 v[66:67], v104 offset:5120
    buffer_load_dwordx4 a[56:59], v4, s[56:59], s61 offen offset:0 sc1
    s_waitcnt lgkmcnt(6)
    v_mfma_f32_16x16x32_bf16 v[24:27], v[52:55], a[64:67], v[24:27]
    ds_read_b64_tr_b16 v[68:69], v105 offset:4096
    buffer_load_dwordx4 a[60:63], v4, s[56:59], s61 offen offset:256 sc1
    v_mfma_f32_16x16x32_bf16 v[28:31], v[52:55], a[68:71], v[28:31]
    ds_read_b64_tr_b16 v[70:71], v105 offset:5120
    s_add_u32 s61, s61, 2048
    s_waitcnt lgkmcnt(6)
    v_mfma_f32_16x16x32_bf16 v[32:35], v[56:59], a[64:67], v[32:35]
    ds_read_b64_tr_b16 v[72:73], v106 offset:4096
    buffer_load_dwordx4 v3, s[48:51], s60 offen lds
    v_mfma_f32_16x16x32_bf16 v[36:39], v[56:59], a[68:71], v[36:39]
    ds_read_b64_tr_b16 v[74:75], v106 offset:5120
    s_add_u32 s60, s60, 8192
    s_waitcnt lgkmcnt(6)
    v_mfma_f32_16x16x32_bf16 v[40:43], v[60:63], a[64:67], v[40:43]
    ds_read_b64_tr_b16 v[76:77], v107 offset:4096
    v_mfma_f32_16x16x32_bf16 v[44:47], v[60:63], a[68:71], v[44:47]
    ds_read_b64_tr_b16 v[78:79], v107 offset:5120
    s_waitcnt lgkmcnt(6)
    v_mfma_f32_16x16x32_bf16 v[16:19], v[64:67], a[72:75], v[16:19]
    ds_read_b64_tr_b16 v[48:49], v104 offset:8192
    s_add_u32 m0, s62, 1024
    buffer_load_dwordx4 a[64:67], v4, s[56:59], s61 offen offset:0 sc1
    v_mfma_f32_16x16x32_bf16 v[20:23], v[64:67], a[76:79], v[20:23]
    ds_read_b64_tr_b16 v[50:51], v104 offset:9216
    buffer_load_dwordx4 a[68:71], v4, s[56:59], s61 offen offset:256 sc1
    s_waitcnt lgkmcnt(6)
    v_mfma_f32_16x16x32_bf16 v[24:27], v[68:71], a[72:75], v[24:27]
    ds_read_b64_tr_b16 v[52:53], v105 offset:8192
    s_add_u32 s61, s61, 2048
    v_mfma_f32_16x16x32_bf16 v[28:31], v[68:71], a[76:79], v[28:31]
    ds_read_b64_tr_b16 v[54:55], v105 offset:9216
    buffer_load_dwordx4 v3, s[48:51], s60 offen lds
    s_waitcnt lgkmcnt(6)
    v_mfma_f32_16x16x32_bf16 v[32:35], v[72:75], a[72:75], v[32:35]
    ds_read_b64_tr_b16 v[56:57], v106 offset:8192
    s_add_u32 s60, s60, 24576
    v_mfma_f32_16x16x32_bf16 v[36:39], v[72:75], a[76:79], v[36:39]
    ds_read_b64_tr_b16 v[58:59], v106 offset:9216
    buffer_load_dwordx2 v[98:99], v6, s[24:27], 0 offen sc1
    s_waitcnt lgkmcnt(6)
    v_mfma_f32_16x16x32_bf16 v[40:43], v[76:79], a[72:75], v[40:43]
    ds_read_b64_tr_b16 v[60:61], v107 offset:8192
    v_mfma_f32_16x16x32_bf16 v[44:47], v[76:79], a[76:79], v[44:47]
    ds_read_b64_tr_b16 v[62:63], v107 offset:9216
    ds_read_b32 v15, v9
    s_waitcnt lgkmcnt(7)
    v_mfma_f32_16x16x32_bf16 v[16:19], v[48:51], a[80:83], v[16:19]
    ds_read_b64_tr_b16 v[64:65], v104 offset:12288
    s_add_u32 m0, s62, 2048
    v_mfma_f32_16x16x32_bf16 v[20:23], v[48:51], a[84:87], v[20:23]
    ds_read_b64_tr_b16 v[66:67], v104 offset:13312
    buffer_load_dwordx4 a[72:75], v4, s[56:59], s61 offen offset:0 sc1
    s_waitcnt lgkmcnt(7)
    v_mfma_f32_16x16x32_bf16 v[24:27], v[52:55], a[80:83], v[24:27]
    ds_read_b64_tr_b16 v[68:69], v105 offset:12288
    buffer_load_dwordx4 a[76:79], v4, s[56:59], s61 offen offset:256 sc1
    v_mfma_f32_16x16x32_bf16 v[28:31], v[52:55], a[84:87], v[28:31]
    ds_read_b64_tr_b16 v[70:71], v105 offset:13312
    s_add_u32 s61, s61, 2048
    s_waitcnt lgkmcnt(7)
    v_mfma_f32_16x16x32_bf16 v[32:35], v[56:59], a[80:83], v[32:35]
    ds_read_b64_tr_b16 v[72:73], v106 offset:12288
    buffer_load_dwordx4 v3, s[48:51], s60 offen lds
    v_mfma_f32_16x16x32_bf16 v[36:39], v[56:59], a[84:87], v[36:39]
    ds_read_b64_tr_b16 v[74:75], v106 offset:13312
    s_add_u32 s60, s60, 8192
    s_waitcnt lgkmcnt(7)
    v_mfma_f32_16x16x32_bf16 v[40:43], v[60:63], a[80:83], v[40:43]
    ds_read_b64_tr_b16 v[76:77], v107 offset:12288
    v_mfma_f32_16x16x32_bf16 v[44:47], v[60:63], a[84:87], v[44:47]
    ds_read_b64_tr_b16 v[78:79], v107 offset:13312
    s_waitcnt vmcnt(45)
    s_waitcnt vmcnt(35)
    v_add_u32 v11, 1, v11
    ds_write_b32 v10, v11
    s_add_u32 s76, s76, 1
    s_waitcnt lgkmcnt(9)
    v_cmp_gt_u32 vcc, s76, v15
    s_cbranch_vccz L_mega_kernel_gok_111
    s_mov_b32 s31, 1048576
L_mega_kernel_gretry_112:
    ds_read_b32 v15, v9
    s_waitcnt lgkmcnt(0)
    v_cmp_gt_u32 vcc, s76, v15
    s_sub_u32 s31, s31, 1
    s_cbranch_scc1 L_mega_kernel_gok_111
    s_cbranch_vccnz L_mega_kernel_gretry_112
L_mega_kernel_gok_111:
    s_add_u32 s63, s63, 16384
    s_cmp_ge_u32 s63, 114688
    s_cselect_b32 s79, s80, s81
    s_cselect_b32 s63, 0, s63
    v_add_u32 v104, s79, v104
    v_add_u32 v105, s79, v105
    v_add_u32 v106, s79, v106
    v_add_u32 v107, s79, v107
    s_waitcnt lgkmcnt(7)
    v_mfma_f32_16x16x32_bf16 v[16:19], v[64:67], a[88:91], v[16:19]
    ds_read_b64_tr_b16 v[48:49], v104 offset:0
    s_add_u32 m0, s62, 3072
    buffer_load_dwordx4 a[80:83], v4, s[56:59], s61 offen offset:0 sc1
    v_mfma_f32_16x16x32_bf16 v[20:23], v[64:67], a[92:95], v[20:23]
    ds_read_b64_tr_b16 v[50:51], v104 offset:1024
    buffer_load_dwordx4 a[84:87], v4, s[56:59], s61 offen offset:256 sc1
    s_waitcnt lgkmcnt(7)
    v_mfma_f32_16x16x32_bf16 v[24:27], v[68:71], a[88:91], v[24:27]
    ds_read_b64_tr_b16 v[52:53], v105 offset:0
    s_add_u32 s61, s61, 2048
    v_mfma_f32_16x16x32_bf16 v[28:31], v[68:71], a[92:95], v[28:31]
    ds_read_b64_tr_b16 v[54:55], v105 offset:1024
    buffer_load_dwordx4 v3, s[48:51], s60 offen lds
    s_waitcnt lgkmcnt(7)
    v_mfma_f32_16x16x32_bf16 v[32:35], v[72:75], a[88:91], v[32:35]
    ds_read_b64_tr_b16 v[56:57], v106 offset:0
    s_add_u32 s60, s60, 221184
    v_mfma_f32_16x16x32_bf16 v[36:39], v[72:75], a[92:95], v[36:39]
    ds_read_b64_tr_b16 v[58:59], v106 offset:1024
    s_add_u32 s62, s62, 16384
    s_waitcnt lgkmcnt(7)
    v_mfma_f32_16x16x32_bf16 v[40:43], v[76:79], a[88:91], v[40:43]
    ds_read_b64_tr_b16 v[60:61], v107 offset:0
    s_cmp_ge_u32 s62, s78
    s_cselect_b32 s62, s77, s62
    v_mfma_f32_16x16x32_bf16 v[44:47], v[76:79], a[92:95], v[44:47]
    ds_read_b64_tr_b16 v[62:63], v107 offset:1024
    s_waitcnt lgkmcnt(6)
    v_mfma_f32_16x16x32_bf16 v[16:19], v[48:51], a[96:99], v[16:19]
    ds_read_b64_tr_b16 v[64:65], v104 offset:4096
    s_add_u32 m0, s62, 0
    v_mfma_f32_16x16x32_bf16 v[20:23], v[48:51], a[100:103], v[20:23]
    ds_read_b64_tr_b16 v[66:67], v104 offset:5120
    buffer_load_dwordx4 a[88:91], v4, s[56:59], s61 offen offset:0 sc1
    s_waitcnt lgkmcnt(6)
    v_mfma_f32_16x16x32_bf16 v[24:27], v[52:55], a[96:99], v[24:27]
    ds_read_b64_tr_b16 v[68:69], v105 offset:4096
    buffer_load_dwordx4 a[92:95], v4, s[56:59], s61 offen offset:256 sc1
    v_mfma_f32_16x16x32_bf16 v[28:31], v[52:55], a[100:103], v[28:31]
    ds_read_b64_tr_b16 v[70:71], v105 offset:5120
    s_add_u32 s61, s61, 2048
    s_waitcnt lgkmcnt(6)
    v_mfma_f32_16x16x32_bf16 v[32:35], v[56:59], a[96:99], v[32:35]
    ds_read_b64_tr_b16 v[72:73], v106 offset:4096
    buffer_load_dwordx4 v3, s[48:51], s60 offen lds
    v_mfma_f32_16x16x32_bf16 v[36:39], v[56:59], a[100:103], v[36:39]
    ds_read_b64_tr_b16 v[74:75], v106 offset:5120
    s_add_u32 s60, s60, 8192
    s_waitcnt lgkmcnt(6)
    v_mfma_f32_16x16x32_bf16 v[40:43], v[60:63], a[96:99], v[40:43]
    ds_read_b64_tr_b16 v[76:77], v107 offset:4096
    v_mfma_f32_16x16x32_bf16 v[44:47], v[60:63], a[100:103], v[44:47]
    ds_read_b64_tr_b16 v[78:79], v107 offset:5120
    s_waitcnt lgkmcnt(6)
    v_mfma_f32_16x16x32_bf16 v[16:19], v[64:67], a[104:107], v[16:19]
    ds_read_b64_tr_b16 v[48:49], v104 offset:8192
    s_add_u32 m0, s62, 1024
    v_mfma_f32_16x16x32_bf16 v[20:23], v[64:67], a[108:111], v[20:23]
    ds_read_b64_tr_b16 v[50:51], v104 offset:9216
    buffer_load_dwordx4 a[96:99], v4, s[56:59], s61 offen offset:0 sc1
    s_waitcnt lgkmcnt(6)
    v_mfma_f32_16x16x32_bf16 v[24:27], v[68:71], a[104:107], v[24:27]
    ds_read_b64_tr_b16 v[52:53], v105 offset:8192
    buffer_load_dwordx4 a[100:103], v4, s[56:59], s61 offen offset:256 sc1
    v_mfma_f32_16x16x32_bf16 v[28:31], v[68:71], a[108:111], v[28:31]
    ds_read_b64_tr_b16 v[54:55], v105 offset:9216
    s_add_u32 s61, s61, 2048
    s_waitcnt lgkmcnt(6)
    v_mfma_f32_16x16x32_bf16 v[32:35], v[72:75], a[104:107], v[32:35]
    ds_read_b64_tr_b16 v[56:57], v106 offset:8192
    buffer_load_dwordx4 v3, s[48:51], s60 offen lds
    v_mfma_f32_16x16x32_bf16 v[36:39], v[72:75], a[108:111], v[36:39]
    ds_read_b64_tr_b16 v[58:59], v106 offset:9216
    s_add_u32 s60, s60, 24576
    s_waitcnt lgkmcnt(6)
    v_mfma_f32_16x16x32_bf16 v[40:43], v[76:79], a[104:107], v[40:43]
    ds_read_b64_tr_b16 v[60:61], v107 offset:8192
    v_mfma_f32_16x16x32_bf16 v[44:47], v[76:79], a[108:111], v[44:47]
    ds_read_b64_tr_b16 v[62:63], v107 offset:9216
    ds_read_b32 v15, v9
    s_waitcnt lgkmcnt(7)
    v_mfma_f32_16x16x32_bf16 v[16:19], v[48:51], a[112:115], v[16:19]
    ds_read_b64_tr_b16 v[64:65], v104 offset:12288
    s_add_u32 m0, s62, 2048
    v_mfma_f32_16x16x32_bf16 v[20:23], v[48:51], a[116:119], v[20:23]
    ds_read_b64_tr_b16 v[66:67], v104 offset:13312
    buffer_load_dwordx4 a[104:107], v4, s[56:59], s61 offen offset:0 sc1
    s_waitcnt lgkmcnt(7)
    v_mfma_f32_16x16x32_bf16 v[24:27], v[52:55], a[112:115], v[24:27]
    ds_read_b64_tr_b16 v[68:69], v105 offset:12288
    buffer_load_dwordx4 a[108:111], v4, s[56:59], s61 offen offset:256 sc1
    v_mfma_f32_16x16x32_bf16 v[28:31], v[52:55], a[116:119], v[28:31]
    ds_read_b64_tr_b16 v[70:71], v105 offset:13312
    s_add_u32 s61, s61, 2048
    s_waitcnt lgkmcnt(7)
    v_mfma_f32_16x16x32_bf16 v[32:35], v[56:59], a[112:115], v[32:35]
    ds_read_b64_tr_b16 v[72:73], v106 offset:12288
    buffer_load_dwordx4 v3, s[48:51], s60 offen lds
    v_mfma_f32_16x16x32_bf16 v[36:39], v[56:59], a[116:119], v[36:39]
    ds_read_b64_tr_b16 v[74:75], v106 offset:13312
    s_add_u32 s60, s60, 8192
    s_waitcnt lgkmcnt(7)
    v_mfma_f32_16x16x32_bf16 v[40:43], v[60:63], a[112:115], v[40:43]
    ds_read_b64_tr_b16 v[76:77], v107 offset:12288
    v_mfma_f32_16x16x32_bf16 v[44:47], v[60:63], a[116:119], v[44:47]
    ds_read_b64_tr_b16 v[78:79], v107 offset:13312
    s_waitcnt vmcnt(45)
    s_waitcnt vmcnt(34)
    v_add_u32 v11, 1, v11
    ds_write_b32 v10, v11
    s_add_u32 s76, s76, 1
    s_waitcnt lgkmcnt(9)
    v_cmp_gt_u32 vcc, s76, v15
    s_cbranch_vccz L_mega_kernel_gok_113
    s_mov_b32 s31, 1048576
L_mega_kernel_gretry_114:
    ds_read_b32 v15, v9
    s_waitcnt lgkmcnt(0)
    v_cmp_gt_u32 vcc, s76, v15
    s_sub_u32 s31, s31, 1
    s_cbranch_scc1 L_mega_kernel_gok_113
    s_cbranch_vccnz L_mega_kernel_gretry_114
L_mega_kernel_gok_113:
    s_add_u32 s63, s63, 16384
    s_cmp_ge_u32 s63, 114688
    s_cselect_b32 s79, s80, s81
    s_cselect_b32 s63, 0, s63
    v_add_u32 v104, s79, v104
    v_add_u32 v105, s79, v105
    v_add_u32 v106, s79, v106
    v_add_u32 v107, s79, v107
    s_waitcnt lgkmcnt(7)
    v_mfma_f32_16x16x32_bf16 v[16:19], v[64:67], a[120:123], v[16:19]
    ds_read_b64_tr_b16 v[48:49], v104 offset:0
    s_add_u32 m0, s62, 3072
    buffer_load_dwordx4 a[112:115], v4, s[56:59], s61 offen offset:0 sc1
    v_mfma_f32_16x16x32_bf16 v[20:23], v[64:67], a[124:127], v[20:23]
    ds_read_b64_tr_b16 v[50:51], v104 offset:1024
    buffer_load_dwordx4 a[116:119], v4, s[56:59], s61 offen offset:256 sc1
    s_waitcnt lgkmcnt(7)
    v_mfma_f32_16x16x32_bf16 v[24:27], v[68:71], a[120:123], v[24:27]
    ds_read_b64_tr_b16 v[52:53], v105 offset:0
    s_add_u32 s61, s61, 2048
    v_mfma_f32_16x16x32_bf16 v[28:31], v[68:71], a[124:127], v[28:31]
    ds_read_b64_tr_b16 v[54:55], v105 offset:1024
    buffer_load_dwordx4 v3, s[48:51], s60 offen lds
    s_waitcnt lgkmcnt(7)
    v_mfma_f32_16x16x32_bf16 v[32:35], v[72:75], a[120:123], v[32:35]
    ds_read_b64_tr_b16 v[56:57], v106 offset:0
    s_add_u32 s60, s60, 221184
    v_mfma_f32_16x16x32_bf16 v[36:39], v[72:75], a[124:127], v[36:39]
    ds_read_b64_tr_b16 v[58:59], v106 offset:1024
    s_add_u32 s62, s62, 16384
    s_waitcnt lgkmcnt(7)
    v_mfma_f32_16x16x32_bf16 v[40:43], v[76:79], a[120:123], v[40:43]
    ds_read_b64_tr_b16 v[60:61], v107 offset:0
    s_cmp_ge_u32 s62, s78
    s_cselect_b32 s62, s77, s62
    v_mfma_f32_16x16x32_bf16 v[44:47], v[76:79], a[124:127], v[44:47]
    ds_read_b64_tr_b16 v[62:63], v107 offset:1024
    s_sub_u32 s72, s72, 1
    s_cmp_lg_u32 s72, 0
    s_cbranch_scc1 L_g2_loop
    s_waitcnt vmcnt(0) lgkmcnt(0)
    v_mov_b32 v11, 200
    ds_write_b32 v10, v11
    s_mov_b32 s76, 199
    s_add_u32 s76, s76, 1
    s_mov_b32 s31, 1048576
L_mega_kernel_gretry_116:
    ds_read_b32 v15, v9
    s_waitcnt lgkmcnt(0)
    v_cmp_gt_u32 vcc, s76, v15
    s_sub_u32 s31, s31, 1
    s_cbranch_scc1 L_mega_kernel_gok_115
    s_cbranch_vccnz L_mega_kernel_gretry_116
L_mega_kernel_gok_115:
    ds_write_b128 v5, v[16:19] offset:0
    ds_write_b128 v5, v[20:23] offset:4352
    ds_write_b128 v5, v[24:27] offset:64
    ds_write_b128 v5, v[28:31] offset:4416
    ds_write_b128 v5, v[32:35] offset:128
    ds_write_b128 v5, v[36:39] offset:4480
    ds_write_b128 v5, v[40:43] offset:192
    ds_write_b128 v5, v[44:47] offset:4544
    s_waitcnt lgkmcnt(0)
    s_barrier
    s_endpgm
L_end:
    s_endpgm
L_at_slow:
    s_waitcnt vmcnt(0)
    s_mov_b32 s60, 0
    s_mov_b32 s63, 64
    v_mov_b32 v108, 0xff800000
    v_mov_b32 v109, 0xff800000
    v_mov_b32 v110, 0
    v_mov_b32 v111, 0
    v_mov_b32 v64, 0
    v_mov_b32 v65, 0
    v_mov_b32 v66, 0
    v_mov_b32 v67, 0
    v_mov_b32 v68, 0
    v_mov_b32 v69, 0
    v_mov_b32 v70, 0
    v_mov_b32 v71, 0
    v_mov_b32 v72, 0
    v_mov_b32 v73, 0
    v_mov_b32 v74, 0
    v_mov_b32 v75, 0
    v_mov_b32 v76, 0
    v_mov_b32 v77, 0
    v_mov_b32 v78, 0
    v_mov_b32 v79, 0
    v_mov_b32 v80, 0
    v_mov_b32 v81, 0
    v_mov_b32 v82, 0
    v_mov_b32 v83, 0
    v_mov_b32 v84, 0
    v_mov_b32 v85, 0
    v_mov_b32 v86, 0
    v_mov_b32 v87, 0
    v_mov_b32 v88, 0
    v_mov_b32 v89, 0
    v_mov_b32 v90, 0
    v_mov_b32 v91, 0
    v_mov_b32 v92, 0
    v_mov_b32 v93, 0
    v_mov_b32 v94, 0
    v_mov_b32 v95, 0
L_at_slow_loop:
    buffer_load_dwordx4 a[16:19], v2, s[48:51], s60 offen offset:0 sc1
    buffer_load_dwordx4 a[20:23], v2, s[48:51], s60 offen offset:1024 sc1
    buffer_load_dwordx4 a[24:27], v2, s[48:51], s60 offen offset:2048 sc1
    buffer_load_dwordx4 a[28:31], v2, s[48:51], s60 offen offset:3072 sc1
    s_add_u32 s60, s60, 4096
    s_waitcnt vmcnt(0)
    v_mfma_f32_32x32x16_bf16 v[16:31], a[16:19], a[0:3], 0
    v_mfma_f32_32x32x16_bf16 v[16:31], a[20:23], a[4:7], v[16:31]
    s_nop 15
    v_max_f32 v7, v16, v17
    v_max3_f32 v7, v18, v19, v7
    v_max3_f32 v7, v20, v21, v7
    v_max3_f32 v7, v22, v23, v7
    v_max3_f32 v7, v24, v25, v7
    v_max3_f32 v7, v26, v27, v7
    v_max3_f32 v7, v28, v29, v7
    v_max3_f32 v7, v30, v31, v7
    v_mov_b32 v8, v7
    s_nop 1
    v_permlane32_swap_b32 v7, v8
    v_max3_f32 v7, v7, v8, v108
    v_sub_f32 v8, v108, v7
    v_exp_f32 v8, v8
    v_mov_b32 v108, v7
    v_sub_f32 v16, v16, v7
    v_sub_f32 v17, v17, v7
    v_sub_f32 v18, v18, v7
    v_sub_f32 v19, v19, v7
    v_sub_f32 v20, v20, v7
    v_sub_f32 v21, v21, v7
    v_sub_f32 v22, v22, v7
    v_sub_f32 v23, v23, v7
    v_sub_f32 v24, v24, v7
    v_sub_f32 v25, v25, v7
    v_sub_f32 v26, v26, v7
    v_sub_f32 v27, v27, v7
    v_sub_f32 v28, v28, v7
    v_sub_f32 v29, v29, v7
    v_sub_f32 v30, v30, v7
    v_sub_f32 v31, v31, v7
    v_exp_f32 v16, v16
    v_exp_f32 v17, v17
    v_exp_f32 v18, v18
    v_exp_f32 v19, v19
    v_exp_f32 v20, v20
    v_exp_f32 v21, v21
    v_exp_f32 v22, v22
    v_exp_f32 v23, v23
    v_exp_f32 v24, v24
    v_exp_f32 v25, v25
    v_exp_f32 v26, v26
    v_exp_f32 v27, v27
    v_exp_f32 v28, v28
    v_exp_f32 v29, v29
    v_exp_f32 v30, v30
    v_exp_f32 v31, v31
    v_mul_f32 v64, v64, v8
    v_mul_f32 v65, v65, v8
    v_mul_f32 v66, v66, v8
    v_mul_f32 v67, v67, v8
    v_mul_f32 v68, v68, v8
    v_mul_f32 v69, v69, v8
    v_mul_f32 v70, v70, v8
    v_mul_f32 v71, v71, v8
    v_mul_f32 v72, v72, v8
    v_mul_f32 v73, v73, v8
    v_mul_f32 v74, v74, v8
    v_mul_f32 v75, v75, v8
    v_mul_f32 v76, v76, v8
    v_mul_f32 v77, v77, v8
    v_mul_f32 v78, v78, v8
    v_mul_f32 v79, v79, v8
    v_cvt_pk_bf16_f32 v48, v16, v17
    v_cvt_pk_bf16_f32 v49, v18, v19
    v_cvt_pk_bf16_f32 v50, v20, v21
    v_cvt_pk_bf16_f32 v51, v22, v23
    v_cvt_pk_bf16_f32 v52, v24, v25
    v_cvt_pk_bf16_f32 v53, v26, v27
    v_cvt_pk_bf16_f32 v54, v28, v29
    v_cvt_pk_bf16_f32 v55, v30, v31
    v_mul_f32 v110, v110, v8
    v_mov_b32 v9, 0
    v_lshlrev_b32 v10, 16, v48
    v_and_b32 v11, 0xffff0000, v48
    v_add_f32 v9, v9, v10
    v_add_f32 v9, v9, v11
    v_lshlrev_b32 v10, 16, v49
    v_and_b32 v11, 0xffff0000, v49
    v_add_f32 v9, v9, v10
    v_add_f32 v9, v9, v11
    v_lshlrev_b32 v10, 16, v50
    v_and_b32 v11, 0xffff0000, v50
    v_add_f32 v9, v9, v10
    v_add_f32 v9, v9, v11
    v_lshlrev_b32 v10, 16, v51
    v_and_b32 v11, 0xffff0000, v51
    v_add_f32 v9, v9, v10
    v_add_f32 v9, v9, v11
    v_lshlrev_b32 v10, 16, v52
    v_and_b32 v11, 0xffff0000, v52
    v_add_f32 v9, v9, v10
    v_add_f32 v9, v9, v11
    v_lshlrev_b32 v10, 16, v53
    v_and_b32 v11, 0xffff0000, v53
    v_add_f32 v9, v9, v10
    v_add_f32 v9, v9, v11
    v_lshlrev_b32 v10, 16, v54
    v_and_b32 v11, 0xffff0000, v54
    v_add_f32 v9, v9, v10
    v_add_f32 v9, v9, v11
    v_lshlrev_b32 v10, 16, v55
    v_and_b32 v11, 0xffff0000, v55
    v_add_f32 v9, v9, v10
    v_add_f32 v9, v9, v11
    v_mov_b32 v10, v9
    s_nop 1
    v_permlane32_swap_b32 v9, v10
    v_add_f32 v9, v9, v10
    v_add_f32 v110, v110, v9
    v_mfma_f32_32x32x16_bf16 v[64:79], a[24:27], v[48:51], v[64:79]
    v_mfma_f32_32x32x16_bf16 v[64:79], a[28:31], v[52:55], v[64:79]
    s_nop 15
    v_mfma_f32_32x32x16_bf16 v[16:31], a[16:19], a[8:11], 0
    v_mfma_f32_32x32x16_bf16 v[16:31], a[20:23], a[12:15], v[16:31]
    s_nop 15
    v_max_f32 v7, v16, v17
    v_max3_f32 v7, v18, v19, v7
    v_max3_f32 v7, v20, v21, v7
    v_max3_f32 v7, v22, v23, v7
    v_max3_f32 v7, v24, v25, v7
    v_max3_f32 v7, v26, v27, v7
    v_max3_f32 v7, v28, v29, v7
    v_max3_f32 v7, v30, v31, v7
    v_mov_b32 v8, v7
    s_nop 1
    v_permlane32_swap_b32 v7, v8
    v_max3_f32 v7, v7, v8, v109
    v_sub_f32 v8, v109, v7
    v_exp_f32 v8, v8
    v_mov_b32 v109, v7
    v_sub_f32 v16, v16, v7
    v_sub_f32 v17, v17, v7
    v_sub_f32 v18, v18, v7
    v_sub_f32 v19, v19, v7
    v_sub_f32 v20, v20, v7
    v_sub_f32 v21, v21, v7
    v_sub_f32 v22, v22, v7
    v_sub_f32 v23, v23, v7
    v_sub_f32 v24, v24, v7
    v_sub_f32 v25, v25, v7
    v_sub_f32 v26, v26, v7
    v_sub_f32 v27, v27, v7
    v_sub_f32 v28, v28, v7
    v_sub_f32 v29, v29, v7
    v_sub_f32 v30, v30, v7
    v_sub_f32 v31, v31, v7
    v_exp_f32 v16, v16
    v_exp_f32 v17, v17
    v_exp_f32 v18, v18
    v_exp_f32 v19, v19
    v_exp_f32 v20, v20
    v_exp_f32 v21, v21
    v_exp_f32 v22, v22
    v_exp_f32 v23, v23
    v_exp_f32 v24, v24
    v_exp_f32 v25, v25
    v_exp_f32 v26, v26
    v_exp_f32 v27, v27
    v_exp_f32 v28, v28
    v_exp_f32 v29, v29
    v_exp_f32 v30, v30
    v_exp_f32 v31, v31
    v_mul_f32 v80, v80, v8
    v_mul_f32 v81, v81, v8
    v_mul_f32 v82, v82, v8
    v_mul_f32 v83, v83, v8
    v_mul_f32 v84, v84, v8
    v_mul_f32 v85, v85, v8
    v_mul_f32 v86, v86, v8
    v_mul_f32 v87, v87, v8
    v_mul_f32 v88, v88, v8
    v_mul_f32 v89, v89, v8
    v_mul_f32 v90, v90, v8
    v_mul_f32 v91, v91, v8
    v_mul_f32 v92, v92, v8
    v_mul_f32 v93, v93, v8
    v_mul_f32 v94, v94, v8
    v_mul_f32 v95, v95, v8
    v_cvt_pk_bf16_f32 v48, v16, v17
    v_cvt_pk_bf16_f32 v49, v18, v19
    v_cvt_pk_bf16_f32 v50, v20, v21
    v_cvt_pk_bf16_f32 v51, v22, v23
    v_cvt_pk_bf16_f32 v52, v24, v25
    v_cvt_pk_bf16_f32 v53, v26, v27
    v_cvt_pk_bf16_f32 v54, v28, v29
    v_cvt_pk_bf16_f32 v55, v30, v31
    v_mul_f32 v111, v111, v8
    v_mov_b32 v9, 0
    v_lshlrev_b32 v10, 16, v48
    v_and_b32 v11, 0xffff0000, v48
    v_add_f32 v9, v9, v10
    v_add_f32 v9, v9, v11
    v_lshlrev_b32 v10, 16, v49
    v_and_b32 v11, 0xffff0000, v49
    v_add_f32 v9, v9, v10
    v_add_f32 v9, v9, v11
    v_lshlrev_b32 v10, 16, v50
    v_and_b32 v11, 0xffff0000, v50
    v_add_f32 v9, v9, v10
    v_add_f32 v9, v9, v11
    v_lshlrev_b32 v10, 16, v51
    v_and_b32 v11, 0xffff0000, v51
    v_add_f32 v9, v9, v10
    v_add_f32 v9, v9, v11
    v_lshlrev_b32 v10, 16, v52
    v_and_b32 v11, 0xffff0000, v52
    v_add_f32 v9, v9, v10
    v_add_f32 v9, v9, v11
    v_lshlrev_b32 v10, 16, v53
    v_and_b32 v11, 0xffff0000, v53
    v_add_f32 v9, v9, v10
    v_add_f32 v9, v9, v11
    v_lshlrev_b32 v10, 16, v54
    v_and_b32 v11, 0xffff0000, v54
    v_add_f32 v9, v9, v10
    v_add_f32 v9, v9, v11
    v_lshlrev_b32 v10, 16, v55
    v_and_b32 v11, 0xffff0000, v55
    v_add_f32 v9, v9, v10
    v_add_f32 v9, v9, v11
    v_mov_b32 v10, v9
    s_nop 1
    v_permlane32_swap_b32 v9, v10
    v_add_f32 v9, v9, v10
    v_add_f32 v111, v111, v9
    v_mfma_f32_32x32x16_bf16 v[80:95], a[24:27], v[48:51], v[80:95]
    v_mfma_f32_32x32x16_bf16 v[80:95], a[28:31], v[52:55], v[80:95]
    s_nop 15
    s_sub_u32 s63, s63, 1
    s_cmp_lg_u32 s63, 0
    s_cbranch_scc1 L_at_slow_loop
    s_branch L_at_fin
L_code_end:
.section .rodata,"a"
.p2align 6
.amdhsa_kernel mega_kernel
  .amdhsa_next_free_vgpr 256
  .amdhsa_next_free_sgpr 102
  .amdhsa_accum_offset 128
  .amdhsa_group_segment_fixed_size 0
  .amdhsa_kernarg_size 80
  .amdhsa_user_sgpr_count 2
  .amdhsa_user_sgpr_kernarg_segment_ptr 1
  .amdhsa_system_sgpr_workgroup_id_x 1
.end_amdhsa_kernel
```
